```python
import torch

def _softmax(x, axis=-1):
    return torch.softmax(x, dim=axis)
def _gelu(x):
    return torch.nn.functional.gelu(x, approximate="tanh")
def _silu(x):
    return torch.nn.functional.silu(x)
def _sigmoid(x):
    return torch.sigmoid(x)
def _layernorm(x, axis=-1, eps=1e-5):
    m = x.mean(dim=axis, keepdim=True)
    v = x.var(dim=axis, keepdim=True, unbiased=False)
    return (x - m) / torch.sqrt(v + eps)
def _scatter_add(tgt, idx, src, axis=0):
    return tgt.clone().index_add_(axis, idx, src)
def _segment_sum(src, seg, n):
    out = torch.zeros((n,) + src.shape[1:], dtype=src.dtype)
    return out.index_add_(0, seg, src)
def _pad(x, pw):
    flat = tuple(v for pair in reversed(pw) for v in pair)
    return torch.nn.functional.pad(x, flat)

kernel_name = 'concat_heads__gqa_block_cached__gqa_block_cached__near_ridge'

def setup_inputs():

    _w = (lambda a: (lambda t: t.to(torch.bfloat16) if t.is_floating_point() else t)(torch.as_tensor(a)))
    def _A_setup():
        B, Sq, D = 8, 128, 640
        Hq, Hkv, Sk, Dh = 32, 32, 512, 192
        assert Hq % Hkv == 0, (Hq, Hkv)
        return {
            "x": _w((lambda *s: torch.randn(*s, dtype=torch.bfloat16) * 0.8)(B, Sq, D)),
            "k_cache": _w((lambda *s: torch.randn(*s, dtype=torch.bfloat16) * 0.8)(B, Hkv, Sk, Dh)),
            "v_cache": _w((lambda *s: torch.randn(*s, dtype=torch.bfloat16) * 0.05)(B, Hkv, Sk, Dh)),
            "wq": _w((lambda *s: torch.randn(*s, dtype=torch.bfloat16) * 0.8)(D, Hq * Dh) * (D ** -0.5)),
            "wo": _w((lambda *s: torch.randn(*s, dtype=torch.bfloat16) * 0.05)(Hq * Dh, D) * ((Hq * Dh) ** -0.5)),
        }
    _A_in = _A_setup()

    def _B_setup():
        B, Sq, D = 8, 128, 640
        Hq, Hkv, Sk, Dh = 32, 32, 512, 192
        assert Hq % Hkv == 0, (Hq, Hkv)
        return {
            "x": _w((lambda *s: torch.randn(*s, dtype=torch.bfloat16) * 0.8)(B, Sq, D)),
            "k_cache": _w((lambda *s: torch.randn(*s, dtype=torch.bfloat16) * 0.8)(B, Hkv, Sk, Dh)),
            "v_cache": _w((lambda *s: torch.randn(*s, dtype=torch.bfloat16) * 0.05)(B, Hkv, Sk, Dh)),
            "wq": _w((lambda *s: torch.randn(*s, dtype=torch.bfloat16) * 0.8)(D, Hq * Dh) * (D ** -0.5)),
            "wo": _w((lambda *s: torch.randn(*s, dtype=torch.bfloat16) * 0.05)(Hq * Dh, D) * ((Hq * Dh) ** -0.5)),
        }
    _B_in = _B_setup()

    return {
        "A_x": _A_in["x"],
        "A_k_cache": _A_in["k_cache"],
        "A_v_cache": _A_in["v_cache"],
        "A_wq": _A_in["wq"],
        "A_wo": _A_in["wo"],
        "B_x": _B_in["x"],
        "B_k_cache": _B_in["k_cache"],
        "B_v_cache": _B_in["v_cache"],
        "B_wq": _B_in["wq"],
        "B_wo": _B_in["wo"],
    }

def reference(A_x, A_k_cache, A_v_cache, A_wq, A_wo, B_x, B_k_cache, B_v_cache, B_wq, B_wo):
    def _A_ref(x, k_cache, v_cache, wq, wo):
        B, Sq, D = x.shape
        Hq, Dh = 32, 192
        Hkv = k_cache.shape[1]
        rep = Hq // Hkv
        q = (lambda x, *d: x.permute(*d))((x @ wq).reshape(B, Sq, Hq, Dh), 0, 2, 1, 3)
        k = (lambda x, n, axis: torch.repeat_interleave(x, n, dim=axis))(k_cache, rep, axis=1)
        v = (lambda x, n, axis: torch.repeat_interleave(x, n, dim=axis))(v_cache, rep, axis=1)
        scores = torch.einsum("bhqd,bhkd->bhqk", q, k) * (Dh ** -0.5)
        p = _softmax(scores, axis=-1)
        o = torch.einsum("bhqk,bhkd->bhqd", p, v)
        return (lambda x, *d: x.permute(*d))(o, 0, 2, 1, 3).reshape(B, Sq, Hq * Dh) @ wo

    def _B_ref(x, k_cache, v_cache, wq, wo):
        B, Sq, D = x.shape
        Hq, Dh = 32, 192
        Hkv = k_cache.shape[1]
        rep = Hq // Hkv
        q = (lambda x, *d: x.permute(*d))((x @ wq).reshape(B, Sq, Hq, Dh), 0, 2, 1, 3)
        k = (lambda x, n, axis: torch.repeat_interleave(x, n, dim=axis))(k_cache, rep, axis=1)
        v = (lambda x, n, axis: torch.repeat_interleave(x, n, dim=axis))(v_cache, rep, axis=1)
        scores = torch.einsum("bhqd,bhkd->bhqk", q, k) * (Dh ** -0.5)
        p = _softmax(scores, axis=-1)
        o = torch.einsum("bhqk,bhkd->bhqd", p, v)
        return (lambda x, *d: x.permute(*d))(o, 0, 2, 1, 3).reshape(B, Sq, Hq * Dh) @ wo

    a = _A_ref(A_x, A_k_cache, A_v_cache, A_wq, A_wo)
    b = _B_ref(B_x, B_k_cache, B_v_cache, B_wq, B_wo)
    return torch.concatenate([a, b], axis=-1)
```

```asm
; @launch grid=(256,1,1) block=(512,1,1) lds=163840
.amdgcn_target "amdgcn-amd-amdhsa--gfx950"
.text
.globl concat_heads__gqa_block_cached__gqa_block_cached__near_ridge_kernel
.p2align 8
.type concat_heads__gqa_block_cached__gqa_block_cached__near_ridge_kernel,@function
concat_heads__gqa_block_cached__gqa_block_cached__near_ridge_kernel:
    s_cmp_ge_u32 s2, 256
    s_cbranch_scc1 L2_end
    s_load_dwordx16 s[32:47], s[0:1], 0
    s_load_dwordx4 s[48:51], s[0:1], 64
    s_load_dwordx2 s[52:53], s[0:1], 96
    s_load_dwordx4 s[84:87], s[0:1], 80
    v_and_b32 v1, 63, v0
    v_lshrrev_b32 v19, 6, v0
    s_and_b32 s54, s2, 7
    v_readfirstlane_b32 s27, v19
    s_lshr_b32 s55, s2, 3
    s_lshr_b32 s56, s54, 2
    s_and_b32 s57, s54, 3
    s_lshl_b32 s57, s57, 3
    s_and_b32 s58, s55, 7
    s_add_u32 s57, s57, s58
    s_lshr_b32 s55, s55, 3
    s_and_b32 s24, s27, 3
    s_lshr_b32 s54, s27, 2
    s_lshl_b32 s58, s54, 2
    s_add_u32 s58, s58, s55
    s_mul_i32 s78, s54, 73728
    s_add_u32 s79, s78, 73728
    s_mul_i32 s25, s24, 3072
    s_add_u32 s26, s25, 73728
    s_lshl_b32 s30, s24, 12
    s_mul_i32 s59, s54, 90112
    s_add_u32 s30, s30, s59
    s_add_u32 s30, s30, 40960
    v_add_u32 v19, 0, v1
    v_mul_u32_u24 v20, 2731, v19
    v_lshrrev_b32 v20, 16, v20
    v_mul_u32_u24 v21, 24, v20
    v_sub_u32 v21, v19, v21
    s_lshl_b32 s59, s24, 3
    v_add_u32 v20, s59, v20
    v_lshrrev_b32 v22, 1, v20
    v_and_b32 v22, 1, v22
    v_lshlrev_b32 v22, 2, v22
    v_bfe_u32 v23, v20, 2, 2
    v_or_b32 v22, v22, v23
    v_xor_b32 v21, v21, v22
    v_mul_u32_u24 v22, 384, v20
    v_lshl_add_u32 v2, v21, 4, v22
    v_mul_u32_u24 v22, 12288, v20
    v_lshl_add_u32 v168, v21, 4, v22
    v_add_u32 v19, 64, v1
    v_mul_u32_u24 v20, 2731, v19
    v_lshrrev_b32 v20, 16, v20
    v_mul_u32_u24 v21, 24, v20
    v_sub_u32 v21, v19, v21
    s_lshl_b32 s59, s24, 3
    v_add_u32 v20, s59, v20
    v_lshrrev_b32 v22, 1, v20
    v_and_b32 v22, 1, v22
    v_lshlrev_b32 v22, 2, v22
    v_bfe_u32 v23, v20, 2, 2
    v_or_b32 v22, v22, v23
    v_xor_b32 v21, v21, v22
    v_mul_u32_u24 v22, 384, v20
    v_lshl_add_u32 v3, v21, 4, v22
    v_mul_u32_u24 v22, 12288, v20
    v_lshl_add_u32 v169, v21, 4, v22
    v_add_u32 v19, 128, v1
    v_mul_u32_u24 v20, 2731, v19
    v_lshrrev_b32 v20, 16, v20
    v_mul_u32_u24 v21, 24, v20
    v_sub_u32 v21, v19, v21
    s_lshl_b32 s59, s24, 3
    v_add_u32 v20, s59, v20
    v_lshrrev_b32 v22, 1, v20
    v_and_b32 v22, 1, v22
    v_lshlrev_b32 v22, 2, v22
    v_bfe_u32 v23, v20, 2, 2
    v_or_b32 v22, v22, v23
    v_xor_b32 v21, v21, v22
    v_mul_u32_u24 v22, 384, v20
    v_lshl_add_u32 v4, v21, 4, v22
    v_mul_u32_u24 v22, 12288, v20
    v_lshl_add_u32 v182, v21, 4, v22
    v_lshrrev_b32 v19, 3, v1
    s_lshl_b32 s59, s24, 5
    v_add_u32 v19, s59, v19
    v_mul_u32_u24 v19, 1280, v19
    v_and_b32 v20, 7, v1
    v_lshrrev_b32 v21, 4, v1
    v_xor_b32 v20, v20, v21
    v_lshl_add_u32 v170, v20, 4, v19
    v_xor_b32 v20, 4, v20
    v_lshl_add_u32 v171, v20, 4, v19
    v_add_u32 v171, 10240, v171
    v_add_u32 v172, 20480, v170
    v_add_u32 v173, 20480, v171
    s_lshl_b32 s28, s55, 1
    s_add_u32 s28, s28, s57
    s_and_b32 s28, s28, 7
    s_mul_i32 s28, s28, 10
    s_lshr_b32 s28, s28, 3
    s_mul_i32 s29, s54, 4
    s_add_u32 s29, s29, s28
    s_cmp_ge_u32 s29, 10
    s_cselect_b32 s59, 10, 0
    s_sub_u32 s29, s29, s59
    s_lshl_b32 s29, s29, 7
    s_mul_i32 s28, s28, 786432
    s_waitcnt lgkmcnt(0)
    s_cmp_eq_u32 s56, 0
    s_cselect_b64 s[60:61], s[32:33], s[42:43]
    s_cselect_b64 s[62:63], s[34:35], s[44:45]
    s_cselect_b64 s[64:65], s[36:37], s[46:47]
    s_cselect_b64 s[66:67], s[38:39], s[48:49]
    s_cselect_b64 s[80:81], s[40:41], s[50:51]
    s_mul_i32 s59, s58, 163840
    s_add_u32 s60, s60, s59
    s_addc_u32 s61, s61, 0
    s_mov_b32 s4, s60
    s_and_b32 s5, s61, 0xffff
    s_mov_b32 s6, 0x28000
    s_mov_b32 s7, 0x00020000
    s_mul_i32 s59, s57, 384
    s_add_u32 s66, s66, s59
    s_addc_u32 s67, s67, 0
    s_sub_u32 s68, 7864320, s59
    s_mov_b32 s8, s66
    s_and_b32 s9, s67, 0xffff
    s_mov_b32 s10, s68
    s_mov_b32 s11, 0x00020000
    s_cmp_eq_u32 s54, 0
    s_cbranch_scc1 L1_i0
    s_add_u32 m0, s26, 0
    s_nop 0
    buffer_load_dwordx4 v168, s[8:11], s28 offen lds
    s_add_u32 m0, s26, 1024
    s_nop 0
    buffer_load_dwordx4 v169, s[8:11], s28 offen lds
    s_add_u32 m0, s26, 2048
    s_nop 0
    buffer_load_dwordx4 v182, s[8:11], s28 offen lds
    s_add_u32 s28, s28, 393216
    s_cmp_eq_u32 s28, 7864320
    s_cselect_b32 s28, 0, s28
    s_add_u32 m0, s26, 12288
    s_nop 0
    buffer_load_dwordx4 v168, s[8:11], s28 offen lds
    s_add_u32 m0, s26, 13312
    s_nop 0
    buffer_load_dwordx4 v169, s[8:11], s28 offen lds
    s_add_u32 m0, s26, 14336
    s_nop 0
    buffer_load_dwordx4 v182, s[8:11], s28 offen lds
    s_add_u32 s28, s28, 393216
    s_cmp_eq_u32 s28, 7864320
    s_cselect_b32 s28, 0, s28
    s_branch L1_i1
L1_i0:
    s_add_u32 m0, s30, 0
    s_nop 0
    buffer_load_dwordx4 v170, s[4:7], s29 offen lds
    s_add_u32 m0, s30, 1024
    s_nop 0
    buffer_load_dwordx4 v171, s[4:7], s29 offen lds
    s_add_u32 m0, s30, 2048
    s_nop 0
    buffer_load_dwordx4 v172, s[4:7], s29 offen lds
    s_add_u32 m0, s30, 3072
    s_nop 0
    buffer_load_dwordx4 v173, s[4:7], s29 offen lds
    s_add_u32 s29, s29, 128
    s_cmp_eq_u32 s29, 1280
    s_cselect_b32 s29, 0, s29
L1_i1:
    s_mul_i32 s41, s54, 49152
    s_add_u32 s41, s41, s78
    s_lshl_b32 s59, s58, 5
    s_add_u32 s59, s59, s57
    s_mul_i32 s69, s59, 196608
    s_add_u32 s62, s62, s69
    s_addc_u32 s63, s63, 0
    s_mov_b32 s12, s62
    s_and_b32 s13, s63, 0xffff
    s_mov_b32 s14, 0x30000
    s_mov_b32 s15, 0x00020000
    s_add_u32 s64, s64, s69
    s_addc_u32 s65, s65, 0
    s_mov_b32 s16, s64
    s_and_b32 s17, s65, 0xffff
    s_mov_b32 s18, 0x30000
    s_mov_b32 s19, 0x00020000
    s_add_u32 s45, s78, s25
    s_add_u32 s70, s52, 0x3c00000
    s_addc_u32 s71, s53, 0
    s_mov_b32 s88, s70
    s_and_b32 s89, s71, 0xffff
    s_mov_b32 s90, 0x10000
    s_mov_b32 s91, 0x00020000
    s_mov_b32 s92, s86
    s_and_b32 s93, s87, 0xffff
    s_mov_b32 s94, 0x100
    s_mov_b32 s95, 0x00020000
    s_cmp_lg_u32 s27, 0
    s_cbranch_scc1 L1_nz
    s_lshl_b32 s59, s2, 7
    v_lshlrev_b32 v19, 15, v1
    v_mov_b32 v20, 0
    s_mov_b64 exec, 3
    buffer_store_dword v20, v19, s[88:91], s59 offen sc1
    s_mov_b64 exec, -1
L1_nz:
    s_lshl_b32 s59, s56, 3
    s_add_u32 s59, s59, s58
    s_lshl_b32 s59, s59, 2
    s_add_u32 s59, s59, s24
    s_lshl_b32 s59, s59, 5
    s_add_u32 s59, s59, s57
    s_mul_i32 s59, s59, 12288
    s_add_u32 s70, s52, s59
    s_addc_u32 s71, s53, 0
    s_mov_b32 s20, s70
    s_and_b32 s21, s71, 0xffff
    s_mov_b32 s22, 0x3000
    s_mov_b32 s23, 0x00020000
    v_lshrrev_b32 v19, 5, v1
    v_and_b32 v20, 31, v1
    v_lshrrev_b32 v21, 1, v20
    v_and_b32 v21, 1, v21
    v_lshlrev_b32 v21, 2, v21
    v_bfe_u32 v22, v20, 2, 2
    v_or_b32 v21, v21, v22
    v_xor_b32 v21, v21, v19
    v_mul_u32_u24 v22, 384, v20
    v_xor_b32 v23, 0, v21
    v_lshl_add_u32 v5, v23, 4, v22
    v_xor_b32 v23, 2, v21
    v_lshl_add_u32 v6, v23, 4, v22
    v_xor_b32 v23, 4, v21
    v_lshl_add_u32 v7, v23, 4, v22
    v_xor_b32 v23, 6, v21
    v_lshl_add_u32 v8, v23, 4, v22
    v_bfe_u32 v21, v20, 1, 3
    v_xor_b32 v21, v21, v19
    v_lshlrev_b32 v22, 7, v20
    v_add_u32 v22, s30, v22
    v_xor_b32 v23, 0, v21
    v_lshl_add_u32 v178, v23, 4, v22
    v_xor_b32 v23, 2, v21
    v_lshl_add_u32 v179, v23, 4, v22
    v_xor_b32 v23, 4, v21
    v_lshl_add_u32 v180, v23, 4, v22
    v_xor_b32 v23, 6, v21
    v_lshl_add_u32 v181, v23, 4, v22
    v_bfe_u32 v20, v1, 2, 2
    v_lshl_add_u32 v21, v19, 2, v20
    v_mul_u32_u24 v21, 384, v21
    v_and_b32 v22, 1, v1
    v_lshl_add_u32 v21, v22, 3, v21
    v_bfe_u32 v22, v1, 3, 1
    v_lshlrev_b32 v22, 2, v22
    v_bfe_u32 v23, v1, 4, 1
    v_lshl_or_b32 v22, v23, 1, v22
    v_bfe_u32 v23, v1, 1, 1
    v_xor_b32 v23, v23, v19
    v_or_b32 v22, v22, v23
    v_xor_b32 v23, 0, v22
    v_lshl_add_u32 v9, v23, 4, v21
    v_xor_b32 v23, 2, v22
    v_lshl_add_u32 v10, v23, 4, v21
    v_xor_b32 v23, 4, v22
    v_lshl_add_u32 v11, v23, 4, v21
    v_xor_b32 v23, 6, v22
    v_lshl_add_u32 v12, v23, 4, v21
    v_lshl_add_u32 v21, v19, 3, v20
    v_mul_u32_u24 v21, 384, v21
    v_add_u32 v21, 73728, v21
    v_bfe_u32 v22, v1, 1, 1
    v_lshl_add_u32 v21, v22, 3, v21
    v_bfe_u32 v22, v1, 3, 1
    v_lshlrev_b32 v22, 2, v22
    v_bfe_u32 v23, v1, 4, 1
    v_xor_b32 v23, v23, v19
    v_lshl_or_b32 v22, v23, 1, v22
    v_and_b32 v23, 1, v1
    v_or_b32 v22, v22, v23
    v_xor_b32 v23, 0, v22
    v_lshl_add_u32 v174, v23, 4, v21
    v_xor_b32 v23, 1, v22
    v_lshl_add_u32 v175, v23, 4, v21
    v_xor_b32 v23, 4, v22
    v_lshl_add_u32 v176, v23, 4, v21
    v_xor_b32 v23, 5, v22
    v_lshl_add_u32 v177, v23, 4, v21
    v_mov_b32 v24, 0
    v_mov_b32 v25, 0
    v_mov_b32 v26, 0
    v_mov_b32 v27, 0
    v_mov_b32 v28, 0
    v_mov_b32 v29, 0
    v_mov_b32 v30, 0
    v_mov_b32 v31, 0
    v_mov_b32 v32, 0
    v_mov_b32 v33, 0
    v_mov_b32 v34, 0
    v_mov_b32 v35, 0
    v_mov_b32 v36, 0
    v_mov_b32 v37, 0
    v_mov_b32 v38, 0
    v_mov_b32 v39, 0
    v_mov_b32 v40, 0
    v_mov_b32 v41, 0
    v_mov_b32 v42, 0
    v_mov_b32 v43, 0
    v_mov_b32 v44, 0
    v_mov_b32 v45, 0
    v_mov_b32 v46, 0
    v_mov_b32 v47, 0
    v_mov_b32 v48, 0
    v_mov_b32 v49, 0
    v_mov_b32 v50, 0
    v_mov_b32 v51, 0
    v_mov_b32 v52, 0
    v_mov_b32 v53, 0
    v_mov_b32 v54, 0
    v_mov_b32 v55, 0
    v_mov_b32 v56, 0
    v_mov_b32 v57, 0
    v_mov_b32 v58, 0
    v_mov_b32 v59, 0
    v_mov_b32 v60, 0
    v_mov_b32 v61, 0
    v_mov_b32 v62, 0
    v_mov_b32 v63, 0
    v_mov_b32 v64, 0
    v_mov_b32 v65, 0
    v_mov_b32 v66, 0
    v_mov_b32 v67, 0
    v_mov_b32 v68, 0
    v_mov_b32 v69, 0
    v_mov_b32 v70, 0
    v_mov_b32 v71, 0
    v_mov_b32 v72, 0
    v_mov_b32 v73, 0
    v_mov_b32 v74, 0
    v_mov_b32 v75, 0
    v_mov_b32 v76, 0
    v_mov_b32 v77, 0
    v_mov_b32 v78, 0
    v_mov_b32 v79, 0
    v_mov_b32 v80, 0
    v_mov_b32 v81, 0
    v_mov_b32 v82, 0
    v_mov_b32 v83, 0
    v_mov_b32 v84, 0
    v_mov_b32 v85, 0
    v_mov_b32 v86, 0
    v_mov_b32 v87, 0
    v_mov_b32 v88, 0
    v_mov_b32 v89, 0
    v_mov_b32 v90, 0
    v_mov_b32 v91, 0
    v_mov_b32 v92, 0
    v_mov_b32 v93, 0
    v_mov_b32 v94, 0
    v_mov_b32 v95, 0
    v_mov_b32 v96, 0
    v_mov_b32 v97, 0
    v_mov_b32 v98, 0
    v_mov_b32 v99, 0
    v_mov_b32 v100, 0
    v_mov_b32 v101, 0
    v_mov_b32 v102, 0
    v_mov_b32 v103, 0
    v_mov_b32 v104, 0
    v_mov_b32 v105, 0
    v_mov_b32 v106, 0
    v_mov_b32 v107, 0
    v_mov_b32 v108, 0
    v_mov_b32 v109, 0
    v_mov_b32 v110, 0
    v_mov_b32 v111, 0
    v_mov_b32 v112, 0
    v_mov_b32 v113, 0
    v_mov_b32 v114, 0
    v_mov_b32 v115, 0
    v_mov_b32 v116, 0
    v_mov_b32 v117, 0
    v_mov_b32 v118, 0
    v_mov_b32 v119, 0
    s_cmp_eq_u32 s54, 0
    s_cbranch_scc1 L1_q0
    s_waitcnt vmcnt(3) lgkmcnt(0)
    s_barrier
    s_add_u32 m0, s26, 24576
    s_nop 0
    buffer_load_dwordx4 v168, s[8:11], s28 offen lds
    s_add_u32 m0, s26, 25600
    s_nop 0
    buffer_load_dwordx4 v169, s[8:11], s28 offen lds
    s_add_u32 m0, s26, 26624
    s_nop 0
    buffer_load_dwordx4 v182, s[8:11], s28 offen lds
    s_add_u32 s28, s28, 393216
    s_cmp_eq_u32 s28, 7864320
    s_cselect_b32 s28, 0, s28
    s_add_u32 m0, s26, 36864
    s_nop 0
    buffer_load_dwordx4 v168, s[8:11], s28 offen lds
    s_add_u32 m0, s26, 37888
    s_nop 0
    buffer_load_dwordx4 v169, s[8:11], s28 offen lds
    s_add_u32 m0, s26, 38912
    s_nop 0
    buffer_load_dwordx4 v182, s[8:11], s28 offen lds
    s_add_u32 s28, s28, 393216
    s_cmp_eq_u32 s28, 7864320
    s_cselect_b32 s28, 0, s28
    s_waitcnt vmcnt(6) lgkmcnt(0)
    s_barrier
    s_add_u32 m0, s26, 0
    s_nop 0
    buffer_load_dwordx4 v168, s[8:11], s28 offen lds
    s_add_u32 m0, s26, 1024
    s_nop 0
    buffer_load_dwordx4 v169, s[8:11], s28 offen lds
    s_add_u32 m0, s26, 2048
    s_nop 0
    buffer_load_dwordx4 v182, s[8:11], s28 offen lds
    s_add_u32 s28, s28, 393216
    s_cmp_eq_u32 s28, 7864320
    s_cselect_b32 s28, 0, s28
    s_waitcnt vmcnt(6) lgkmcnt(0)
    s_barrier
    s_add_u32 m0, s26, 12288
    s_nop 0
    buffer_load_dwordx4 v168, s[8:11], s28 offen lds
    s_add_u32 m0, s26, 13312
    s_nop 0
    buffer_load_dwordx4 v169, s[8:11], s28 offen lds
    s_add_u32 m0, s26, 14336
    s_nop 0
    buffer_load_dwordx4 v182, s[8:11], s28 offen lds
    s_add_u32 s28, s28, 393216
    s_cmp_eq_u32 s28, 7864320
    s_cselect_b32 s28, 0, s28
    s_waitcnt vmcnt(6) lgkmcnt(0)
    s_barrier
    s_add_u32 m0, s26, 24576
    s_nop 0
    buffer_load_dwordx4 v168, s[8:11], s28 offen lds
    s_add_u32 m0, s26, 25600
    s_nop 0
    buffer_load_dwordx4 v169, s[8:11], s28 offen lds
    s_add_u32 m0, s26, 26624
    s_nop 0
    buffer_load_dwordx4 v182, s[8:11], s28 offen lds
    s_add_u32 s28, s28, 393216
    s_cmp_eq_u32 s28, 7864320
    s_cselect_b32 s28, 0, s28
    s_waitcnt vmcnt(6) lgkmcnt(0)
    s_barrier
    s_add_u32 m0, s26, 36864
    s_nop 0
    buffer_load_dwordx4 v168, s[8:11], s28 offen lds
    s_add_u32 m0, s26, 37888
    s_nop 0
    buffer_load_dwordx4 v169, s[8:11], s28 offen lds
    s_add_u32 m0, s26, 38912
    s_nop 0
    buffer_load_dwordx4 v182, s[8:11], s28 offen lds
    s_add_u32 s28, s28, 393216
    s_cmp_eq_u32 s28, 7864320
    s_cselect_b32 s28, 0, s28
    s_add_u32 m0, s30, 0
    s_nop 0
    buffer_load_dwordx4 v170, s[4:7], s29 offen lds
    s_add_u32 m0, s30, 1024
    s_nop 0
    buffer_load_dwordx4 v171, s[4:7], s29 offen lds
    s_add_u32 m0, s30, 2048
    s_nop 0
    buffer_load_dwordx4 v172, s[4:7], s29 offen lds
    s_add_u32 m0, s30, 3072
    s_nop 0
    buffer_load_dwordx4 v173, s[4:7], s29 offen lds
    s_add_u32 s29, s29, 128
    s_cmp_eq_u32 s29, 1280
    s_cselect_b32 s29, 0, s29
    s_add_u32 m0, s30, 16384
    s_nop 0
    buffer_load_dwordx4 v170, s[4:7], s29 offen lds
    s_add_u32 m0, s30, 17408
    s_nop 0
    buffer_load_dwordx4 v171, s[4:7], s29 offen lds
    s_add_u32 m0, s30, 18432
    s_nop 0
    buffer_load_dwordx4 v172, s[4:7], s29 offen lds
    s_add_u32 m0, s30, 19456
    s_nop 0
    buffer_load_dwordx4 v173, s[4:7], s29 offen lds
    s_add_u32 s29, s29, 128
    s_cmp_eq_u32 s29, 1280
    s_cselect_b32 s29, 0, s29
    s_waitcnt vmcnt(14) lgkmcnt(0)
    s_barrier
    s_add_u32 m0, s26, 0
    s_nop 0
    buffer_load_dwordx4 v168, s[8:11], s28 offen lds
    s_add_u32 m0, s26, 1024
    s_nop 0
    buffer_load_dwordx4 v169, s[8:11], s28 offen lds
    s_add_u32 m0, s26, 2048
    s_nop 0
    buffer_load_dwordx4 v182, s[8:11], s28 offen lds
    s_add_u32 s28, s28, 393216
    s_cmp_eq_u32 s28, 7864320
    s_cselect_b32 s28, 0, s28
    s_waitcnt vmcnt(14) lgkmcnt(0)
    s_barrier
    s_add_u32 m0, s26, 12288
    s_nop 0
    buffer_load_dwordx4 v168, s[8:11], s28 offen lds
    s_add_u32 m0, s26, 13312
    s_nop 0
    buffer_load_dwordx4 v169, s[8:11], s28 offen lds
    s_add_u32 m0, s26, 14336
    s_nop 0
    buffer_load_dwordx4 v182, s[8:11], s28 offen lds
    s_add_u32 s28, s28, 393216
    s_cmp_eq_u32 s28, 7864320
    s_cselect_b32 s28, 0, s28
    s_waitcnt vmcnt(14) lgkmcnt(0)
    s_barrier
    s_add_u32 m0, s26, 24576
    s_nop 0
    buffer_load_dwordx4 v168, s[8:11], s28 offen lds
    s_add_u32 m0, s26, 25600
    s_nop 0
    buffer_load_dwordx4 v169, s[8:11], s28 offen lds
    s_add_u32 m0, s26, 26624
    s_nop 0
    buffer_load_dwordx4 v182, s[8:11], s28 offen lds
    s_add_u32 s28, s28, 393216
    s_cmp_eq_u32 s28, 7864320
    s_cselect_b32 s28, 0, s28
    s_waitcnt vmcnt(6) lgkmcnt(0)
    s_barrier
    s_add_u32 m0, s26, 36864
    s_nop 0
    buffer_load_dwordx4 v168, s[8:11], s28 offen lds
    s_add_u32 m0, s26, 37888
    s_nop 0
    buffer_load_dwordx4 v169, s[8:11], s28 offen lds
    s_add_u32 m0, s26, 38912
    s_nop 0
    buffer_load_dwordx4 v182, s[8:11], s28 offen lds
    s_add_u32 s28, s28, 393216
    s_cmp_eq_u32 s28, 7864320
    s_cselect_b32 s28, 0, s28
    ds_read_b128 v[120:123], v178 offset:0
    ds_read_b128 v[124:127], v179 offset:0
    ds_read_b128 v[128:131], v180 offset:0
    ds_read_b128 v[132:135], v181 offset:0
    ds_read_b64_tr_b16 v[200:201], v174 offset:0
    ds_read_b64_tr_b16 v[202:203], v175 offset:1536
    ds_read_b64_tr_b16 v[204:205], v176 offset:0
    ds_read_b64_tr_b16 v[206:207], v177 offset:1536
    ds_read_b64_tr_b16 v[208:209], v174 offset:128
    ds_read_b64_tr_b16 v[210:211], v175 offset:1664
    ds_read_b64_tr_b16 v[212:213], v176 offset:128
    ds_read_b64_tr_b16 v[214:215], v177 offset:1664
    ds_read_b64_tr_b16 v[216:217], v174 offset:256
    ds_read_b64_tr_b16 v[218:219], v175 offset:1792
    ds_read_b64_tr_b16 v[220:221], v176 offset:256
    ds_read_b64_tr_b16 v[222:223], v177 offset:1792
    s_waitcnt lgkmcnt(10)
    v_mfma_f32_32x32x16_bf16 v[24:39], v[200:203], v[120:123], v[24:39]
    ds_read_b64_tr_b16 v[224:225], v174 offset:6144
    ds_read_b64_tr_b16 v[226:227], v175 offset:7680
    ds_read_b64_tr_b16 v[228:229], v176 offset:6144
    s_add_u32 m0, s30, 0
    s_nop 0
    buffer_load_dwordx4 v170, s[4:7], s29 offen lds
    s_waitcnt lgkmcnt(11)
    v_mfma_f32_32x32x16_bf16 v[40:55], v[204:207], v[120:123], v[40:55]
    ds_read_b64_tr_b16 v[230:231], v177 offset:7680
    ds_read_b64_tr_b16 v[232:233], v174 offset:6272
    ds_read_b64_tr_b16 v[234:235], v175 offset:7808
    s_add_u32 m0, s30, 1024
    s_nop 0
    buffer_load_dwordx4 v171, s[4:7], s29 offen lds
    s_waitcnt lgkmcnt(12)
    v_mfma_f32_32x32x16_bf16 v[56:71], v[208:211], v[120:123], v[56:71]
    ds_read_b64_tr_b16 v[236:237], v176 offset:6272
    ds_read_b64_tr_b16 v[238:239], v177 offset:7808
    ds_read_b64_tr_b16 v[240:241], v174 offset:6400
    s_add_u32 m0, s30, 2048
    s_nop 0
    buffer_load_dwordx4 v172, s[4:7], s29 offen lds
    s_waitcnt lgkmcnt(13)
    v_mfma_f32_32x32x16_bf16 v[72:87], v[212:215], v[120:123], v[72:87]
    ds_read_b64_tr_b16 v[242:243], v175 offset:7936
    ds_read_b64_tr_b16 v[244:245], v176 offset:6400
    ds_read_b64_tr_b16 v[246:247], v177 offset:7936
    s_add_u32 m0, s30, 3072
    s_nop 0
    buffer_load_dwordx4 v173, s[4:7], s29 offen lds
    s_add_u32 s29, s29, 128
    s_cmp_eq_u32 s29, 1280
    s_cselect_b32 s29, 0, s29
    s_waitcnt lgkmcnt(14)
    v_mfma_f32_32x32x16_bf16 v[88:103], v[216:219], v[120:123], v[88:103]
    s_waitcnt lgkmcnt(12)
    v_mfma_f32_32x32x16_bf16 v[104:119], v[220:223], v[120:123], v[104:119]
    s_waitcnt vmcnt(10) lgkmcnt(0)
    s_barrier
    v_mfma_f32_32x32x16_bf16 v[24:39], v[224:227], v[124:127], v[24:39]
    ds_read_b64_tr_b16 v[200:201], v174 offset:12288
    ds_read_b64_tr_b16 v[202:203], v175 offset:13824
    ds_read_b64_tr_b16 v[204:205], v176 offset:12288
    s_add_u32 m0, s26, 0
    s_nop 0
    buffer_load_dwordx4 v168, s[8:11], s28 offen lds
    v_mfma_f32_32x32x16_bf16 v[40:55], v[228:231], v[124:127], v[40:55]
    ds_read_b64_tr_b16 v[206:207], v177 offset:13824
    ds_read_b64_tr_b16 v[208:209], v174 offset:12416
    ds_read_b64_tr_b16 v[210:211], v175 offset:13952
    v_mfma_f32_32x32x16_bf16 v[56:71], v[232:235], v[124:127], v[56:71]
    ds_read_b64_tr_b16 v[212:213], v176 offset:12416
    ds_read_b64_tr_b16 v[214:215], v177 offset:13952
    ds_read_b64_tr_b16 v[216:217], v174 offset:12544
    s_add_u32 m0, s26, 1024
    s_nop 0
    buffer_load_dwordx4 v169, s[8:11], s28 offen lds
    v_mfma_f32_32x32x16_bf16 v[72:87], v[236:239], v[124:127], v[72:87]
    ds_read_b64_tr_b16 v[218:219], v175 offset:14080
    ds_read_b64_tr_b16 v[220:221], v176 offset:12544
    ds_read_b64_tr_b16 v[222:223], v177 offset:14080
    v_mfma_f32_32x32x16_bf16 v[88:103], v[240:243], v[124:127], v[88:103]
    s_add_u32 m0, s26, 2048
    s_nop 0
    buffer_load_dwordx4 v182, s[8:11], s28 offen lds
    s_add_u32 s28, s28, 393216
    s_cmp_eq_u32 s28, 7864320
    s_cselect_b32 s28, 0, s28
    v_mfma_f32_32x32x16_bf16 v[104:119], v[244:247], v[124:127], v[104:119]
    s_waitcnt lgkmcnt(10)
    v_mfma_f32_32x32x16_bf16 v[24:39], v[200:203], v[128:131], v[24:39]
    ds_read_b64_tr_b16 v[224:225], v174 offset:18432
    ds_read_b64_tr_b16 v[226:227], v175 offset:19968
    ds_read_b64_tr_b16 v[228:229], v176 offset:18432
    s_waitcnt lgkmcnt(11)
    v_mfma_f32_32x32x16_bf16 v[40:55], v[204:207], v[128:131], v[40:55]
    ds_read_b64_tr_b16 v[230:231], v177 offset:19968
    ds_read_b64_tr_b16 v[232:233], v174 offset:18560
    ds_read_b64_tr_b16 v[234:235], v175 offset:20096
    s_waitcnt lgkmcnt(12)
    v_mfma_f32_32x32x16_bf16 v[56:71], v[208:211], v[128:131], v[56:71]
    ds_read_b64_tr_b16 v[236:237], v176 offset:18560
    ds_read_b64_tr_b16 v[238:239], v177 offset:20096
    ds_read_b64_tr_b16 v[240:241], v174 offset:18688
    s_waitcnt lgkmcnt(13)
    v_mfma_f32_32x32x16_bf16 v[72:87], v[212:215], v[128:131], v[72:87]
    ds_read_b64_tr_b16 v[242:243], v175 offset:20224
    ds_read_b64_tr_b16 v[244:245], v176 offset:18688
    ds_read_b64_tr_b16 v[246:247], v177 offset:20224
    s_waitcnt lgkmcnt(14)
    v_mfma_f32_32x32x16_bf16 v[88:103], v[216:219], v[128:131], v[88:103]
    s_waitcnt lgkmcnt(12)
    v_mfma_f32_32x32x16_bf16 v[104:119], v[220:223], v[128:131], v[104:119]
    s_waitcnt vmcnt(10) lgkmcnt(0)
    s_barrier
    v_mfma_f32_32x32x16_bf16 v[24:39], v[224:227], v[132:135], v[24:39]
    ds_read_b128 v[136:139], v178 offset:16384
    ds_read_b128 v[140:143], v179 offset:16384
    ds_read_b128 v[144:147], v180 offset:16384
    ds_read_b128 v[148:151], v181 offset:16384
    s_add_u32 m0, s26, 12288
    s_nop 0
    buffer_load_dwordx4 v168, s[8:11], s28 offen lds
    v_mfma_f32_32x32x16_bf16 v[40:55], v[228:231], v[132:135], v[40:55]
    ds_read_b64_tr_b16 v[200:201], v174 offset:24576
    ds_read_b64_tr_b16 v[202:203], v175 offset:26112
    ds_read_b64_tr_b16 v[204:205], v176 offset:24576
    v_mfma_f32_32x32x16_bf16 v[56:71], v[232:235], v[132:135], v[56:71]
    ds_read_b64_tr_b16 v[206:207], v177 offset:26112
    ds_read_b64_tr_b16 v[208:209], v174 offset:24704
    ds_read_b64_tr_b16 v[210:211], v175 offset:26240
    s_add_u32 m0, s26, 13312
    s_nop 0
    buffer_load_dwordx4 v169, s[8:11], s28 offen lds
    v_mfma_f32_32x32x16_bf16 v[72:87], v[236:239], v[132:135], v[72:87]
    ds_read_b64_tr_b16 v[212:213], v176 offset:24704
    ds_read_b64_tr_b16 v[214:215], v177 offset:26240
    ds_read_b64_tr_b16 v[216:217], v174 offset:24832
    v_mfma_f32_32x32x16_bf16 v[88:103], v[240:243], v[132:135], v[88:103]
    ds_read_b64_tr_b16 v[218:219], v175 offset:26368
    ds_read_b64_tr_b16 v[220:221], v176 offset:24832
    ds_read_b64_tr_b16 v[222:223], v177 offset:26368
    s_add_u32 m0, s26, 14336
    s_nop 0
    buffer_load_dwordx4 v182, s[8:11], s28 offen lds
    s_add_u32 s28, s28, 393216
    s_cmp_eq_u32 s28, 7864320
    s_cselect_b32 s28, 0, s28
    v_mfma_f32_32x32x16_bf16 v[104:119], v[244:247], v[132:135], v[104:119]
    s_waitcnt lgkmcnt(10)
    v_mfma_f32_32x32x16_bf16 v[24:39], v[200:203], v[136:139], v[24:39]
    ds_read_b64_tr_b16 v[224:225], v174 offset:30720
    ds_read_b64_tr_b16 v[226:227], v175 offset:32256
    ds_read_b64_tr_b16 v[228:229], v176 offset:30720
    s_add_u32 m0, s30, 16384
    s_nop 0
    buffer_load_dwordx4 v170, s[4:7], s29 offen lds
    s_waitcnt lgkmcnt(11)
    v_mfma_f32_32x32x16_bf16 v[40:55], v[204:207], v[136:139], v[40:55]
    ds_read_b64_tr_b16 v[230:231], v177 offset:32256
    ds_read_b64_tr_b16 v[232:233], v174 offset:30848
    ds_read_b64_tr_b16 v[234:235], v175 offset:32384
    s_add_u32 m0, s30, 17408
    s_nop 0
    buffer_load_dwordx4 v171, s[4:7], s29 offen lds
    s_waitcnt lgkmcnt(12)
    v_mfma_f32_32x32x16_bf16 v[56:71], v[208:211], v[136:139], v[56:71]
    ds_read_b64_tr_b16 v[236:237], v176 offset:30848
    ds_read_b64_tr_b16 v[238:239], v177 offset:32384
    ds_read_b64_tr_b16 v[240:241], v174 offset:30976
    s_add_u32 m0, s30, 18432
    s_nop 0
    buffer_load_dwordx4 v172, s[4:7], s29 offen lds
    s_waitcnt lgkmcnt(13)
    v_mfma_f32_32x32x16_bf16 v[72:87], v[212:215], v[136:139], v[72:87]
    ds_read_b64_tr_b16 v[242:243], v175 offset:32512
    ds_read_b64_tr_b16 v[244:245], v176 offset:30976
    ds_read_b64_tr_b16 v[246:247], v177 offset:32512
    s_add_u32 m0, s30, 19456
    s_nop 0
    buffer_load_dwordx4 v173, s[4:7], s29 offen lds
    s_add_u32 s29, s29, 128
    s_cmp_eq_u32 s29, 1280
    s_cselect_b32 s29, 0, s29
    s_waitcnt lgkmcnt(14)
    v_mfma_f32_32x32x16_bf16 v[88:103], v[216:219], v[136:139], v[88:103]
    s_waitcnt lgkmcnt(12)
    v_mfma_f32_32x32x16_bf16 v[104:119], v[220:223], v[136:139], v[104:119]
    s_waitcnt vmcnt(14) lgkmcnt(0)
    s_barrier
    v_mfma_f32_32x32x16_bf16 v[24:39], v[224:227], v[140:143], v[24:39]
    ds_read_b64_tr_b16 v[200:201], v174 offset:36864
    ds_read_b64_tr_b16 v[202:203], v175 offset:38400
    ds_read_b64_tr_b16 v[204:205], v176 offset:36864
    s_add_u32 m0, s26, 24576
    s_nop 0
    buffer_load_dwordx4 v168, s[8:11], s28 offen lds
    v_mfma_f32_32x32x16_bf16 v[40:55], v[228:231], v[140:143], v[40:55]
    ds_read_b64_tr_b16 v[206:207], v177 offset:38400
    ds_read_b64_tr_b16 v[208:209], v174 offset:36992
    ds_read_b64_tr_b16 v[210:211], v175 offset:38528
    v_mfma_f32_32x32x16_bf16 v[56:71], v[232:235], v[140:143], v[56:71]
    ds_read_b64_tr_b16 v[212:213], v176 offset:36992
    ds_read_b64_tr_b16 v[214:215], v177 offset:38528
    ds_read_b64_tr_b16 v[216:217], v174 offset:37120
    s_add_u32 m0, s26, 25600
    s_nop 0
    buffer_load_dwordx4 v169, s[8:11], s28 offen lds
    v_mfma_f32_32x32x16_bf16 v[72:87], v[236:239], v[140:143], v[72:87]
    ds_read_b64_tr_b16 v[218:219], v175 offset:38656
    ds_read_b64_tr_b16 v[220:221], v176 offset:37120
    ds_read_b64_tr_b16 v[222:223], v177 offset:38656
    v_mfma_f32_32x32x16_bf16 v[88:103], v[240:243], v[140:143], v[88:103]
    s_add_u32 m0, s26, 26624
    s_nop 0
    buffer_load_dwordx4 v182, s[8:11], s28 offen lds
    s_add_u32 s28, s28, 393216
    s_cmp_eq_u32 s28, 7864320
    s_cselect_b32 s28, 0, s28
    v_mfma_f32_32x32x16_bf16 v[104:119], v[244:247], v[140:143], v[104:119]
    s_waitcnt lgkmcnt(10)
    v_mfma_f32_32x32x16_bf16 v[24:39], v[200:203], v[144:147], v[24:39]
    ds_read_b64_tr_b16 v[224:225], v174 offset:43008
    ds_read_b64_tr_b16 v[226:227], v175 offset:44544
    ds_read_b64_tr_b16 v[228:229], v176 offset:43008
    s_waitcnt lgkmcnt(11)
    v_mfma_f32_32x32x16_bf16 v[40:55], v[204:207], v[144:147], v[40:55]
    ds_read_b64_tr_b16 v[230:231], v177 offset:44544
    ds_read_b64_tr_b16 v[232:233], v174 offset:43136
    ds_read_b64_tr_b16 v[234:235], v175 offset:44672
    s_waitcnt lgkmcnt(12)
    v_mfma_f32_32x32x16_bf16 v[56:71], v[208:211], v[144:147], v[56:71]
    ds_read_b64_tr_b16 v[236:237], v176 offset:43136
    ds_read_b64_tr_b16 v[238:239], v177 offset:44672
    ds_read_b64_tr_b16 v[240:241], v174 offset:43264
    s_waitcnt lgkmcnt(13)
    v_mfma_f32_32x32x16_bf16 v[72:87], v[212:215], v[144:147], v[72:87]
    ds_read_b64_tr_b16 v[242:243], v175 offset:44800
    ds_read_b64_tr_b16 v[244:245], v176 offset:43264
    ds_read_b64_tr_b16 v[246:247], v177 offset:44800
    s_waitcnt lgkmcnt(14)
    v_mfma_f32_32x32x16_bf16 v[88:103], v[216:219], v[144:147], v[88:103]
    s_waitcnt lgkmcnt(12)
    v_mfma_f32_32x32x16_bf16 v[104:119], v[220:223], v[144:147], v[104:119]
    s_waitcnt vmcnt(10) lgkmcnt(0)
    s_barrier
    v_mfma_f32_32x32x16_bf16 v[24:39], v[224:227], v[148:151], v[24:39]
    ds_read_b128 v[120:123], v178 offset:0
    ds_read_b128 v[124:127], v179 offset:0
    ds_read_b128 v[128:131], v180 offset:0
    ds_read_b128 v[132:135], v181 offset:0
    s_add_u32 m0, s26, 36864
    s_nop 0
    buffer_load_dwordx4 v168, s[8:11], s28 offen lds
    v_mfma_f32_32x32x16_bf16 v[40:55], v[228:231], v[148:151], v[40:55]
    ds_read_b64_tr_b16 v[200:201], v174 offset:0
    ds_read_b64_tr_b16 v[202:203], v175 offset:1536
    ds_read_b64_tr_b16 v[204:205], v176 offset:0
    v_mfma_f32_32x32x16_bf16 v[56:71], v[232:235], v[148:151], v[56:71]
    ds_read_b64_tr_b16 v[206:207], v177 offset:1536
    ds_read_b64_tr_b16 v[208:209], v174 offset:128
    ds_read_b64_tr_b16 v[210:211], v175 offset:1664
    s_add_u32 m0, s26, 37888
    s_nop 0
    buffer_load_dwordx4 v169, s[8:11], s28 offen lds
    v_mfma_f32_32x32x16_bf16 v[72:87], v[236:239], v[148:151], v[72:87]
    ds_read_b64_tr_b16 v[212:213], v176 offset:128
    ds_read_b64_tr_b16 v[214:215], v177 offset:1664
    ds_read_b64_tr_b16 v[216:217], v174 offset:256
    v_mfma_f32_32x32x16_bf16 v[88:103], v[240:243], v[148:151], v[88:103]
    ds_read_b64_tr_b16 v[218:219], v175 offset:1792
    ds_read_b64_tr_b16 v[220:221], v176 offset:256
    ds_read_b64_tr_b16 v[222:223], v177 offset:1792
    s_add_u32 m0, s26, 38912
    s_nop 0
    buffer_load_dwordx4 v182, s[8:11], s28 offen lds
    s_add_u32 s28, s28, 393216
    s_cmp_eq_u32 s28, 7864320
    s_cselect_b32 s28, 0, s28
    v_mfma_f32_32x32x16_bf16 v[104:119], v[244:247], v[148:151], v[104:119]
    s_waitcnt lgkmcnt(10)
    v_mfma_f32_32x32x16_bf16 v[24:39], v[200:203], v[120:123], v[24:39]
    ds_read_b64_tr_b16 v[224:225], v174 offset:6144
    ds_read_b64_tr_b16 v[226:227], v175 offset:7680
    ds_read_b64_tr_b16 v[228:229], v176 offset:6144
    s_add_u32 m0, s30, 0
    s_nop 0
    buffer_load_dwordx4 v170, s[4:7], s29 offen lds
    s_waitcnt lgkmcnt(11)
    v_mfma_f32_32x32x16_bf16 v[40:55], v[204:207], v[120:123], v[40:55]
    ds_read_b64_tr_b16 v[230:231], v177 offset:7680
    ds_read_b64_tr_b16 v[232:233], v174 offset:6272
    ds_read_b64_tr_b16 v[234:235], v175 offset:7808
    s_add_u32 m0, s30, 1024
    s_nop 0
    buffer_load_dwordx4 v171, s[4:7], s29 offen lds
    s_waitcnt lgkmcnt(12)
    v_mfma_f32_32x32x16_bf16 v[56:71], v[208:211], v[120:123], v[56:71]
    ds_read_b64_tr_b16 v[236:237], v176 offset:6272
    ds_read_b64_tr_b16 v[238:239], v177 offset:7808
    ds_read_b64_tr_b16 v[240:241], v174 offset:6400
    s_add_u32 m0, s30, 2048
    s_nop 0
    buffer_load_dwordx4 v172, s[4:7], s29 offen lds
    s_waitcnt lgkmcnt(13)
    v_mfma_f32_32x32x16_bf16 v[72:87], v[212:215], v[120:123], v[72:87]
    ds_read_b64_tr_b16 v[242:243], v175 offset:7936
    ds_read_b64_tr_b16 v[244:245], v176 offset:6400
    ds_read_b64_tr_b16 v[246:247], v177 offset:7936
    s_add_u32 m0, s30, 3072
    s_nop 0
    buffer_load_dwordx4 v173, s[4:7], s29 offen lds
    s_add_u32 s29, s29, 128
    s_cmp_eq_u32 s29, 1280
    s_cselect_b32 s29, 0, s29
    s_waitcnt lgkmcnt(14)
    v_mfma_f32_32x32x16_bf16 v[88:103], v[216:219], v[120:123], v[88:103]
    s_waitcnt lgkmcnt(12)
    v_mfma_f32_32x32x16_bf16 v[104:119], v[220:223], v[120:123], v[104:119]
    s_waitcnt vmcnt(14) lgkmcnt(0)
    s_barrier
    v_mfma_f32_32x32x16_bf16 v[24:39], v[224:227], v[124:127], v[24:39]
    ds_read_b64_tr_b16 v[200:201], v174 offset:12288
    ds_read_b64_tr_b16 v[202:203], v175 offset:13824
    ds_read_b64_tr_b16 v[204:205], v176 offset:12288
    s_add_u32 m0, s26, 0
    s_nop 0
    buffer_load_dwordx4 v168, s[8:11], s28 offen lds
    v_mfma_f32_32x32x16_bf16 v[40:55], v[228:231], v[124:127], v[40:55]
    ds_read_b64_tr_b16 v[206:207], v177 offset:13824
    ds_read_b64_tr_b16 v[208:209], v174 offset:12416
    ds_read_b64_tr_b16 v[210:211], v175 offset:13952
    v_mfma_f32_32x32x16_bf16 v[56:71], v[232:235], v[124:127], v[56:71]
    ds_read_b64_tr_b16 v[212:213], v176 offset:12416
    ds_read_b64_tr_b16 v[214:215], v177 offset:13952
    ds_read_b64_tr_b16 v[216:217], v174 offset:12544
    s_add_u32 m0, s26, 1024
    s_nop 0
    buffer_load_dwordx4 v169, s[8:11], s28 offen lds
    v_mfma_f32_32x32x16_bf16 v[72:87], v[236:239], v[124:127], v[72:87]
    ds_read_b64_tr_b16 v[218:219], v175 offset:14080
    ds_read_b64_tr_b16 v[220:221], v176 offset:12544
    ds_read_b64_tr_b16 v[222:223], v177 offset:14080
    v_mfma_f32_32x32x16_bf16 v[88:103], v[240:243], v[124:127], v[88:103]
    s_add_u32 m0, s26, 2048
    s_nop 0
    buffer_load_dwordx4 v182, s[8:11], s28 offen lds
    s_add_u32 s28, s28, 393216
    s_cmp_eq_u32 s28, 7864320
    s_cselect_b32 s28, 0, s28
    v_mfma_f32_32x32x16_bf16 v[104:119], v[244:247], v[124:127], v[104:119]
    s_waitcnt lgkmcnt(10)
    v_mfma_f32_32x32x16_bf16 v[24:39], v[200:203], v[128:131], v[24:39]
    ds_read_b64_tr_b16 v[224:225], v174 offset:18432
    ds_read_b64_tr_b16 v[226:227], v175 offset:19968
    ds_read_b64_tr_b16 v[228:229], v176 offset:18432
    s_waitcnt lgkmcnt(11)
    v_mfma_f32_32x32x16_bf16 v[40:55], v[204:207], v[128:131], v[40:55]
    ds_read_b64_tr_b16 v[230:231], v177 offset:19968
    ds_read_b64_tr_b16 v[232:233], v174 offset:18560
    ds_read_b64_tr_b16 v[234:235], v175 offset:20096
    s_waitcnt lgkmcnt(12)
    v_mfma_f32_32x32x16_bf16 v[56:71], v[208:211], v[128:131], v[56:71]
    ds_read_b64_tr_b16 v[236:237], v176 offset:18560
    ds_read_b64_tr_b16 v[238:239], v177 offset:20096
    ds_read_b64_tr_b16 v[240:241], v174 offset:18688
    s_waitcnt lgkmcnt(13)
    v_mfma_f32_32x32x16_bf16 v[72:87], v[212:215], v[128:131], v[72:87]
    ds_read_b64_tr_b16 v[242:243], v175 offset:20224
    ds_read_b64_tr_b16 v[244:245], v176 offset:18688
    ds_read_b64_tr_b16 v[246:247], v177 offset:20224
    s_waitcnt lgkmcnt(14)
    v_mfma_f32_32x32x16_bf16 v[88:103], v[216:219], v[128:131], v[88:103]
    s_waitcnt lgkmcnt(12)
    v_mfma_f32_32x32x16_bf16 v[104:119], v[220:223], v[128:131], v[104:119]
    s_waitcnt vmcnt(10) lgkmcnt(0)
    s_barrier
    v_mfma_f32_32x32x16_bf16 v[24:39], v[224:227], v[132:135], v[24:39]
    ds_read_b128 v[136:139], v178 offset:16384
    ds_read_b128 v[140:143], v179 offset:16384
    ds_read_b128 v[144:147], v180 offset:16384
    ds_read_b128 v[148:151], v181 offset:16384
    s_add_u32 m0, s26, 12288
    s_nop 0
    buffer_load_dwordx4 v168, s[8:11], s28 offen lds
    v_mfma_f32_32x32x16_bf16 v[40:55], v[228:231], v[132:135], v[40:55]
    ds_read_b64_tr_b16 v[200:201], v174 offset:24576
    ds_read_b64_tr_b16 v[202:203], v175 offset:26112
    ds_read_b64_tr_b16 v[204:205], v176 offset:24576
    v_mfma_f32_32x32x16_bf16 v[56:71], v[232:235], v[132:135], v[56:71]
    ds_read_b64_tr_b16 v[206:207], v177 offset:26112
    ds_read_b64_tr_b16 v[208:209], v174 offset:24704
    ds_read_b64_tr_b16 v[210:211], v175 offset:26240
    s_add_u32 m0, s26, 13312
    s_nop 0
    buffer_load_dwordx4 v169, s[8:11], s28 offen lds
    v_mfma_f32_32x32x16_bf16 v[72:87], v[236:239], v[132:135], v[72:87]
    ds_read_b64_tr_b16 v[212:213], v176 offset:24704
    ds_read_b64_tr_b16 v[214:215], v177 offset:26240
    ds_read_b64_tr_b16 v[216:217], v174 offset:24832
    v_mfma_f32_32x32x16_bf16 v[88:103], v[240:243], v[132:135], v[88:103]
    ds_read_b64_tr_b16 v[218:219], v175 offset:26368
    ds_read_b64_tr_b16 v[220:221], v176 offset:24832
    ds_read_b64_tr_b16 v[222:223], v177 offset:26368
    s_add_u32 m0, s26, 14336
    s_nop 0
    buffer_load_dwordx4 v182, s[8:11], s28 offen lds
    s_add_u32 s28, s28, 393216
    s_cmp_eq_u32 s28, 7864320
    s_cselect_b32 s28, 0, s28
    v_mfma_f32_32x32x16_bf16 v[104:119], v[244:247], v[132:135], v[104:119]
    s_waitcnt lgkmcnt(10)
    v_mfma_f32_32x32x16_bf16 v[24:39], v[200:203], v[136:139], v[24:39]
    ds_read_b64_tr_b16 v[224:225], v174 offset:30720
    ds_read_b64_tr_b16 v[226:227], v175 offset:32256
    ds_read_b64_tr_b16 v[228:229], v176 offset:30720
    s_add_u32 m0, s30, 16384
    s_nop 0
    buffer_load_dwordx4 v170, s[4:7], s29 offen lds
    s_waitcnt lgkmcnt(11)
    v_mfma_f32_32x32x16_bf16 v[40:55], v[204:207], v[136:139], v[40:55]
    ds_read_b64_tr_b16 v[230:231], v177 offset:32256
    ds_read_b64_tr_b16 v[232:233], v174 offset:30848
    ds_read_b64_tr_b16 v[234:235], v175 offset:32384
    s_add_u32 m0, s30, 17408
    s_nop 0
    buffer_load_dwordx4 v171, s[4:7], s29 offen lds
    s_waitcnt lgkmcnt(12)
    v_mfma_f32_32x32x16_bf16 v[56:71], v[208:211], v[136:139], v[56:71]
    ds_read_b64_tr_b16 v[236:237], v176 offset:30848
    ds_read_b64_tr_b16 v[238:239], v177 offset:32384
    ds_read_b64_tr_b16 v[240:241], v174 offset:30976
    s_add_u32 m0, s30, 18432
    s_nop 0
    buffer_load_dwordx4 v172, s[4:7], s29 offen lds
    s_waitcnt lgkmcnt(13)
    v_mfma_f32_32x32x16_bf16 v[72:87], v[212:215], v[136:139], v[72:87]
    ds_read_b64_tr_b16 v[242:243], v175 offset:32512
    ds_read_b64_tr_b16 v[244:245], v176 offset:30976
    ds_read_b64_tr_b16 v[246:247], v177 offset:32512
    s_add_u32 m0, s30, 19456
    s_nop 0
    buffer_load_dwordx4 v173, s[4:7], s29 offen lds
    s_add_u32 s29, s29, 128
    s_cmp_eq_u32 s29, 1280
    s_cselect_b32 s29, 0, s29
    s_waitcnt lgkmcnt(14)
    v_mfma_f32_32x32x16_bf16 v[88:103], v[216:219], v[136:139], v[88:103]
    s_waitcnt lgkmcnt(12)
    v_mfma_f32_32x32x16_bf16 v[104:119], v[220:223], v[136:139], v[104:119]
    s_waitcnt vmcnt(14) lgkmcnt(0)
    s_barrier
    v_mfma_f32_32x32x16_bf16 v[24:39], v[224:227], v[140:143], v[24:39]
    ds_read_b64_tr_b16 v[200:201], v174 offset:36864
    ds_read_b64_tr_b16 v[202:203], v175 offset:38400
    ds_read_b64_tr_b16 v[204:205], v176 offset:36864
    s_add_u32 m0, s26, 24576
    s_nop 0
    buffer_load_dwordx4 v168, s[8:11], s28 offen lds
    v_mfma_f32_32x32x16_bf16 v[40:55], v[228:231], v[140:143], v[40:55]
    ds_read_b64_tr_b16 v[206:207], v177 offset:38400
    ds_read_b64_tr_b16 v[208:209], v174 offset:36992
    ds_read_b64_tr_b16 v[210:211], v175 offset:38528
    v_mfma_f32_32x32x16_bf16 v[56:71], v[232:235], v[140:143], v[56:71]
    ds_read_b64_tr_b16 v[212:213], v176 offset:36992
    ds_read_b64_tr_b16 v[214:215], v177 offset:38528
    ds_read_b64_tr_b16 v[216:217], v174 offset:37120
    s_add_u32 m0, s26, 25600
    s_nop 0
    buffer_load_dwordx4 v169, s[8:11], s28 offen lds
    v_mfma_f32_32x32x16_bf16 v[72:87], v[236:239], v[140:143], v[72:87]
    ds_read_b64_tr_b16 v[218:219], v175 offset:38656
    ds_read_b64_tr_b16 v[220:221], v176 offset:37120
    ds_read_b64_tr_b16 v[222:223], v177 offset:38656
    v_mfma_f32_32x32x16_bf16 v[88:103], v[240:243], v[140:143], v[88:103]
    s_add_u32 m0, s26, 26624
    s_nop 0
    buffer_load_dwordx4 v182, s[8:11], s28 offen lds
    s_add_u32 s28, s28, 393216
    s_cmp_eq_u32 s28, 7864320
    s_cselect_b32 s28, 0, s28
    v_mfma_f32_32x32x16_bf16 v[104:119], v[244:247], v[140:143], v[104:119]
    s_waitcnt lgkmcnt(10)
    v_mfma_f32_32x32x16_bf16 v[24:39], v[200:203], v[144:147], v[24:39]
    ds_read_b64_tr_b16 v[224:225], v174 offset:43008
    ds_read_b64_tr_b16 v[226:227], v175 offset:44544
    ds_read_b64_tr_b16 v[228:229], v176 offset:43008
    s_waitcnt lgkmcnt(11)
    v_mfma_f32_32x32x16_bf16 v[40:55], v[204:207], v[144:147], v[40:55]
    ds_read_b64_tr_b16 v[230:231], v177 offset:44544
    ds_read_b64_tr_b16 v[232:233], v174 offset:43136
    ds_read_b64_tr_b16 v[234:235], v175 offset:44672
    s_waitcnt lgkmcnt(12)
    v_mfma_f32_32x32x16_bf16 v[56:71], v[208:211], v[144:147], v[56:71]
    ds_read_b64_tr_b16 v[236:237], v176 offset:43136
    ds_read_b64_tr_b16 v[238:239], v177 offset:44672
    ds_read_b64_tr_b16 v[240:241], v174 offset:43264
    s_waitcnt lgkmcnt(13)
    v_mfma_f32_32x32x16_bf16 v[72:87], v[212:215], v[144:147], v[72:87]
    ds_read_b64_tr_b16 v[242:243], v175 offset:44800
    ds_read_b64_tr_b16 v[244:245], v176 offset:43264
    ds_read_b64_tr_b16 v[246:247], v177 offset:44800
    s_waitcnt lgkmcnt(14)
    v_mfma_f32_32x32x16_bf16 v[88:103], v[216:219], v[144:147], v[88:103]
    s_waitcnt lgkmcnt(12)
    v_mfma_f32_32x32x16_bf16 v[104:119], v[220:223], v[144:147], v[104:119]
    s_waitcnt vmcnt(10) lgkmcnt(0)
    s_barrier
    v_mfma_f32_32x32x16_bf16 v[24:39], v[224:227], v[148:151], v[24:39]
    ds_read_b128 v[120:123], v178 offset:0
    ds_read_b128 v[124:127], v179 offset:0
    ds_read_b128 v[128:131], v180 offset:0
    ds_read_b128 v[132:135], v181 offset:0
    s_add_u32 m0, s26, 36864
    s_nop 0
    buffer_load_dwordx4 v168, s[8:11], s28 offen lds
    v_mfma_f32_32x32x16_bf16 v[40:55], v[228:231], v[148:151], v[40:55]
    ds_read_b64_tr_b16 v[200:201], v174 offset:0
    ds_read_b64_tr_b16 v[202:203], v175 offset:1536
    ds_read_b64_tr_b16 v[204:205], v176 offset:0
    v_mfma_f32_32x32x16_bf16 v[56:71], v[232:235], v[148:151], v[56:71]
    ds_read_b64_tr_b16 v[206:207], v177 offset:1536
    ds_read_b64_tr_b16 v[208:209], v174 offset:128
    ds_read_b64_tr_b16 v[210:211], v175 offset:1664
    s_add_u32 m0, s26, 37888
    s_nop 0
    buffer_load_dwordx4 v169, s[8:11], s28 offen lds
    v_mfma_f32_32x32x16_bf16 v[72:87], v[236:239], v[148:151], v[72:87]
    ds_read_b64_tr_b16 v[212:213], v176 offset:128
    ds_read_b64_tr_b16 v[214:215], v177 offset:1664
    ds_read_b64_tr_b16 v[216:217], v174 offset:256
    v_mfma_f32_32x32x16_bf16 v[88:103], v[240:243], v[148:151], v[88:103]
    ds_read_b64_tr_b16 v[218:219], v175 offset:1792
    ds_read_b64_tr_b16 v[220:221], v176 offset:256
    ds_read_b64_tr_b16 v[222:223], v177 offset:1792
    s_add_u32 m0, s26, 38912
    s_nop 0
    buffer_load_dwordx4 v182, s[8:11], s28 offen lds
    s_add_u32 s28, s28, 393216
    s_cmp_eq_u32 s28, 7864320
    s_cselect_b32 s28, 0, s28
    v_mfma_f32_32x32x16_bf16 v[104:119], v[244:247], v[148:151], v[104:119]
    s_waitcnt lgkmcnt(10)
    v_mfma_f32_32x32x16_bf16 v[24:39], v[200:203], v[120:123], v[24:39]
    ds_read_b64_tr_b16 v[224:225], v174 offset:6144
    ds_read_b64_tr_b16 v[226:227], v175 offset:7680
    ds_read_b64_tr_b16 v[228:229], v176 offset:6144
    s_add_u32 m0, s30, 0
    s_nop 0
    buffer_load_dwordx4 v170, s[4:7], s29 offen lds
    s_waitcnt lgkmcnt(11)
    v_mfma_f32_32x32x16_bf16 v[40:55], v[204:207], v[120:123], v[40:55]
    ds_read_b64_tr_b16 v[230:231], v177 offset:7680
    ds_read_b64_tr_b16 v[232:233], v174 offset:6272
    ds_read_b64_tr_b16 v[234:235], v175 offset:7808
    s_add_u32 m0, s30, 1024
    s_nop 0
    buffer_load_dwordx4 v171, s[4:7], s29 offen lds
    s_waitcnt lgkmcnt(12)
    v_mfma_f32_32x32x16_bf16 v[56:71], v[208:211], v[120:123], v[56:71]
    ds_read_b64_tr_b16 v[236:237], v176 offset:6272
    ds_read_b64_tr_b16 v[238:239], v177 offset:7808
    ds_read_b64_tr_b16 v[240:241], v174 offset:6400
    s_add_u32 m0, s30, 2048
    s_nop 0
    buffer_load_dwordx4 v172, s[4:7], s29 offen lds
    s_waitcnt lgkmcnt(13)
    v_mfma_f32_32x32x16_bf16 v[72:87], v[212:215], v[120:123], v[72:87]
    ds_read_b64_tr_b16 v[242:243], v175 offset:7936
    ds_read_b64_tr_b16 v[244:245], v176 offset:6400
    ds_read_b64_tr_b16 v[246:247], v177 offset:7936
    s_add_u32 m0, s30, 3072
    s_nop 0
    buffer_load_dwordx4 v173, s[4:7], s29 offen lds
    s_add_u32 s29, s29, 128
    s_cmp_eq_u32 s29, 1280
    s_cselect_b32 s29, 0, s29
    s_waitcnt lgkmcnt(14)
    v_mfma_f32_32x32x16_bf16 v[88:103], v[216:219], v[120:123], v[88:103]
    s_waitcnt lgkmcnt(12)
    v_mfma_f32_32x32x16_bf16 v[104:119], v[220:223], v[120:123], v[104:119]
    s_waitcnt vmcnt(14) lgkmcnt(0)
    s_barrier
    v_mfma_f32_32x32x16_bf16 v[24:39], v[224:227], v[124:127], v[24:39]
    ds_read_b64_tr_b16 v[200:201], v174 offset:12288
    ds_read_b64_tr_b16 v[202:203], v175 offset:13824
    ds_read_b64_tr_b16 v[204:205], v176 offset:12288
    s_add_u32 m0, s26, 0
    s_nop 0
    buffer_load_dwordx4 v168, s[8:11], s28 offen lds
    v_mfma_f32_32x32x16_bf16 v[40:55], v[228:231], v[124:127], v[40:55]
    ds_read_b64_tr_b16 v[206:207], v177 offset:13824
    ds_read_b64_tr_b16 v[208:209], v174 offset:12416
    ds_read_b64_tr_b16 v[210:211], v175 offset:13952
    v_mfma_f32_32x32x16_bf16 v[56:71], v[232:235], v[124:127], v[56:71]
    ds_read_b64_tr_b16 v[212:213], v176 offset:12416
    ds_read_b64_tr_b16 v[214:215], v177 offset:13952
    ds_read_b64_tr_b16 v[216:217], v174 offset:12544
    s_add_u32 m0, s26, 1024
    s_nop 0
    buffer_load_dwordx4 v169, s[8:11], s28 offen lds
    v_mfma_f32_32x32x16_bf16 v[72:87], v[236:239], v[124:127], v[72:87]
    ds_read_b64_tr_b16 v[218:219], v175 offset:14080
    ds_read_b64_tr_b16 v[220:221], v176 offset:12544
    ds_read_b64_tr_b16 v[222:223], v177 offset:14080
    v_mfma_f32_32x32x16_bf16 v[88:103], v[240:243], v[124:127], v[88:103]
    s_add_u32 m0, s26, 2048
    s_nop 0
    buffer_load_dwordx4 v182, s[8:11], s28 offen lds
    s_add_u32 s28, s28, 393216
    s_cmp_eq_u32 s28, 7864320
    s_cselect_b32 s28, 0, s28
    v_mfma_f32_32x32x16_bf16 v[104:119], v[244:247], v[124:127], v[104:119]
    s_waitcnt lgkmcnt(10)
    v_mfma_f32_32x32x16_bf16 v[24:39], v[200:203], v[128:131], v[24:39]
    ds_read_b64_tr_b16 v[224:225], v174 offset:18432
    ds_read_b64_tr_b16 v[226:227], v175 offset:19968
    ds_read_b64_tr_b16 v[228:229], v176 offset:18432
    s_waitcnt lgkmcnt(11)
    v_mfma_f32_32x32x16_bf16 v[40:55], v[204:207], v[128:131], v[40:55]
    ds_read_b64_tr_b16 v[230:231], v177 offset:19968
    ds_read_b64_tr_b16 v[232:233], v174 offset:18560
    ds_read_b64_tr_b16 v[234:235], v175 offset:20096
    s_waitcnt lgkmcnt(12)
    v_mfma_f32_32x32x16_bf16 v[56:71], v[208:211], v[128:131], v[56:71]
    ds_read_b64_tr_b16 v[236:237], v176 offset:18560
    ds_read_b64_tr_b16 v[238:239], v177 offset:20096
    ds_read_b64_tr_b16 v[240:241], v174 offset:18688
    s_waitcnt lgkmcnt(13)
    v_mfma_f32_32x32x16_bf16 v[72:87], v[212:215], v[128:131], v[72:87]
    ds_read_b64_tr_b16 v[242:243], v175 offset:20224
    ds_read_b64_tr_b16 v[244:245], v176 offset:18688
    ds_read_b64_tr_b16 v[246:247], v177 offset:20224
    s_waitcnt lgkmcnt(14)
    v_mfma_f32_32x32x16_bf16 v[88:103], v[216:219], v[128:131], v[88:103]
    s_waitcnt lgkmcnt(12)
    v_mfma_f32_32x32x16_bf16 v[104:119], v[220:223], v[128:131], v[104:119]
    s_waitcnt vmcnt(10) lgkmcnt(0)
    s_barrier
    v_mfma_f32_32x32x16_bf16 v[24:39], v[224:227], v[132:135], v[24:39]
    ds_read_b128 v[136:139], v178 offset:16384
    ds_read_b128 v[140:143], v179 offset:16384
    ds_read_b128 v[144:147], v180 offset:16384
    ds_read_b128 v[148:151], v181 offset:16384
    s_add_u32 m0, s26, 12288
    s_nop 0
    buffer_load_dwordx4 v168, s[8:11], s28 offen lds
    v_mfma_f32_32x32x16_bf16 v[40:55], v[228:231], v[132:135], v[40:55]
    ds_read_b64_tr_b16 v[200:201], v174 offset:24576
    ds_read_b64_tr_b16 v[202:203], v175 offset:26112
    ds_read_b64_tr_b16 v[204:205], v176 offset:24576
    v_mfma_f32_32x32x16_bf16 v[56:71], v[232:235], v[132:135], v[56:71]
    ds_read_b64_tr_b16 v[206:207], v177 offset:26112
    ds_read_b64_tr_b16 v[208:209], v174 offset:24704
    ds_read_b64_tr_b16 v[210:211], v175 offset:26240
    s_add_u32 m0, s26, 13312
    s_nop 0
    buffer_load_dwordx4 v169, s[8:11], s28 offen lds
    v_mfma_f32_32x32x16_bf16 v[72:87], v[236:239], v[132:135], v[72:87]
    ds_read_b64_tr_b16 v[212:213], v176 offset:24704
    ds_read_b64_tr_b16 v[214:215], v177 offset:26240
    ds_read_b64_tr_b16 v[216:217], v174 offset:24832
    v_mfma_f32_32x32x16_bf16 v[88:103], v[240:243], v[132:135], v[88:103]
    ds_read_b64_tr_b16 v[218:219], v175 offset:26368
    ds_read_b64_tr_b16 v[220:221], v176 offset:24832
    ds_read_b64_tr_b16 v[222:223], v177 offset:26368
    s_add_u32 m0, s26, 14336
    s_nop 0
    buffer_load_dwordx4 v182, s[8:11], s28 offen lds
    s_add_u32 s28, s28, 393216
    s_cmp_eq_u32 s28, 7864320
    s_cselect_b32 s28, 0, s28
    v_mfma_f32_32x32x16_bf16 v[104:119], v[244:247], v[132:135], v[104:119]
    s_waitcnt lgkmcnt(10)
    v_mfma_f32_32x32x16_bf16 v[24:39], v[200:203], v[136:139], v[24:39]
    ds_read_b64_tr_b16 v[224:225], v174 offset:30720
    ds_read_b64_tr_b16 v[226:227], v175 offset:32256
    ds_read_b64_tr_b16 v[228:229], v176 offset:30720
    s_add_u32 m0, s30, 16384
    s_nop 0
    buffer_load_dwordx4 v170, s[4:7], s29 offen lds
    s_waitcnt lgkmcnt(11)
    v_mfma_f32_32x32x16_bf16 v[40:55], v[204:207], v[136:139], v[40:55]
    ds_read_b64_tr_b16 v[230:231], v177 offset:32256
    ds_read_b64_tr_b16 v[232:233], v174 offset:30848
    ds_read_b64_tr_b16 v[234:235], v175 offset:32384
    s_add_u32 m0, s30, 17408
    s_nop 0
    buffer_load_dwordx4 v171, s[4:7], s29 offen lds
    s_waitcnt lgkmcnt(12)
    v_mfma_f32_32x32x16_bf16 v[56:71], v[208:211], v[136:139], v[56:71]
    ds_read_b64_tr_b16 v[236:237], v176 offset:30848
    ds_read_b64_tr_b16 v[238:239], v177 offset:32384
    ds_read_b64_tr_b16 v[240:241], v174 offset:30976
    s_add_u32 m0, s30, 18432
    s_nop 0
    buffer_load_dwordx4 v172, s[4:7], s29 offen lds
    s_waitcnt lgkmcnt(13)
    v_mfma_f32_32x32x16_bf16 v[72:87], v[212:215], v[136:139], v[72:87]
    ds_read_b64_tr_b16 v[242:243], v175 offset:32512
    ds_read_b64_tr_b16 v[244:245], v176 offset:30976
    ds_read_b64_tr_b16 v[246:247], v177 offset:32512
    s_add_u32 m0, s30, 19456
    s_nop 0
    buffer_load_dwordx4 v173, s[4:7], s29 offen lds
    s_add_u32 s29, s29, 128
    s_cmp_eq_u32 s29, 1280
    s_cselect_b32 s29, 0, s29
    s_waitcnt lgkmcnt(14)
    v_mfma_f32_32x32x16_bf16 v[88:103], v[216:219], v[136:139], v[88:103]
    s_waitcnt lgkmcnt(12)
    v_mfma_f32_32x32x16_bf16 v[104:119], v[220:223], v[136:139], v[104:119]
    s_waitcnt vmcnt(14) lgkmcnt(0)
    s_barrier
    v_mfma_f32_32x32x16_bf16 v[24:39], v[224:227], v[140:143], v[24:39]
    ds_read_b64_tr_b16 v[200:201], v174 offset:36864
    ds_read_b64_tr_b16 v[202:203], v175 offset:38400
    ds_read_b64_tr_b16 v[204:205], v176 offset:36864
    s_add_u32 m0, s26, 24576
    s_nop 0
    buffer_load_dwordx4 v168, s[8:11], s28 offen lds
    v_mfma_f32_32x32x16_bf16 v[40:55], v[228:231], v[140:143], v[40:55]
    ds_read_b64_tr_b16 v[206:207], v177 offset:38400
    ds_read_b64_tr_b16 v[208:209], v174 offset:36992
    ds_read_b64_tr_b16 v[210:211], v175 offset:38528
    v_mfma_f32_32x32x16_bf16 v[56:71], v[232:235], v[140:143], v[56:71]
    ds_read_b64_tr_b16 v[212:213], v176 offset:36992
    ds_read_b64_tr_b16 v[214:215], v177 offset:38528
    ds_read_b64_tr_b16 v[216:217], v174 offset:37120
    s_add_u32 m0, s26, 25600
    s_nop 0
    buffer_load_dwordx4 v169, s[8:11], s28 offen lds
    v_mfma_f32_32x32x16_bf16 v[72:87], v[236:239], v[140:143], v[72:87]
    ds_read_b64_tr_b16 v[218:219], v175 offset:38656
    ds_read_b64_tr_b16 v[220:221], v176 offset:37120
    ds_read_b64_tr_b16 v[222:223], v177 offset:38656
    v_mfma_f32_32x32x16_bf16 v[88:103], v[240:243], v[140:143], v[88:103]
    s_add_u32 m0, s26, 26624
    s_nop 0
    buffer_load_dwordx4 v182, s[8:11], s28 offen lds
    s_add_u32 s28, s28, 393216
    s_cmp_eq_u32 s28, 7864320
    s_cselect_b32 s28, 0, s28
    v_mfma_f32_32x32x16_bf16 v[104:119], v[244:247], v[140:143], v[104:119]
    s_waitcnt lgkmcnt(10)
    v_mfma_f32_32x32x16_bf16 v[24:39], v[200:203], v[144:147], v[24:39]
    ds_read_b64_tr_b16 v[224:225], v174 offset:43008
    ds_read_b64_tr_b16 v[226:227], v175 offset:44544
    ds_read_b64_tr_b16 v[228:229], v176 offset:43008
    s_waitcnt lgkmcnt(11)
    v_mfma_f32_32x32x16_bf16 v[40:55], v[204:207], v[144:147], v[40:55]
    ds_read_b64_tr_b16 v[230:231], v177 offset:44544
    ds_read_b64_tr_b16 v[232:233], v174 offset:43136
    ds_read_b64_tr_b16 v[234:235], v175 offset:44672
    s_waitcnt lgkmcnt(12)
    v_mfma_f32_32x32x16_bf16 v[56:71], v[208:211], v[144:147], v[56:71]
    ds_read_b64_tr_b16 v[236:237], v176 offset:43136
    ds_read_b64_tr_b16 v[238:239], v177 offset:44672
    ds_read_b64_tr_b16 v[240:241], v174 offset:43264
    s_waitcnt lgkmcnt(13)
    v_mfma_f32_32x32x16_bf16 v[72:87], v[212:215], v[144:147], v[72:87]
    ds_read_b64_tr_b16 v[242:243], v175 offset:44800
    ds_read_b64_tr_b16 v[244:245], v176 offset:43264
    ds_read_b64_tr_b16 v[246:247], v177 offset:44800
    s_waitcnt lgkmcnt(14)
    v_mfma_f32_32x32x16_bf16 v[88:103], v[216:219], v[144:147], v[88:103]
    s_waitcnt lgkmcnt(12)
    v_mfma_f32_32x32x16_bf16 v[104:119], v[220:223], v[144:147], v[104:119]
    s_waitcnt vmcnt(10) lgkmcnt(0)
    s_barrier
    v_mfma_f32_32x32x16_bf16 v[24:39], v[224:227], v[148:151], v[24:39]
    ds_read_b128 v[120:123], v178 offset:0
    ds_read_b128 v[124:127], v179 offset:0
    ds_read_b128 v[128:131], v180 offset:0
    ds_read_b128 v[132:135], v181 offset:0
    s_add_u32 m0, s26, 36864
    s_nop 0
    buffer_load_dwordx4 v168, s[8:11], s28 offen lds
    v_mfma_f32_32x32x16_bf16 v[40:55], v[228:231], v[148:151], v[40:55]
    ds_read_b64_tr_b16 v[200:201], v174 offset:0
    ds_read_b64_tr_b16 v[202:203], v175 offset:1536
    ds_read_b64_tr_b16 v[204:205], v176 offset:0
    v_mfma_f32_32x32x16_bf16 v[56:71], v[232:235], v[148:151], v[56:71]
    ds_read_b64_tr_b16 v[206:207], v177 offset:1536
    ds_read_b64_tr_b16 v[208:209], v174 offset:128
    ds_read_b64_tr_b16 v[210:211], v175 offset:1664
    s_add_u32 m0, s26, 37888
    s_nop 0
    buffer_load_dwordx4 v169, s[8:11], s28 offen lds
    v_mfma_f32_32x32x16_bf16 v[72:87], v[236:239], v[148:151], v[72:87]
    ds_read_b64_tr_b16 v[212:213], v176 offset:128
    ds_read_b64_tr_b16 v[214:215], v177 offset:1664
    ds_read_b64_tr_b16 v[216:217], v174 offset:256
    v_mfma_f32_32x32x16_bf16 v[88:103], v[240:243], v[148:151], v[88:103]
    ds_read_b64_tr_b16 v[218:219], v175 offset:1792
    ds_read_b64_tr_b16 v[220:221], v176 offset:256
    ds_read_b64_tr_b16 v[222:223], v177 offset:1792
    s_add_u32 m0, s26, 38912
    s_nop 0
    buffer_load_dwordx4 v182, s[8:11], s28 offen lds
    s_add_u32 s28, s28, 393216
    s_cmp_eq_u32 s28, 7864320
    s_cselect_b32 s28, 0, s28
    v_mfma_f32_32x32x16_bf16 v[104:119], v[244:247], v[148:151], v[104:119]
    s_waitcnt lgkmcnt(10)
    v_mfma_f32_32x32x16_bf16 v[24:39], v[200:203], v[120:123], v[24:39]
    ds_read_b64_tr_b16 v[224:225], v174 offset:6144
    ds_read_b64_tr_b16 v[226:227], v175 offset:7680
    ds_read_b64_tr_b16 v[228:229], v176 offset:6144
    s_add_u32 m0, s30, 0
    s_nop 0
    buffer_load_dwordx4 v170, s[4:7], s29 offen lds
    s_waitcnt lgkmcnt(11)
    v_mfma_f32_32x32x16_bf16 v[40:55], v[204:207], v[120:123], v[40:55]
    ds_read_b64_tr_b16 v[230:231], v177 offset:7680
    ds_read_b64_tr_b16 v[232:233], v174 offset:6272
    ds_read_b64_tr_b16 v[234:235], v175 offset:7808
    s_add_u32 m0, s30, 1024
    s_nop 0
    buffer_load_dwordx4 v171, s[4:7], s29 offen lds
    s_waitcnt lgkmcnt(12)
    v_mfma_f32_32x32x16_bf16 v[56:71], v[208:211], v[120:123], v[56:71]
    ds_read_b64_tr_b16 v[236:237], v176 offset:6272
    ds_read_b64_tr_b16 v[238:239], v177 offset:7808
    ds_read_b64_tr_b16 v[240:241], v174 offset:6400
    s_add_u32 m0, s30, 2048
    s_nop 0
    buffer_load_dwordx4 v172, s[4:7], s29 offen lds
    s_waitcnt lgkmcnt(13)
    v_mfma_f32_32x32x16_bf16 v[72:87], v[212:215], v[120:123], v[72:87]
    ds_read_b64_tr_b16 v[242:243], v175 offset:7936
    ds_read_b64_tr_b16 v[244:245], v176 offset:6400
    ds_read_b64_tr_b16 v[246:247], v177 offset:7936
    s_add_u32 m0, s30, 3072
    s_nop 0
    buffer_load_dwordx4 v173, s[4:7], s29 offen lds
    s_add_u32 s29, s29, 128
    s_cmp_eq_u32 s29, 1280
    s_cselect_b32 s29, 0, s29
    s_waitcnt lgkmcnt(14)
    v_mfma_f32_32x32x16_bf16 v[88:103], v[216:219], v[120:123], v[88:103]
    s_waitcnt lgkmcnt(12)
    v_mfma_f32_32x32x16_bf16 v[104:119], v[220:223], v[120:123], v[104:119]
    s_waitcnt vmcnt(14) lgkmcnt(0)
    s_barrier
    v_mfma_f32_32x32x16_bf16 v[24:39], v[224:227], v[124:127], v[24:39]
    ds_read_b64_tr_b16 v[200:201], v174 offset:12288
    ds_read_b64_tr_b16 v[202:203], v175 offset:13824
    ds_read_b64_tr_b16 v[204:205], v176 offset:12288
    s_add_u32 m0, s26, 0
    s_nop 0
    buffer_load_dwordx4 v168, s[8:11], s28 offen lds
    v_mfma_f32_32x32x16_bf16 v[40:55], v[228:231], v[124:127], v[40:55]
    ds_read_b64_tr_b16 v[206:207], v177 offset:13824
    ds_read_b64_tr_b16 v[208:209], v174 offset:12416
    ds_read_b64_tr_b16 v[210:211], v175 offset:13952
    v_mfma_f32_32x32x16_bf16 v[56:71], v[232:235], v[124:127], v[56:71]
    ds_read_b64_tr_b16 v[212:213], v176 offset:12416
    ds_read_b64_tr_b16 v[214:215], v177 offset:13952
    ds_read_b64_tr_b16 v[216:217], v174 offset:12544
    s_add_u32 m0, s26, 1024
    s_nop 0
    buffer_load_dwordx4 v169, s[8:11], s28 offen lds
    v_mfma_f32_32x32x16_bf16 v[72:87], v[236:239], v[124:127], v[72:87]
    ds_read_b64_tr_b16 v[218:219], v175 offset:14080
    ds_read_b64_tr_b16 v[220:221], v176 offset:12544
    ds_read_b64_tr_b16 v[222:223], v177 offset:14080
    v_mfma_f32_32x32x16_bf16 v[88:103], v[240:243], v[124:127], v[88:103]
    s_add_u32 m0, s26, 2048
    s_nop 0
    buffer_load_dwordx4 v182, s[8:11], s28 offen lds
    s_add_u32 s28, s28, 393216
    s_cmp_eq_u32 s28, 7864320
    s_cselect_b32 s28, 0, s28
    v_mfma_f32_32x32x16_bf16 v[104:119], v[244:247], v[124:127], v[104:119]
    s_waitcnt lgkmcnt(10)
    v_mfma_f32_32x32x16_bf16 v[24:39], v[200:203], v[128:131], v[24:39]
    ds_read_b64_tr_b16 v[224:225], v174 offset:18432
    ds_read_b64_tr_b16 v[226:227], v175 offset:19968
    ds_read_b64_tr_b16 v[228:229], v176 offset:18432
    s_waitcnt lgkmcnt(11)
    v_mfma_f32_32x32x16_bf16 v[40:55], v[204:207], v[128:131], v[40:55]
    ds_read_b64_tr_b16 v[230:231], v177 offset:19968
    ds_read_b64_tr_b16 v[232:233], v174 offset:18560
    ds_read_b64_tr_b16 v[234:235], v175 offset:20096
    s_waitcnt lgkmcnt(12)
    v_mfma_f32_32x32x16_bf16 v[56:71], v[208:211], v[128:131], v[56:71]
    ds_read_b64_tr_b16 v[236:237], v176 offset:18560
    ds_read_b64_tr_b16 v[238:239], v177 offset:20096
    ds_read_b64_tr_b16 v[240:241], v174 offset:18688
    s_waitcnt lgkmcnt(13)
    v_mfma_f32_32x32x16_bf16 v[72:87], v[212:215], v[128:131], v[72:87]
    ds_read_b64_tr_b16 v[242:243], v175 offset:20224
    ds_read_b64_tr_b16 v[244:245], v176 offset:18688
    ds_read_b64_tr_b16 v[246:247], v177 offset:20224
    s_waitcnt lgkmcnt(14)
    v_mfma_f32_32x32x16_bf16 v[88:103], v[216:219], v[128:131], v[88:103]
    s_waitcnt lgkmcnt(12)
    v_mfma_f32_32x32x16_bf16 v[104:119], v[220:223], v[128:131], v[104:119]
    s_waitcnt vmcnt(10) lgkmcnt(0)
    s_barrier
    v_mfma_f32_32x32x16_bf16 v[24:39], v[224:227], v[132:135], v[24:39]
    ds_read_b128 v[136:139], v178 offset:16384
    ds_read_b128 v[140:143], v179 offset:16384
    ds_read_b128 v[144:147], v180 offset:16384
    ds_read_b128 v[148:151], v181 offset:16384
    s_add_u32 m0, s26, 12288
    s_nop 0
    buffer_load_dwordx4 v168, s[8:11], s28 offen lds
    v_mfma_f32_32x32x16_bf16 v[40:55], v[228:231], v[132:135], v[40:55]
    ds_read_b64_tr_b16 v[200:201], v174 offset:24576
    ds_read_b64_tr_b16 v[202:203], v175 offset:26112
    ds_read_b64_tr_b16 v[204:205], v176 offset:24576
    v_mfma_f32_32x32x16_bf16 v[56:71], v[232:235], v[132:135], v[56:71]
    ds_read_b64_tr_b16 v[206:207], v177 offset:26112
    ds_read_b64_tr_b16 v[208:209], v174 offset:24704
    ds_read_b64_tr_b16 v[210:211], v175 offset:26240
    s_add_u32 m0, s26, 13312
    s_nop 0
    buffer_load_dwordx4 v169, s[8:11], s28 offen lds
    v_mfma_f32_32x32x16_bf16 v[72:87], v[236:239], v[132:135], v[72:87]
    ds_read_b64_tr_b16 v[212:213], v176 offset:24704
    ds_read_b64_tr_b16 v[214:215], v177 offset:26240
    ds_read_b64_tr_b16 v[216:217], v174 offset:24832
    v_mfma_f32_32x32x16_bf16 v[88:103], v[240:243], v[132:135], v[88:103]
    ds_read_b64_tr_b16 v[218:219], v175 offset:26368
    ds_read_b64_tr_b16 v[220:221], v176 offset:24832
    ds_read_b64_tr_b16 v[222:223], v177 offset:26368
    s_add_u32 m0, s26, 14336
    s_nop 0
    buffer_load_dwordx4 v182, s[8:11], s28 offen lds
    s_add_u32 s28, s28, 393216
    s_cmp_eq_u32 s28, 7864320
    s_cselect_b32 s28, 0, s28
    v_mfma_f32_32x32x16_bf16 v[104:119], v[244:247], v[132:135], v[104:119]
    s_waitcnt lgkmcnt(10)
    v_mfma_f32_32x32x16_bf16 v[24:39], v[200:203], v[136:139], v[24:39]
    ds_read_b64_tr_b16 v[224:225], v174 offset:30720
    ds_read_b64_tr_b16 v[226:227], v175 offset:32256
    ds_read_b64_tr_b16 v[228:229], v176 offset:30720
    s_add_u32 m0, s30, 16384
    s_nop 0
    buffer_load_dwordx4 v170, s[4:7], s29 offen lds
    s_waitcnt lgkmcnt(11)
    v_mfma_f32_32x32x16_bf16 v[40:55], v[204:207], v[136:139], v[40:55]
    ds_read_b64_tr_b16 v[230:231], v177 offset:32256
    ds_read_b64_tr_b16 v[232:233], v174 offset:30848
    ds_read_b64_tr_b16 v[234:235], v175 offset:32384
    s_add_u32 m0, s30, 17408
    s_nop 0
    buffer_load_dwordx4 v171, s[4:7], s29 offen lds
    s_waitcnt lgkmcnt(12)
    v_mfma_f32_32x32x16_bf16 v[56:71], v[208:211], v[136:139], v[56:71]
    ds_read_b64_tr_b16 v[236:237], v176 offset:30848
    ds_read_b64_tr_b16 v[238:239], v177 offset:32384
    ds_read_b64_tr_b16 v[240:241], v174 offset:30976
    s_add_u32 m0, s30, 18432
    s_nop 0
    buffer_load_dwordx4 v172, s[4:7], s29 offen lds
    s_waitcnt lgkmcnt(13)
    v_mfma_f32_32x32x16_bf16 v[72:87], v[212:215], v[136:139], v[72:87]
    ds_read_b64_tr_b16 v[242:243], v175 offset:32512
    ds_read_b64_tr_b16 v[244:245], v176 offset:30976
    ds_read_b64_tr_b16 v[246:247], v177 offset:32512
    s_add_u32 m0, s30, 19456
    s_nop 0
    buffer_load_dwordx4 v173, s[4:7], s29 offen lds
    s_add_u32 s29, s29, 128
    s_cmp_eq_u32 s29, 1280
    s_cselect_b32 s29, 0, s29
    s_waitcnt lgkmcnt(14)
    v_mfma_f32_32x32x16_bf16 v[88:103], v[216:219], v[136:139], v[88:103]
    s_waitcnt lgkmcnt(12)
    v_mfma_f32_32x32x16_bf16 v[104:119], v[220:223], v[136:139], v[104:119]
    s_waitcnt vmcnt(14) lgkmcnt(0)
    s_barrier
    v_mfma_f32_32x32x16_bf16 v[24:39], v[224:227], v[140:143], v[24:39]
    ds_read_b64_tr_b16 v[200:201], v174 offset:36864
    ds_read_b64_tr_b16 v[202:203], v175 offset:38400
    ds_read_b64_tr_b16 v[204:205], v176 offset:36864
    s_add_u32 m0, s26, 24576
    s_nop 0
    buffer_load_dwordx4 v168, s[8:11], s28 offen lds
    v_mfma_f32_32x32x16_bf16 v[40:55], v[228:231], v[140:143], v[40:55]
    ds_read_b64_tr_b16 v[206:207], v177 offset:38400
    ds_read_b64_tr_b16 v[208:209], v174 offset:36992
    ds_read_b64_tr_b16 v[210:211], v175 offset:38528
    v_mfma_f32_32x32x16_bf16 v[56:71], v[232:235], v[140:143], v[56:71]
    ds_read_b64_tr_b16 v[212:213], v176 offset:36992
    ds_read_b64_tr_b16 v[214:215], v177 offset:38528
    ds_read_b64_tr_b16 v[216:217], v174 offset:37120
    s_add_u32 m0, s26, 25600
    s_nop 0
    buffer_load_dwordx4 v169, s[8:11], s28 offen lds
    v_mfma_f32_32x32x16_bf16 v[72:87], v[236:239], v[140:143], v[72:87]
    ds_read_b64_tr_b16 v[218:219], v175 offset:38656
    ds_read_b64_tr_b16 v[220:221], v176 offset:37120
    ds_read_b64_tr_b16 v[222:223], v177 offset:38656
    v_mfma_f32_32x32x16_bf16 v[88:103], v[240:243], v[140:143], v[88:103]
    s_add_u32 m0, s26, 26624
    s_nop 0
    buffer_load_dwordx4 v182, s[8:11], s28 offen lds
    s_add_u32 s28, s28, 393216
    s_cmp_eq_u32 s28, 7864320
    s_cselect_b32 s28, 0, s28
    v_mfma_f32_32x32x16_bf16 v[104:119], v[244:247], v[140:143], v[104:119]
    s_waitcnt lgkmcnt(10)
    v_mfma_f32_32x32x16_bf16 v[24:39], v[200:203], v[144:147], v[24:39]
    ds_read_b64_tr_b16 v[224:225], v174 offset:43008
    ds_read_b64_tr_b16 v[226:227], v175 offset:44544
    ds_read_b64_tr_b16 v[228:229], v176 offset:43008
    s_waitcnt lgkmcnt(11)
    v_mfma_f32_32x32x16_bf16 v[40:55], v[204:207], v[144:147], v[40:55]
    ds_read_b64_tr_b16 v[230:231], v177 offset:44544
    ds_read_b64_tr_b16 v[232:233], v174 offset:43136
    ds_read_b64_tr_b16 v[234:235], v175 offset:44672
    s_waitcnt lgkmcnt(12)
    v_mfma_f32_32x32x16_bf16 v[56:71], v[208:211], v[144:147], v[56:71]
    ds_read_b64_tr_b16 v[236:237], v176 offset:43136
    ds_read_b64_tr_b16 v[238:239], v177 offset:44672
    ds_read_b64_tr_b16 v[240:241], v174 offset:43264
    s_waitcnt lgkmcnt(13)
    v_mfma_f32_32x32x16_bf16 v[72:87], v[212:215], v[144:147], v[72:87]
    ds_read_b64_tr_b16 v[242:243], v175 offset:44800
    ds_read_b64_tr_b16 v[244:245], v176 offset:43264
    ds_read_b64_tr_b16 v[246:247], v177 offset:44800
    s_waitcnt lgkmcnt(14)
    v_mfma_f32_32x32x16_bf16 v[88:103], v[216:219], v[144:147], v[88:103]
    s_waitcnt lgkmcnt(12)
    v_mfma_f32_32x32x16_bf16 v[104:119], v[220:223], v[144:147], v[104:119]
    s_waitcnt vmcnt(10) lgkmcnt(0)
    s_barrier
    v_mfma_f32_32x32x16_bf16 v[24:39], v[224:227], v[148:151], v[24:39]
    ds_read_b128 v[120:123], v178 offset:0
    ds_read_b128 v[124:127], v179 offset:0
    ds_read_b128 v[128:131], v180 offset:0
    ds_read_b128 v[132:135], v181 offset:0
    s_add_u32 m0, s26, 36864
    s_nop 0
    buffer_load_dwordx4 v168, s[8:11], s28 offen lds
    v_mfma_f32_32x32x16_bf16 v[40:55], v[228:231], v[148:151], v[40:55]
    ds_read_b64_tr_b16 v[200:201], v174 offset:0
    ds_read_b64_tr_b16 v[202:203], v175 offset:1536
    ds_read_b64_tr_b16 v[204:205], v176 offset:0
    v_mfma_f32_32x32x16_bf16 v[56:71], v[232:235], v[148:151], v[56:71]
    ds_read_b64_tr_b16 v[206:207], v177 offset:1536
    ds_read_b64_tr_b16 v[208:209], v174 offset:128
    ds_read_b64_tr_b16 v[210:211], v175 offset:1664
    s_add_u32 m0, s26, 37888
    s_nop 0
    buffer_load_dwordx4 v169, s[8:11], s28 offen lds
    v_mfma_f32_32x32x16_bf16 v[72:87], v[236:239], v[148:151], v[72:87]
    ds_read_b64_tr_b16 v[212:213], v176 offset:128
    ds_read_b64_tr_b16 v[214:215], v177 offset:1664
    ds_read_b64_tr_b16 v[216:217], v174 offset:256
    v_mfma_f32_32x32x16_bf16 v[88:103], v[240:243], v[148:151], v[88:103]
    ds_read_b64_tr_b16 v[218:219], v175 offset:1792
    ds_read_b64_tr_b16 v[220:221], v176 offset:256
    ds_read_b64_tr_b16 v[222:223], v177 offset:1792
    s_add_u32 m0, s26, 38912
    s_nop 0
    buffer_load_dwordx4 v182, s[8:11], s28 offen lds
    s_add_u32 s28, s28, 393216
    s_cmp_eq_u32 s28, 7864320
    s_cselect_b32 s28, 0, s28
    v_mfma_f32_32x32x16_bf16 v[104:119], v[244:247], v[148:151], v[104:119]
    s_waitcnt lgkmcnt(10)
    v_mfma_f32_32x32x16_bf16 v[24:39], v[200:203], v[120:123], v[24:39]
    ds_read_b64_tr_b16 v[224:225], v174 offset:6144
    ds_read_b64_tr_b16 v[226:227], v175 offset:7680
    ds_read_b64_tr_b16 v[228:229], v176 offset:6144
    s_waitcnt lgkmcnt(11)
    v_mfma_f32_32x32x16_bf16 v[40:55], v[204:207], v[120:123], v[40:55]
    ds_read_b64_tr_b16 v[230:231], v177 offset:7680
    ds_read_b64_tr_b16 v[232:233], v174 offset:6272
    ds_read_b64_tr_b16 v[234:235], v175 offset:7808
    s_waitcnt lgkmcnt(12)
    v_mfma_f32_32x32x16_bf16 v[56:71], v[208:211], v[120:123], v[56:71]
    ds_read_b64_tr_b16 v[236:237], v176 offset:6272
    ds_read_b64_tr_b16 v[238:239], v177 offset:7808
    ds_read_b64_tr_b16 v[240:241], v174 offset:6400
    s_waitcnt lgkmcnt(13)
    v_mfma_f32_32x32x16_bf16 v[72:87], v[212:215], v[120:123], v[72:87]
    ds_read_b64_tr_b16 v[242:243], v175 offset:7936
    ds_read_b64_tr_b16 v[244:245], v176 offset:6400
    ds_read_b64_tr_b16 v[246:247], v177 offset:7936
    s_waitcnt lgkmcnt(14)
    v_mfma_f32_32x32x16_bf16 v[88:103], v[216:219], v[120:123], v[88:103]
    s_waitcnt lgkmcnt(12)
    v_mfma_f32_32x32x16_bf16 v[104:119], v[220:223], v[120:123], v[104:119]
    s_waitcnt vmcnt(10) lgkmcnt(0)
    s_barrier
    v_mfma_f32_32x32x16_bf16 v[24:39], v[224:227], v[124:127], v[24:39]
    ds_read_b64_tr_b16 v[200:201], v174 offset:12288
    ds_read_b64_tr_b16 v[202:203], v175 offset:13824
    ds_read_b64_tr_b16 v[204:205], v176 offset:12288
    s_add_u32 m0, s45, 49152
    s_mov_b32 s44, 0
    buffer_load_dwordx4 v2, s[12:15], s44 offen nt lds
    v_mfma_f32_32x32x16_bf16 v[40:55], v[228:231], v[124:127], v[40:55]
    ds_read_b64_tr_b16 v[206:207], v177 offset:13824
    ds_read_b64_tr_b16 v[208:209], v174 offset:12416
    ds_read_b64_tr_b16 v[210:211], v175 offset:13952
    s_add_u32 m0, s45, 50176
    s_mov_b32 s44, 0
    buffer_load_dwordx4 v3, s[12:15], s44 offen nt lds
    v_mfma_f32_32x32x16_bf16 v[56:71], v[232:235], v[124:127], v[56:71]
    ds_read_b64_tr_b16 v[212:213], v176 offset:12416
    ds_read_b64_tr_b16 v[214:215], v177 offset:13952
    ds_read_b64_tr_b16 v[216:217], v174 offset:12544
    s_add_u32 m0, s45, 51200
    s_mov_b32 s44, 0
    buffer_load_dwordx4 v4, s[12:15], s44 offen nt lds
    v_mfma_f32_32x32x16_bf16 v[72:87], v[236:239], v[124:127], v[72:87]
    ds_read_b64_tr_b16 v[218:219], v175 offset:14080
    ds_read_b64_tr_b16 v[220:221], v176 offset:12544
    ds_read_b64_tr_b16 v[222:223], v177 offset:14080
    s_add_u32 m0, s45, 61440
    s_mov_b32 s44, 12288
    buffer_load_dwordx4 v2, s[12:15], s44 offen nt lds
    v_mfma_f32_32x32x16_bf16 v[88:103], v[240:243], v[124:127], v[88:103]
    s_add_u32 m0, s45, 62464
    s_mov_b32 s44, 12288
    buffer_load_dwordx4 v3, s[12:15], s44 offen nt lds
    v_mfma_f32_32x32x16_bf16 v[104:119], v[244:247], v[124:127], v[104:119]
    s_add_u32 m0, s45, 63488
    s_mov_b32 s44, 12288
    buffer_load_dwordx4 v4, s[12:15], s44 offen nt lds
    s_waitcnt lgkmcnt(10)
    v_mfma_f32_32x32x16_bf16 v[24:39], v[200:203], v[128:131], v[24:39]
    ds_read_b64_tr_b16 v[224:225], v174 offset:18432
    ds_read_b64_tr_b16 v[226:227], v175 offset:19968
    ds_read_b64_tr_b16 v[228:229], v176 offset:18432
    s_waitcnt lgkmcnt(11)
    v_mfma_f32_32x32x16_bf16 v[40:55], v[204:207], v[128:131], v[40:55]
    ds_read_b64_tr_b16 v[230:231], v177 offset:19968
    ds_read_b64_tr_b16 v[232:233], v174 offset:18560
    ds_read_b64_tr_b16 v[234:235], v175 offset:20096
    s_waitcnt lgkmcnt(12)
    v_mfma_f32_32x32x16_bf16 v[56:71], v[208:211], v[128:131], v[56:71]
    ds_read_b64_tr_b16 v[236:237], v176 offset:18560
    ds_read_b64_tr_b16 v[238:239], v177 offset:20096
    ds_read_b64_tr_b16 v[240:241], v174 offset:18688
    s_waitcnt lgkmcnt(13)
    v_mfma_f32_32x32x16_bf16 v[72:87], v[212:215], v[128:131], v[72:87]
    ds_read_b64_tr_b16 v[242:243], v175 offset:20224
    ds_read_b64_tr_b16 v[244:245], v176 offset:18688
    ds_read_b64_tr_b16 v[246:247], v177 offset:20224
    s_waitcnt lgkmcnt(14)
    v_mfma_f32_32x32x16_bf16 v[88:103], v[216:219], v[128:131], v[88:103]
    s_waitcnt lgkmcnt(12)
    v_mfma_f32_32x32x16_bf16 v[104:119], v[220:223], v[128:131], v[104:119]
    s_waitcnt vmcnt(9) lgkmcnt(0)
    s_barrier
    v_mfma_f32_32x32x16_bf16 v[24:39], v[224:227], v[132:135], v[24:39]
    ds_read_b128 v[136:139], v178 offset:16384
    ds_read_b128 v[140:143], v179 offset:16384
    ds_read_b128 v[144:147], v180 offset:16384
    ds_read_b128 v[148:151], v181 offset:16384
    s_add_u32 m0, s45, 0
    s_mov_b32 s44, 0
    buffer_load_dwordx4 v2, s[16:19], s44 offen nt lds
    v_mfma_f32_32x32x16_bf16 v[40:55], v[228:231], v[132:135], v[40:55]
    ds_read_b64_tr_b16 v[200:201], v174 offset:24576
    ds_read_b64_tr_b16 v[202:203], v175 offset:26112
    ds_read_b64_tr_b16 v[204:205], v176 offset:24576
    s_add_u32 m0, s45, 1024
    s_mov_b32 s44, 0
    buffer_load_dwordx4 v3, s[16:19], s44 offen nt lds
    v_mfma_f32_32x32x16_bf16 v[56:71], v[232:235], v[132:135], v[56:71]
    ds_read_b64_tr_b16 v[206:207], v177 offset:26112
    ds_read_b64_tr_b16 v[208:209], v174 offset:24704
    ds_read_b64_tr_b16 v[210:211], v175 offset:26240
    s_add_u32 m0, s45, 2048
    s_mov_b32 s44, 0
    buffer_load_dwordx4 v4, s[16:19], s44 offen nt lds
    v_mfma_f32_32x32x16_bf16 v[72:87], v[236:239], v[132:135], v[72:87]
    ds_read_b64_tr_b16 v[212:213], v176 offset:24704
    ds_read_b64_tr_b16 v[214:215], v177 offset:26240
    ds_read_b64_tr_b16 v[216:217], v174 offset:24832
    s_add_u32 m0, s45, 12288
    s_mov_b32 s44, 12288
    buffer_load_dwordx4 v2, s[16:19], s44 offen nt lds
    v_mfma_f32_32x32x16_bf16 v[88:103], v[240:243], v[132:135], v[88:103]
    ds_read_b64_tr_b16 v[218:219], v175 offset:26368
    ds_read_b64_tr_b16 v[220:221], v176 offset:24832
    ds_read_b64_tr_b16 v[222:223], v177 offset:26368
    s_add_u32 m0, s45, 13312
    s_mov_b32 s44, 12288
    buffer_load_dwordx4 v3, s[16:19], s44 offen nt lds
    v_mfma_f32_32x32x16_bf16 v[104:119], v[244:247], v[132:135], v[104:119]
    s_add_u32 m0, s45, 14336
    s_mov_b32 s44, 12288
    buffer_load_dwordx4 v4, s[16:19], s44 offen nt lds
    s_waitcnt lgkmcnt(10)
    v_mfma_f32_32x32x16_bf16 v[24:39], v[200:203], v[136:139], v[24:39]
    ds_read_b64_tr_b16 v[224:225], v174 offset:30720
    ds_read_b64_tr_b16 v[226:227], v175 offset:32256
    ds_read_b64_tr_b16 v[228:229], v176 offset:30720
    s_waitcnt lgkmcnt(11)
    v_mfma_f32_32x32x16_bf16 v[40:55], v[204:207], v[136:139], v[40:55]
    ds_read_b64_tr_b16 v[230:231], v177 offset:32256
    ds_read_b64_tr_b16 v[232:233], v174 offset:30848
    ds_read_b64_tr_b16 v[234:235], v175 offset:32384
    s_waitcnt lgkmcnt(12)
    v_mfma_f32_32x32x16_bf16 v[56:71], v[208:211], v[136:139], v[56:71]
    ds_read_b64_tr_b16 v[236:237], v176 offset:30848
    ds_read_b64_tr_b16 v[238:239], v177 offset:32384
    ds_read_b64_tr_b16 v[240:241], v174 offset:30976
    s_waitcnt lgkmcnt(13)
    v_mfma_f32_32x32x16_bf16 v[72:87], v[212:215], v[136:139], v[72:87]
    ds_read_b64_tr_b16 v[242:243], v175 offset:32512
    ds_read_b64_tr_b16 v[244:245], v176 offset:30976
    ds_read_b64_tr_b16 v[246:247], v177 offset:32512
    s_waitcnt lgkmcnt(14)
    v_mfma_f32_32x32x16_bf16 v[88:103], v[216:219], v[136:139], v[88:103]
    s_waitcnt lgkmcnt(12)
    v_mfma_f32_32x32x16_bf16 v[104:119], v[220:223], v[136:139], v[104:119]
    s_waitcnt vmcnt(12) lgkmcnt(0)
    s_barrier
    v_mfma_f32_32x32x16_bf16 v[24:39], v[224:227], v[140:143], v[24:39]
    ds_read_b64_tr_b16 v[200:201], v174 offset:36864
    ds_read_b64_tr_b16 v[202:203], v175 offset:38400
    ds_read_b64_tr_b16 v[204:205], v176 offset:36864
    s_add_u32 m0, s45, 24576
    s_mov_b32 s44, 24576
    buffer_load_dwordx4 v2, s[12:15], s44 offen nt lds
    v_mfma_f32_32x32x16_bf16 v[40:55], v[228:231], v[140:143], v[40:55]
    ds_read_b64_tr_b16 v[206:207], v177 offset:38400
    ds_read_b64_tr_b16 v[208:209], v174 offset:36992
    ds_read_b64_tr_b16 v[210:211], v175 offset:38528
    v_mfma_f32_32x32x16_bf16 v[56:71], v[232:235], v[140:143], v[56:71]
    ds_read_b64_tr_b16 v[212:213], v176 offset:36992
    ds_read_b64_tr_b16 v[214:215], v177 offset:38528
    ds_read_b64_tr_b16 v[216:217], v174 offset:37120
    s_add_u32 m0, s45, 25600
    s_mov_b32 s44, 24576
    buffer_load_dwordx4 v3, s[12:15], s44 offen nt lds
    v_mfma_f32_32x32x16_bf16 v[72:87], v[236:239], v[140:143], v[72:87]
    ds_read_b64_tr_b16 v[218:219], v175 offset:38656
    ds_read_b64_tr_b16 v[220:221], v176 offset:37120
    ds_read_b64_tr_b16 v[222:223], v177 offset:38656
    v_mfma_f32_32x32x16_bf16 v[88:103], v[240:243], v[140:143], v[88:103]
    s_add_u32 m0, s45, 26624
    s_mov_b32 s44, 24576
    buffer_load_dwordx4 v4, s[12:15], s44 offen nt lds
    v_mfma_f32_32x32x16_bf16 v[104:119], v[244:247], v[140:143], v[104:119]
    s_waitcnt lgkmcnt(10)
    v_mfma_f32_32x32x16_bf16 v[24:39], v[200:203], v[144:147], v[24:39]
    ds_read_b64_tr_b16 v[224:225], v174 offset:43008
    ds_read_b64_tr_b16 v[226:227], v175 offset:44544
    ds_read_b64_tr_b16 v[228:229], v176 offset:43008
    s_waitcnt lgkmcnt(11)
    v_mfma_f32_32x32x16_bf16 v[40:55], v[204:207], v[144:147], v[40:55]
    ds_read_b64_tr_b16 v[230:231], v177 offset:44544
    ds_read_b64_tr_b16 v[232:233], v174 offset:43136
    ds_read_b64_tr_b16 v[234:235], v175 offset:44672
    s_waitcnt lgkmcnt(12)
    v_mfma_f32_32x32x16_bf16 v[56:71], v[208:211], v[144:147], v[56:71]
    ds_read_b64_tr_b16 v[236:237], v176 offset:43136
    ds_read_b64_tr_b16 v[238:239], v177 offset:44672
    ds_read_b64_tr_b16 v[240:241], v174 offset:43264
    s_waitcnt lgkmcnt(13)
    v_mfma_f32_32x32x16_bf16 v[72:87], v[212:215], v[144:147], v[72:87]
    ds_read_b64_tr_b16 v[242:243], v175 offset:44800
    ds_read_b64_tr_b16 v[244:245], v176 offset:43264
    ds_read_b64_tr_b16 v[246:247], v177 offset:44800
    s_waitcnt lgkmcnt(14)
    v_mfma_f32_32x32x16_bf16 v[88:103], v[216:219], v[144:147], v[88:103]
    s_waitcnt lgkmcnt(12)
    v_mfma_f32_32x32x16_bf16 v[104:119], v[220:223], v[144:147], v[104:119]
    s_waitcnt vmcnt(12) lgkmcnt(0)
    s_barrier
    v_add_u32 v13, s41, v5
    v_add_u32 v14, s41, v6
    v_add_u32 v15, s41, v7
    v_add_u32 v16, s41, v8
    v_mfma_f32_32x32x16_bf16 v[24:39], v[224:227], v[148:151], v[24:39]
    ds_read_b128 v[200:203], v13 offset:0
    ds_read_b128 v[204:207], v14 offset:0
    s_add_u32 m0, s45, 36864
    s_mov_b32 s44, 36864
    buffer_load_dwordx4 v2, s[12:15], s44 offen nt lds
    v_mfma_f32_32x32x16_bf16 v[40:55], v[228:231], v[148:151], v[40:55]
    ds_read_b128 v[208:211], v15 offset:0
    ds_read_b128 v[212:215], v16 offset:0
    v_mfma_f32_32x32x16_bf16 v[56:71], v[232:235], v[148:151], v[56:71]
    ds_read_b128 v[216:219], v13 offset:128
    s_add_u32 m0, s45, 37888
    s_mov_b32 s44, 36864
    buffer_load_dwordx4 v3, s[12:15], s44 offen nt lds
    v_mfma_f32_32x32x16_bf16 v[72:87], v[236:239], v[148:151], v[72:87]
    ds_read_b128 v[220:223], v14 offset:128
    v_mfma_f32_32x32x16_bf16 v[88:103], v[240:243], v[148:151], v[88:103]
    s_add_u32 m0, s45, 38912
    s_mov_b32 s44, 36864
    buffer_load_dwordx4 v4, s[12:15], s44 offen nt lds
    v_mfma_f32_32x32x16_bf16 v[104:119], v[244:247], v[148:151], v[104:119]
    s_branch L1_qj
L1_q0:
    s_waitcnt vmcnt(0) lgkmcnt(0)
    s_barrier
    ds_read_b128 v[120:123], v178 offset:0
    ds_read_b128 v[124:127], v179 offset:0
    ds_read_b128 v[128:131], v180 offset:0
    ds_read_b128 v[132:135], v181 offset:0
    ds_read_b64_tr_b16 v[200:201], v174 offset:0
    ds_read_b64_tr_b16 v[202:203], v175 offset:1536
    ds_read_b64_tr_b16 v[204:205], v176 offset:0
    ds_read_b64_tr_b16 v[206:207], v177 offset:1536
    ds_read_b64_tr_b16 v[208:209], v174 offset:128
    ds_read_b64_tr_b16 v[210:211], v175 offset:1664
    ds_read_b64_tr_b16 v[212:213], v176 offset:128
    ds_read_b64_tr_b16 v[214:215], v177 offset:1664
    ds_read_b64_tr_b16 v[216:217], v174 offset:256
    ds_read_b64_tr_b16 v[218:219], v175 offset:1792
    ds_read_b64_tr_b16 v[220:221], v176 offset:256
    ds_read_b64_tr_b16 v[222:223], v177 offset:1792
    s_waitcnt lgkmcnt(10)
    v_mfma_f32_32x32x16_bf16 v[24:39], v[200:203], v[120:123], v[24:39]
    ds_read_b64_tr_b16 v[224:225], v174 offset:6144
    ds_read_b64_tr_b16 v[226:227], v175 offset:7680
    ds_read_b64_tr_b16 v[228:229], v176 offset:6144
    s_add_u32 m0, s30, 16384
    s_nop 0
    buffer_load_dwordx4 v170, s[4:7], s29 offen lds
    s_add_u32 m0, s30, 17408
    s_nop 0
    buffer_load_dwordx4 v171, s[4:7], s29 offen lds
    s_waitcnt lgkmcnt(11)
    v_mfma_f32_32x32x16_bf16 v[40:55], v[204:207], v[120:123], v[40:55]
    ds_read_b64_tr_b16 v[230:231], v177 offset:7680
    ds_read_b64_tr_b16 v[232:233], v174 offset:6272
    ds_read_b64_tr_b16 v[234:235], v175 offset:7808
    s_add_u32 m0, s30, 18432
    s_nop 0
    buffer_load_dwordx4 v172, s[4:7], s29 offen lds
    s_add_u32 m0, s30, 19456
    s_nop 0
    buffer_load_dwordx4 v173, s[4:7], s29 offen lds
    s_add_u32 s29, s29, 128
    s_cmp_eq_u32 s29, 1280
    s_cselect_b32 s29, 0, s29
    s_waitcnt lgkmcnt(12)
    v_mfma_f32_32x32x16_bf16 v[56:71], v[208:211], v[120:123], v[56:71]
    ds_read_b64_tr_b16 v[236:237], v176 offset:6272
    ds_read_b64_tr_b16 v[238:239], v177 offset:7808
    ds_read_b64_tr_b16 v[240:241], v174 offset:6400
    s_add_u32 m0, s30, 0
    s_nop 0
    buffer_load_dwordx4 v170, s[4:7], s29 offen lds
    s_waitcnt lgkmcnt(13)
    v_mfma_f32_32x32x16_bf16 v[72:87], v[212:215], v[120:123], v[72:87]
    ds_read_b64_tr_b16 v[242:243], v175 offset:7936
    ds_read_b64_tr_b16 v[244:245], v176 offset:6400
    ds_read_b64_tr_b16 v[246:247], v177 offset:7936
    s_add_u32 m0, s30, 1024
    s_nop 0
    buffer_load_dwordx4 v171, s[4:7], s29 offen lds
    s_add_u32 m0, s30, 2048
    s_nop 0
    buffer_load_dwordx4 v172, s[4:7], s29 offen lds
    s_waitcnt lgkmcnt(14)
    v_mfma_f32_32x32x16_bf16 v[88:103], v[216:219], v[120:123], v[88:103]
    s_add_u32 m0, s30, 3072
    s_nop 0
    buffer_load_dwordx4 v173, s[4:7], s29 offen lds
    s_add_u32 s29, s29, 128
    s_cmp_eq_u32 s29, 1280
    s_cselect_b32 s29, 0, s29
    s_waitcnt lgkmcnt(12)
    v_mfma_f32_32x32x16_bf16 v[104:119], v[220:223], v[120:123], v[104:119]
    s_waitcnt vmcnt(63) lgkmcnt(0)
    s_barrier
    v_mfma_f32_32x32x16_bf16 v[24:39], v[224:227], v[124:127], v[24:39]
    ds_read_b64_tr_b16 v[200:201], v174 offset:12288
    ds_read_b64_tr_b16 v[202:203], v175 offset:13824
    ds_read_b64_tr_b16 v[204:205], v176 offset:12288
    v_mfma_f32_32x32x16_bf16 v[40:55], v[228:231], v[124:127], v[40:55]
    ds_read_b64_tr_b16 v[206:207], v177 offset:13824
    ds_read_b64_tr_b16 v[208:209], v174 offset:12416
    ds_read_b64_tr_b16 v[210:211], v175 offset:13952
    v_mfma_f32_32x32x16_bf16 v[56:71], v[232:235], v[124:127], v[56:71]
    ds_read_b64_tr_b16 v[212:213], v176 offset:12416
    ds_read_b64_tr_b16 v[214:215], v177 offset:13952
    ds_read_b64_tr_b16 v[216:217], v174 offset:12544
    v_mfma_f32_32x32x16_bf16 v[72:87], v[236:239], v[124:127], v[72:87]
    ds_read_b64_tr_b16 v[218:219], v175 offset:14080
    ds_read_b64_tr_b16 v[220:221], v176 offset:12544
    ds_read_b64_tr_b16 v[222:223], v177 offset:14080
    v_mfma_f32_32x32x16_bf16 v[88:103], v[240:243], v[124:127], v[88:103]
    v_mfma_f32_32x32x16_bf16 v[104:119], v[244:247], v[124:127], v[104:119]
    s_waitcnt lgkmcnt(10)
    v_mfma_f32_32x32x16_bf16 v[24:39], v[200:203], v[128:131], v[24:39]
    ds_read_b64_tr_b16 v[224:225], v174 offset:18432
    ds_read_b64_tr_b16 v[226:227], v175 offset:19968
    ds_read_b64_tr_b16 v[228:229], v176 offset:18432
    s_waitcnt lgkmcnt(11)
    v_mfma_f32_32x32x16_bf16 v[40:55], v[204:207], v[128:131], v[40:55]
    ds_read_b64_tr_b16 v[230:231], v177 offset:19968
    ds_read_b64_tr_b16 v[232:233], v174 offset:18560
    ds_read_b64_tr_b16 v[234:235], v175 offset:20096
    s_waitcnt lgkmcnt(12)
    v_mfma_f32_32x32x16_bf16 v[56:71], v[208:211], v[128:131], v[56:71]
    ds_read_b64_tr_b16 v[236:237], v176 offset:18560
    ds_read_b64_tr_b16 v[238:239], v177 offset:20096
    ds_read_b64_tr_b16 v[240:241], v174 offset:18688
    s_waitcnt lgkmcnt(13)
    v_mfma_f32_32x32x16_bf16 v[72:87], v[212:215], v[128:131], v[72:87]
    ds_read_b64_tr_b16 v[242:243], v175 offset:20224
    ds_read_b64_tr_b16 v[244:245], v176 offset:18688
    ds_read_b64_tr_b16 v[246:247], v177 offset:20224
    s_waitcnt lgkmcnt(14)
    v_mfma_f32_32x32x16_bf16 v[88:103], v[216:219], v[128:131], v[88:103]
    s_waitcnt lgkmcnt(12)
    v_mfma_f32_32x32x16_bf16 v[104:119], v[220:223], v[128:131], v[104:119]
    s_waitcnt vmcnt(4) lgkmcnt(0)
    s_barrier
    v_mfma_f32_32x32x16_bf16 v[24:39], v[224:227], v[132:135], v[24:39]
    ds_read_b128 v[136:139], v178 offset:16384
    ds_read_b128 v[140:143], v179 offset:16384
    ds_read_b128 v[144:147], v180 offset:16384
    ds_read_b128 v[148:151], v181 offset:16384
    v_mfma_f32_32x32x16_bf16 v[40:55], v[228:231], v[132:135], v[40:55]
    ds_read_b64_tr_b16 v[200:201], v174 offset:24576
    ds_read_b64_tr_b16 v[202:203], v175 offset:26112
    ds_read_b64_tr_b16 v[204:205], v176 offset:24576
    v_mfma_f32_32x32x16_bf16 v[56:71], v[232:235], v[132:135], v[56:71]
    ds_read_b64_tr_b16 v[206:207], v177 offset:26112
    ds_read_b64_tr_b16 v[208:209], v174 offset:24704
    ds_read_b64_tr_b16 v[210:211], v175 offset:26240
    v_mfma_f32_32x32x16_bf16 v[72:87], v[236:239], v[132:135], v[72:87]
    ds_read_b64_tr_b16 v[212:213], v176 offset:24704
    ds_read_b64_tr_b16 v[214:215], v177 offset:26240
    ds_read_b64_tr_b16 v[216:217], v174 offset:24832
    v_mfma_f32_32x32x16_bf16 v[88:103], v[240:243], v[132:135], v[88:103]
    ds_read_b64_tr_b16 v[218:219], v175 offset:26368
    ds_read_b64_tr_b16 v[220:221], v176 offset:24832
    ds_read_b64_tr_b16 v[222:223], v177 offset:26368
    v_mfma_f32_32x32x16_bf16 v[104:119], v[244:247], v[132:135], v[104:119]
    s_waitcnt lgkmcnt(10)
    v_mfma_f32_32x32x16_bf16 v[24:39], v[200:203], v[136:139], v[24:39]
    ds_read_b64_tr_b16 v[224:225], v174 offset:30720
    ds_read_b64_tr_b16 v[226:227], v175 offset:32256
    ds_read_b64_tr_b16 v[228:229], v176 offset:30720
    s_add_u32 m0, s30, 16384
    s_nop 0
    buffer_load_dwordx4 v170, s[4:7], s29 offen lds
    s_waitcnt lgkmcnt(11)
    v_mfma_f32_32x32x16_bf16 v[40:55], v[204:207], v[136:139], v[40:55]
    ds_read_b64_tr_b16 v[230:231], v177 offset:32256
    ds_read_b64_tr_b16 v[232:233], v174 offset:30848
    ds_read_b64_tr_b16 v[234:235], v175 offset:32384
    s_add_u32 m0, s30, 17408
    s_nop 0
    buffer_load_dwordx4 v171, s[4:7], s29 offen lds
    s_waitcnt lgkmcnt(12)
    v_mfma_f32_32x32x16_bf16 v[56:71], v[208:211], v[136:139], v[56:71]
    ds_read_b64_tr_b16 v[236:237], v176 offset:30848
    ds_read_b64_tr_b16 v[238:239], v177 offset:32384
    ds_read_b64_tr_b16 v[240:241], v174 offset:30976
    s_add_u32 m0, s30, 18432
    s_nop 0
    buffer_load_dwordx4 v172, s[4:7], s29 offen lds
    s_waitcnt lgkmcnt(13)
    v_mfma_f32_32x32x16_bf16 v[72:87], v[212:215], v[136:139], v[72:87]
    ds_read_b64_tr_b16 v[242:243], v175 offset:32512
    ds_read_b64_tr_b16 v[244:245], v176 offset:30976
    ds_read_b64_tr_b16 v[246:247], v177 offset:32512
    s_add_u32 m0, s30, 19456
    s_nop 0
    buffer_load_dwordx4 v173, s[4:7], s29 offen lds
    s_add_u32 s29, s29, 128
    s_cmp_eq_u32 s29, 1280
    s_cselect_b32 s29, 0, s29
    s_waitcnt lgkmcnt(14)
    v_mfma_f32_32x32x16_bf16 v[88:103], v[216:219], v[136:139], v[88:103]
    s_waitcnt lgkmcnt(12)
    v_mfma_f32_32x32x16_bf16 v[104:119], v[220:223], v[136:139], v[104:119]
    s_waitcnt vmcnt(63) lgkmcnt(0)
    s_barrier
    v_mfma_f32_32x32x16_bf16 v[24:39], v[224:227], v[140:143], v[24:39]
    ds_read_b64_tr_b16 v[200:201], v174 offset:36864
    ds_read_b64_tr_b16 v[202:203], v175 offset:38400
    ds_read_b64_tr_b16 v[204:205], v176 offset:36864
    v_mfma_f32_32x32x16_bf16 v[40:55], v[228:231], v[140:143], v[40:55]
    ds_read_b64_tr_b16 v[206:207], v177 offset:38400
    ds_read_b64_tr_b16 v[208:209], v174 offset:36992
    ds_read_b64_tr_b16 v[210:211], v175 offset:38528
    v_mfma_f32_32x32x16_bf16 v[56:71], v[232:235], v[140:143], v[56:71]
    ds_read_b64_tr_b16 v[212:213], v176 offset:36992
    ds_read_b64_tr_b16 v[214:215], v177 offset:38528
    ds_read_b64_tr_b16 v[216:217], v174 offset:37120
    v_mfma_f32_32x32x16_bf16 v[72:87], v[236:239], v[140:143], v[72:87]
    ds_read_b64_tr_b16 v[218:219], v175 offset:38656
    ds_read_b64_tr_b16 v[220:221], v176 offset:37120
    ds_read_b64_tr_b16 v[222:223], v177 offset:38656
    v_mfma_f32_32x32x16_bf16 v[88:103], v[240:243], v[140:143], v[88:103]
    v_mfma_f32_32x32x16_bf16 v[104:119], v[244:247], v[140:143], v[104:119]
    s_waitcnt lgkmcnt(10)
    v_mfma_f32_32x32x16_bf16 v[24:39], v[200:203], v[144:147], v[24:39]
    ds_read_b64_tr_b16 v[224:225], v174 offset:43008
    ds_read_b64_tr_b16 v[226:227], v175 offset:44544
    ds_read_b64_tr_b16 v[228:229], v176 offset:43008
    s_waitcnt lgkmcnt(11)
    v_mfma_f32_32x32x16_bf16 v[40:55], v[204:207], v[144:147], v[40:55]
    ds_read_b64_tr_b16 v[230:231], v177 offset:44544
    ds_read_b64_tr_b16 v[232:233], v174 offset:43136
    ds_read_b64_tr_b16 v[234:235], v175 offset:44672
    s_waitcnt lgkmcnt(12)
    v_mfma_f32_32x32x16_bf16 v[56:71], v[208:211], v[144:147], v[56:71]
    ds_read_b64_tr_b16 v[236:237], v176 offset:43136
    ds_read_b64_tr_b16 v[238:239], v177 offset:44672
    ds_read_b64_tr_b16 v[240:241], v174 offset:43264
    s_waitcnt lgkmcnt(13)
    v_mfma_f32_32x32x16_bf16 v[72:87], v[212:215], v[144:147], v[72:87]
    ds_read_b64_tr_b16 v[242:243], v175 offset:44800
    ds_read_b64_tr_b16 v[244:245], v176 offset:43264
    ds_read_b64_tr_b16 v[246:247], v177 offset:44800
    s_waitcnt lgkmcnt(14)
    v_mfma_f32_32x32x16_bf16 v[88:103], v[216:219], v[144:147], v[88:103]
    s_waitcnt lgkmcnt(12)
    v_mfma_f32_32x32x16_bf16 v[104:119], v[220:223], v[144:147], v[104:119]
    s_waitcnt vmcnt(4) lgkmcnt(0)
    s_barrier
    v_mfma_f32_32x32x16_bf16 v[24:39], v[224:227], v[148:151], v[24:39]
    ds_read_b128 v[120:123], v178 offset:0
    ds_read_b128 v[124:127], v179 offset:0
    ds_read_b128 v[128:131], v180 offset:0
    ds_read_b128 v[132:135], v181 offset:0
    v_mfma_f32_32x32x16_bf16 v[40:55], v[228:231], v[148:151], v[40:55]
    ds_read_b64_tr_b16 v[200:201], v174 offset:0
    ds_read_b64_tr_b16 v[202:203], v175 offset:1536
    ds_read_b64_tr_b16 v[204:205], v176 offset:0
    v_mfma_f32_32x32x16_bf16 v[56:71], v[232:235], v[148:151], v[56:71]
    ds_read_b64_tr_b16 v[206:207], v177 offset:1536
    ds_read_b64_tr_b16 v[208:209], v174 offset:128
    ds_read_b64_tr_b16 v[210:211], v175 offset:1664
    v_mfma_f32_32x32x16_bf16 v[72:87], v[236:239], v[148:151], v[72:87]
    ds_read_b64_tr_b16 v[212:213], v176 offset:128
    ds_read_b64_tr_b16 v[214:215], v177 offset:1664
    ds_read_b64_tr_b16 v[216:217], v174 offset:256
    v_mfma_f32_32x32x16_bf16 v[88:103], v[240:243], v[148:151], v[88:103]
    ds_read_b64_tr_b16 v[218:219], v175 offset:1792
    ds_read_b64_tr_b16 v[220:221], v176 offset:256
    ds_read_b64_tr_b16 v[222:223], v177 offset:1792
    v_mfma_f32_32x32x16_bf16 v[104:119], v[244:247], v[148:151], v[104:119]
    s_waitcnt lgkmcnt(10)
    v_mfma_f32_32x32x16_bf16 v[24:39], v[200:203], v[120:123], v[24:39]
    ds_read_b64_tr_b16 v[224:225], v174 offset:6144
    ds_read_b64_tr_b16 v[226:227], v175 offset:7680
    ds_read_b64_tr_b16 v[228:229], v176 offset:6144
    s_add_u32 m0, s30, 0
    s_nop 0
    buffer_load_dwordx4 v170, s[4:7], s29 offen lds
    s_waitcnt lgkmcnt(11)
    v_mfma_f32_32x32x16_bf16 v[40:55], v[204:207], v[120:123], v[40:55]
    ds_read_b64_tr_b16 v[230:231], v177 offset:7680
    ds_read_b64_tr_b16 v[232:233], v174 offset:6272
    ds_read_b64_tr_b16 v[234:235], v175 offset:7808
    s_add_u32 m0, s30, 1024
    s_nop 0
    buffer_load_dwordx4 v171, s[4:7], s29 offen lds
    s_waitcnt lgkmcnt(12)
    v_mfma_f32_32x32x16_bf16 v[56:71], v[208:211], v[120:123], v[56:71]
    ds_read_b64_tr_b16 v[236:237], v176 offset:6272
    ds_read_b64_tr_b16 v[238:239], v177 offset:7808
    ds_read_b64_tr_b16 v[240:241], v174 offset:6400
    s_add_u32 m0, s30, 2048
    s_nop 0
    buffer_load_dwordx4 v172, s[4:7], s29 offen lds
    s_waitcnt lgkmcnt(13)
    v_mfma_f32_32x32x16_bf16 v[72:87], v[212:215], v[120:123], v[72:87]
    ds_read_b64_tr_b16 v[242:243], v175 offset:7936
    ds_read_b64_tr_b16 v[244:245], v176 offset:6400
    ds_read_b64_tr_b16 v[246:247], v177 offset:7936
    s_add_u32 m0, s30, 3072
    s_nop 0
    buffer_load_dwordx4 v173, s[4:7], s29 offen lds
    s_add_u32 s29, s29, 128
    s_cmp_eq_u32 s29, 1280
    s_cselect_b32 s29, 0, s29
    s_waitcnt lgkmcnt(14)
    v_mfma_f32_32x32x16_bf16 v[88:103], v[216:219], v[120:123], v[88:103]
    s_waitcnt lgkmcnt(12)
    v_mfma_f32_32x32x16_bf16 v[104:119], v[220:223], v[120:123], v[104:119]
    s_waitcnt vmcnt(63) lgkmcnt(0)
    s_barrier
    v_mfma_f32_32x32x16_bf16 v[24:39], v[224:227], v[124:127], v[24:39]
    ds_read_b64_tr_b16 v[200:201], v174 offset:12288
    ds_read_b64_tr_b16 v[202:203], v175 offset:13824
    ds_read_b64_tr_b16 v[204:205], v176 offset:12288
    v_mfma_f32_32x32x16_bf16 v[40:55], v[228:231], v[124:127], v[40:55]
    ds_read_b64_tr_b16 v[206:207], v177 offset:13824
    ds_read_b64_tr_b16 v[208:209], v174 offset:12416
    ds_read_b64_tr_b16 v[210:211], v175 offset:13952
    v_mfma_f32_32x32x16_bf16 v[56:71], v[232:235], v[124:127], v[56:71]
    ds_read_b64_tr_b16 v[212:213], v176 offset:12416
    ds_read_b64_tr_b16 v[214:215], v177 offset:13952
    ds_read_b64_tr_b16 v[216:217], v174 offset:12544
    v_mfma_f32_32x32x16_bf16 v[72:87], v[236:239], v[124:127], v[72:87]
    ds_read_b64_tr_b16 v[218:219], v175 offset:14080
    ds_read_b64_tr_b16 v[220:221], v176 offset:12544
    ds_read_b64_tr_b16 v[222:223], v177 offset:14080
    v_mfma_f32_32x32x16_bf16 v[88:103], v[240:243], v[124:127], v[88:103]
    v_mfma_f32_32x32x16_bf16 v[104:119], v[244:247], v[124:127], v[104:119]
    s_cmp_lg_u32 s27, 0
    s_cbranch_scc1 L1_ni
    s_lshr_b32 s59, s2, 6
    s_lshl_b32 s59, s59, 3
    s_and_b32 s82, s2, 7
    s_add_u32 s59, s59, s82
    s_lshl_b32 s59, s59, 2
    s_getreg_b32 s82, hwreg(HW_REG_XCC_ID, 0, 4)
    s_and_b32 s82, s82, 7
    s_lshl_b32 s82, s82, 2
    s_lshl_b32 s83, 1, s82
    v_mov_b32 v186, 0
    v_mov_b32 v187, s83
    s_lshl_b32 s83, s83, 3
    s_mov_b64 exec, 1
    buffer_atomic_add v187, v186, s[92:95], s59 offen sc1
    s_mov_b64 exec, -1
L1_ni:
    s_waitcnt lgkmcnt(10)
    v_mfma_f32_32x32x16_bf16 v[24:39], v[200:203], v[128:131], v[24:39]
    ds_read_b64_tr_b16 v[224:225], v174 offset:18432
    ds_read_b64_tr_b16 v[226:227], v175 offset:19968
    ds_read_b64_tr_b16 v[228:229], v176 offset:18432
    s_waitcnt lgkmcnt(11)
    v_mfma_f32_32x32x16_bf16 v[40:55], v[204:207], v[128:131], v[40:55]
    ds_read_b64_tr_b16 v[230:231], v177 offset:19968
    ds_read_b64_tr_b16 v[232:233], v174 offset:18560
    ds_read_b64_tr_b16 v[234:235], v175 offset:20096
    s_waitcnt lgkmcnt(12)
    v_mfma_f32_32x32x16_bf16 v[56:71], v[208:211], v[128:131], v[56:71]
    ds_read_b64_tr_b16 v[236:237], v176 offset:18560
    ds_read_b64_tr_b16 v[238:239], v177 offset:20096
    ds_read_b64_tr_b16 v[240:241], v174 offset:18688
    s_waitcnt lgkmcnt(13)
    v_mfma_f32_32x32x16_bf16 v[72:87], v[212:215], v[128:131], v[72:87]
    ds_read_b64_tr_b16 v[242:243], v175 offset:20224
    ds_read_b64_tr_b16 v[244:245], v176 offset:18688
    ds_read_b64_tr_b16 v[246:247], v177 offset:20224
    s_waitcnt lgkmcnt(14)
    v_mfma_f32_32x32x16_bf16 v[88:103], v[216:219], v[128:131], v[88:103]
    s_waitcnt lgkmcnt(12)
    v_mfma_f32_32x32x16_bf16 v[104:119], v[220:223], v[128:131], v[104:119]
    s_waitcnt vmcnt(4) lgkmcnt(0)
    s_barrier
    v_mfma_f32_32x32x16_bf16 v[24:39], v[224:227], v[132:135], v[24:39]
    ds_read_b128 v[136:139], v178 offset:16384
    ds_read_b128 v[140:143], v179 offset:16384
    ds_read_b128 v[144:147], v180 offset:16384
    ds_read_b128 v[148:151], v181 offset:16384
    v_mfma_f32_32x32x16_bf16 v[40:55], v[228:231], v[132:135], v[40:55]
    ds_read_b64_tr_b16 v[200:201], v174 offset:24576
    ds_read_b64_tr_b16 v[202:203], v175 offset:26112
    ds_read_b64_tr_b16 v[204:205], v176 offset:24576
    v_mfma_f32_32x32x16_bf16 v[56:71], v[232:235], v[132:135], v[56:71]
    ds_read_b64_tr_b16 v[206:207], v177 offset:26112
    ds_read_b64_tr_b16 v[208:209], v174 offset:24704
    ds_read_b64_tr_b16 v[210:211], v175 offset:26240
    v_mfma_f32_32x32x16_bf16 v[72:87], v[236:239], v[132:135], v[72:87]
    ds_read_b64_tr_b16 v[212:213], v176 offset:24704
    ds_read_b64_tr_b16 v[214:215], v177 offset:26240
    ds_read_b64_tr_b16 v[216:217], v174 offset:24832
    v_mfma_f32_32x32x16_bf16 v[88:103], v[240:243], v[132:135], v[88:103]
    ds_read_b64_tr_b16 v[218:219], v175 offset:26368
    ds_read_b64_tr_b16 v[220:221], v176 offset:24832
    ds_read_b64_tr_b16 v[222:223], v177 offset:26368
    v_mfma_f32_32x32x16_bf16 v[104:119], v[244:247], v[132:135], v[104:119]
    s_waitcnt lgkmcnt(10)
    v_mfma_f32_32x32x16_bf16 v[24:39], v[200:203], v[136:139], v[24:39]
    ds_read_b64_tr_b16 v[224:225], v174 offset:30720
    ds_read_b64_tr_b16 v[226:227], v175 offset:32256
    ds_read_b64_tr_b16 v[228:229], v176 offset:30720
    s_add_u32 m0, s30, 16384
    s_nop 0
    buffer_load_dwordx4 v170, s[4:7], s29 offen lds
    s_waitcnt lgkmcnt(11)
    v_mfma_f32_32x32x16_bf16 v[40:55], v[204:207], v[136:139], v[40:55]
    ds_read_b64_tr_b16 v[230:231], v177 offset:32256
    ds_read_b64_tr_b16 v[232:233], v174 offset:30848
    ds_read_b64_tr_b16 v[234:235], v175 offset:32384
    s_add_u32 m0, s30, 17408
    s_nop 0
    buffer_load_dwordx4 v171, s[4:7], s29 offen lds
    s_waitcnt lgkmcnt(12)
    v_mfma_f32_32x32x16_bf16 v[56:71], v[208:211], v[136:139], v[56:71]
    ds_read_b64_tr_b16 v[236:237], v176 offset:30848
    ds_read_b64_tr_b16 v[238:239], v177 offset:32384
    ds_read_b64_tr_b16 v[240:241], v174 offset:30976
    s_add_u32 m0, s30, 18432
    s_nop 0
    buffer_load_dwordx4 v172, s[4:7], s29 offen lds
    s_waitcnt lgkmcnt(13)
    v_mfma_f32_32x32x16_bf16 v[72:87], v[212:215], v[136:139], v[72:87]
    ds_read_b64_tr_b16 v[242:243], v175 offset:32512
    ds_read_b64_tr_b16 v[244:245], v176 offset:30976
    ds_read_b64_tr_b16 v[246:247], v177 offset:32512
    s_add_u32 m0, s30, 19456
    s_nop 0
    buffer_load_dwordx4 v173, s[4:7], s29 offen lds
    s_add_u32 s29, s29, 128
    s_cmp_eq_u32 s29, 1280
    s_cselect_b32 s29, 0, s29
    s_waitcnt lgkmcnt(14)
    v_mfma_f32_32x32x16_bf16 v[88:103], v[216:219], v[136:139], v[88:103]
    s_waitcnt lgkmcnt(12)
    v_mfma_f32_32x32x16_bf16 v[104:119], v[220:223], v[136:139], v[104:119]
    s_waitcnt vmcnt(63) lgkmcnt(0)
    s_barrier
    v_mfma_f32_32x32x16_bf16 v[24:39], v[224:227], v[140:143], v[24:39]
    ds_read_b64_tr_b16 v[200:201], v174 offset:36864
    ds_read_b64_tr_b16 v[202:203], v175 offset:38400
    ds_read_b64_tr_b16 v[204:205], v176 offset:36864
    v_mfma_f32_32x32x16_bf16 v[40:55], v[228:231], v[140:143], v[40:55]
    ds_read_b64_tr_b16 v[206:207], v177 offset:38400
    ds_read_b64_tr_b16 v[208:209], v174 offset:36992
    ds_read_b64_tr_b16 v[210:211], v175 offset:38528
    v_mfma_f32_32x32x16_bf16 v[56:71], v[232:235], v[140:143], v[56:71]
    ds_read_b64_tr_b16 v[212:213], v176 offset:36992
    ds_read_b64_tr_b16 v[214:215], v177 offset:38528
    ds_read_b64_tr_b16 v[216:217], v174 offset:37120
    v_mfma_f32_32x32x16_bf16 v[72:87], v[236:239], v[140:143], v[72:87]
    ds_read_b64_tr_b16 v[218:219], v175 offset:38656
    ds_read_b64_tr_b16 v[220:221], v176 offset:37120
    ds_read_b64_tr_b16 v[222:223], v177 offset:38656
    v_mfma_f32_32x32x16_bf16 v[88:103], v[240:243], v[140:143], v[88:103]
    v_mfma_f32_32x32x16_bf16 v[104:119], v[244:247], v[140:143], v[104:119]
    s_waitcnt lgkmcnt(10)
    v_mfma_f32_32x32x16_bf16 v[24:39], v[200:203], v[144:147], v[24:39]
    ds_read_b64_tr_b16 v[224:225], v174 offset:43008
    ds_read_b64_tr_b16 v[226:227], v175 offset:44544
    ds_read_b64_tr_b16 v[228:229], v176 offset:43008
    s_add_u32 m0, s45, 0
    s_mov_b32 s44, 0
    buffer_load_dwordx4 v2, s[12:15], s44 offen nt lds
    s_waitcnt lgkmcnt(11)
    v_mfma_f32_32x32x16_bf16 v[40:55], v[204:207], v[144:147], v[40:55]
    ds_read_b64_tr_b16 v[230:231], v177 offset:44544
    ds_read_b64_tr_b16 v[232:233], v174 offset:43136
    ds_read_b64_tr_b16 v[234:235], v175 offset:44672
    s_add_u32 m0, s45, 1024
    s_mov_b32 s44, 0
    buffer_load_dwordx4 v3, s[12:15], s44 offen nt lds
    s_waitcnt lgkmcnt(12)
    v_mfma_f32_32x32x16_bf16 v[56:71], v[208:211], v[144:147], v[56:71]
    ds_read_b64_tr_b16 v[236:237], v176 offset:43136
    ds_read_b64_tr_b16 v[238:239], v177 offset:44672
    ds_read_b64_tr_b16 v[240:241], v174 offset:43264
    s_waitcnt lgkmcnt(13)
    v_mfma_f32_32x32x16_bf16 v[72:87], v[212:215], v[144:147], v[72:87]
    ds_read_b64_tr_b16 v[242:243], v175 offset:44800
    ds_read_b64_tr_b16 v[244:245], v176 offset:43264
    ds_read_b64_tr_b16 v[246:247], v177 offset:44800
    s_add_u32 m0, s45, 2048
    s_mov_b32 s44, 0
    buffer_load_dwordx4 v4, s[12:15], s44 offen nt lds
    s_waitcnt lgkmcnt(14)
    v_mfma_f32_32x32x16_bf16 v[88:103], v[216:219], v[144:147], v[88:103]
    s_waitcnt lgkmcnt(12)
    v_mfma_f32_32x32x16_bf16 v[104:119], v[220:223], v[144:147], v[104:119]
    s_waitcnt vmcnt(7) lgkmcnt(0)
    s_barrier
    v_mfma_f32_32x32x16_bf16 v[24:39], v[224:227], v[148:151], v[24:39]
    ds_read_b128 v[120:123], v178 offset:0
    ds_read_b128 v[124:127], v179 offset:0
    ds_read_b128 v[128:131], v180 offset:0
    ds_read_b128 v[132:135], v181 offset:0
    v_mfma_f32_32x32x16_bf16 v[40:55], v[228:231], v[148:151], v[40:55]
    ds_read_b64_tr_b16 v[200:201], v174 offset:0
    ds_read_b64_tr_b16 v[202:203], v175 offset:1536
    ds_read_b64_tr_b16 v[204:205], v176 offset:0
    v_mfma_f32_32x32x16_bf16 v[56:71], v[232:235], v[148:151], v[56:71]
    ds_read_b64_tr_b16 v[206:207], v177 offset:1536
    ds_read_b64_tr_b16 v[208:209], v174 offset:128
    ds_read_b64_tr_b16 v[210:211], v175 offset:1664
    v_mfma_f32_32x32x16_bf16 v[72:87], v[236:239], v[148:151], v[72:87]
    ds_read_b64_tr_b16 v[212:213], v176 offset:128
    ds_read_b64_tr_b16 v[214:215], v177 offset:1664
    ds_read_b64_tr_b16 v[216:217], v174 offset:256
    v_mfma_f32_32x32x16_bf16 v[88:103], v[240:243], v[148:151], v[88:103]
    ds_read_b64_tr_b16 v[218:219], v175 offset:1792
    ds_read_b64_tr_b16 v[220:221], v176 offset:256
    ds_read_b64_tr_b16 v[222:223], v177 offset:1792
    v_mfma_f32_32x32x16_bf16 v[104:119], v[244:247], v[148:151], v[104:119]
    s_waitcnt lgkmcnt(10)
    v_mfma_f32_32x32x16_bf16 v[24:39], v[200:203], v[120:123], v[24:39]
    ds_read_b64_tr_b16 v[224:225], v174 offset:6144
    ds_read_b64_tr_b16 v[226:227], v175 offset:7680
    ds_read_b64_tr_b16 v[228:229], v176 offset:6144
    s_add_u32 m0, s30, 0
    s_nop 0
    buffer_load_dwordx4 v170, s[4:7], s29 offen lds
    s_waitcnt lgkmcnt(11)
    v_mfma_f32_32x32x16_bf16 v[40:55], v[204:207], v[120:123], v[40:55]
    ds_read_b64_tr_b16 v[230:231], v177 offset:7680
    ds_read_b64_tr_b16 v[232:233], v174 offset:6272
    ds_read_b64_tr_b16 v[234:235], v175 offset:7808
    s_add_u32 m0, s30, 1024
    s_nop 0
    buffer_load_dwordx4 v171, s[4:7], s29 offen lds
    s_waitcnt lgkmcnt(12)
    v_mfma_f32_32x32x16_bf16 v[56:71], v[208:211], v[120:123], v[56:71]
    ds_read_b64_tr_b16 v[236:237], v176 offset:6272
    ds_read_b64_tr_b16 v[238:239], v177 offset:7808
    ds_read_b64_tr_b16 v[240:241], v174 offset:6400
    s_add_u32 m0, s30, 2048
    s_nop 0
    buffer_load_dwordx4 v172, s[4:7], s29 offen lds
    s_waitcnt lgkmcnt(13)
    v_mfma_f32_32x32x16_bf16 v[72:87], v[212:215], v[120:123], v[72:87]
    ds_read_b64_tr_b16 v[242:243], v175 offset:7936
    ds_read_b64_tr_b16 v[244:245], v176 offset:6400
    ds_read_b64_tr_b16 v[246:247], v177 offset:7936
    s_add_u32 m0, s30, 3072
    s_nop 0
    buffer_load_dwordx4 v173, s[4:7], s29 offen lds
    s_add_u32 s29, s29, 128
    s_cmp_eq_u32 s29, 1280
    s_cselect_b32 s29, 0, s29
    s_waitcnt lgkmcnt(14)
    v_mfma_f32_32x32x16_bf16 v[88:103], v[216:219], v[120:123], v[88:103]
    s_waitcnt lgkmcnt(12)
    v_mfma_f32_32x32x16_bf16 v[104:119], v[220:223], v[120:123], v[104:119]
    s_waitcnt vmcnt(63) lgkmcnt(0)
    s_barrier
    v_mfma_f32_32x32x16_bf16 v[24:39], v[224:227], v[124:127], v[24:39]
    ds_read_b64_tr_b16 v[200:201], v174 offset:12288
    ds_read_b64_tr_b16 v[202:203], v175 offset:13824
    ds_read_b64_tr_b16 v[204:205], v176 offset:12288
    v_mfma_f32_32x32x16_bf16 v[40:55], v[228:231], v[124:127], v[40:55]
    ds_read_b64_tr_b16 v[206:207], v177 offset:13824
    ds_read_b64_tr_b16 v[208:209], v174 offset:12416
    ds_read_b64_tr_b16 v[210:211], v175 offset:13952
    v_mfma_f32_32x32x16_bf16 v[56:71], v[232:235], v[124:127], v[56:71]
    ds_read_b64_tr_b16 v[212:213], v176 offset:12416
    ds_read_b64_tr_b16 v[214:215], v177 offset:13952
    ds_read_b64_tr_b16 v[216:217], v174 offset:12544
    v_mfma_f32_32x32x16_bf16 v[72:87], v[236:239], v[124:127], v[72:87]
    ds_read_b64_tr_b16 v[218:219], v175 offset:14080
    ds_read_b64_tr_b16 v[220:221], v176 offset:12544
    ds_read_b64_tr_b16 v[222:223], v177 offset:14080
    v_mfma_f32_32x32x16_bf16 v[88:103], v[240:243], v[124:127], v[88:103]
    v_mfma_f32_32x32x16_bf16 v[104:119], v[244:247], v[124:127], v[104:119]
    s_waitcnt lgkmcnt(10)
    v_mfma_f32_32x32x16_bf16 v[24:39], v[200:203], v[128:131], v[24:39]
    ds_read_b64_tr_b16 v[224:225], v174 offset:18432
    ds_read_b64_tr_b16 v[226:227], v175 offset:19968
    ds_read_b64_tr_b16 v[228:229], v176 offset:18432
    s_add_u32 m0, s45, 12288
    s_mov_b32 s44, 12288
    buffer_load_dwordx4 v2, s[12:15], s44 offen nt lds
    s_waitcnt lgkmcnt(11)
    v_mfma_f32_32x32x16_bf16 v[40:55], v[204:207], v[128:131], v[40:55]
    ds_read_b64_tr_b16 v[230:231], v177 offset:19968
    ds_read_b64_tr_b16 v[232:233], v174 offset:18560
    ds_read_b64_tr_b16 v[234:235], v175 offset:20096
    s_add_u32 m0, s45, 13312
    s_mov_b32 s44, 12288
    buffer_load_dwordx4 v3, s[12:15], s44 offen nt lds
    s_waitcnt lgkmcnt(12)
    v_mfma_f32_32x32x16_bf16 v[56:71], v[208:211], v[128:131], v[56:71]
    ds_read_b64_tr_b16 v[236:237], v176 offset:18560
    ds_read_b64_tr_b16 v[238:239], v177 offset:20096
    ds_read_b64_tr_b16 v[240:241], v174 offset:18688
    s_waitcnt lgkmcnt(13)
    v_mfma_f32_32x32x16_bf16 v[72:87], v[212:215], v[128:131], v[72:87]
    ds_read_b64_tr_b16 v[242:243], v175 offset:20224
    ds_read_b64_tr_b16 v[244:245], v176 offset:18688
    ds_read_b64_tr_b16 v[246:247], v177 offset:20224
    s_add_u32 m0, s45, 14336
    s_mov_b32 s44, 12288
    buffer_load_dwordx4 v4, s[12:15], s44 offen nt lds
    s_waitcnt lgkmcnt(14)
    v_mfma_f32_32x32x16_bf16 v[88:103], v[216:219], v[128:131], v[88:103]
    s_waitcnt lgkmcnt(12)
    v_mfma_f32_32x32x16_bf16 v[104:119], v[220:223], v[128:131], v[104:119]
    s_waitcnt vmcnt(10) lgkmcnt(0)
    s_barrier
    v_mfma_f32_32x32x16_bf16 v[24:39], v[224:227], v[132:135], v[24:39]
    ds_read_b128 v[136:139], v178 offset:16384
    ds_read_b128 v[140:143], v179 offset:16384
    ds_read_b128 v[144:147], v180 offset:16384
    ds_read_b128 v[148:151], v181 offset:16384
    v_mfma_f32_32x32x16_bf16 v[40:55], v[228:231], v[132:135], v[40:55]
    ds_read_b64_tr_b16 v[200:201], v174 offset:24576
    ds_read_b64_tr_b16 v[202:203], v175 offset:26112
    ds_read_b64_tr_b16 v[204:205], v176 offset:24576
    v_mfma_f32_32x32x16_bf16 v[56:71], v[232:235], v[132:135], v[56:71]
    ds_read_b64_tr_b16 v[206:207], v177 offset:26112
    ds_read_b64_tr_b16 v[208:209], v174 offset:24704
    ds_read_b64_tr_b16 v[210:211], v175 offset:26240
    v_mfma_f32_32x32x16_bf16 v[72:87], v[236:239], v[132:135], v[72:87]
    ds_read_b64_tr_b16 v[212:213], v176 offset:24704
    ds_read_b64_tr_b16 v[214:215], v177 offset:26240
    ds_read_b64_tr_b16 v[216:217], v174 offset:24832
    v_mfma_f32_32x32x16_bf16 v[88:103], v[240:243], v[132:135], v[88:103]
    ds_read_b64_tr_b16 v[218:219], v175 offset:26368
    ds_read_b64_tr_b16 v[220:221], v176 offset:24832
    ds_read_b64_tr_b16 v[222:223], v177 offset:26368
    v_mfma_f32_32x32x16_bf16 v[104:119], v[244:247], v[132:135], v[104:119]
    s_waitcnt lgkmcnt(10)
    v_mfma_f32_32x32x16_bf16 v[24:39], v[200:203], v[136:139], v[24:39]
    ds_read_b64_tr_b16 v[224:225], v174 offset:30720
    ds_read_b64_tr_b16 v[226:227], v175 offset:32256
    ds_read_b64_tr_b16 v[228:229], v176 offset:30720
    s_add_u32 m0, s30, 16384
    s_nop 0
    buffer_load_dwordx4 v170, s[4:7], s29 offen lds
    s_waitcnt lgkmcnt(11)
    v_mfma_f32_32x32x16_bf16 v[40:55], v[204:207], v[136:139], v[40:55]
    ds_read_b64_tr_b16 v[230:231], v177 offset:32256
    ds_read_b64_tr_b16 v[232:233], v174 offset:30848
    ds_read_b64_tr_b16 v[234:235], v175 offset:32384
    s_add_u32 m0, s30, 17408
    s_nop 0
    buffer_load_dwordx4 v171, s[4:7], s29 offen lds
    s_waitcnt lgkmcnt(12)
    v_mfma_f32_32x32x16_bf16 v[56:71], v[208:211], v[136:139], v[56:71]
    ds_read_b64_tr_b16 v[236:237], v176 offset:30848
    ds_read_b64_tr_b16 v[238:239], v177 offset:32384
    ds_read_b64_tr_b16 v[240:241], v174 offset:30976
    s_add_u32 m0, s30, 18432
    s_nop 0
    buffer_load_dwordx4 v172, s[4:7], s29 offen lds
    s_waitcnt lgkmcnt(13)
    v_mfma_f32_32x32x16_bf16 v[72:87], v[212:215], v[136:139], v[72:87]
    ds_read_b64_tr_b16 v[242:243], v175 offset:32512
    ds_read_b64_tr_b16 v[244:245], v176 offset:30976
    ds_read_b64_tr_b16 v[246:247], v177 offset:32512
    s_add_u32 m0, s30, 19456
    s_nop 0
    buffer_load_dwordx4 v173, s[4:7], s29 offen lds
    s_add_u32 s29, s29, 128
    s_cmp_eq_u32 s29, 1280
    s_cselect_b32 s29, 0, s29
    s_waitcnt lgkmcnt(14)
    v_mfma_f32_32x32x16_bf16 v[88:103], v[216:219], v[136:139], v[88:103]
    s_waitcnt lgkmcnt(12)
    v_mfma_f32_32x32x16_bf16 v[104:119], v[220:223], v[136:139], v[104:119]
    s_waitcnt vmcnt(63) lgkmcnt(0)
    s_barrier
    v_mfma_f32_32x32x16_bf16 v[24:39], v[224:227], v[140:143], v[24:39]
    ds_read_b64_tr_b16 v[200:201], v174 offset:36864
    ds_read_b64_tr_b16 v[202:203], v175 offset:38400
    ds_read_b64_tr_b16 v[204:205], v176 offset:36864
    v_mfma_f32_32x32x16_bf16 v[40:55], v[228:231], v[140:143], v[40:55]
    ds_read_b64_tr_b16 v[206:207], v177 offset:38400
    ds_read_b64_tr_b16 v[208:209], v174 offset:36992
    ds_read_b64_tr_b16 v[210:211], v175 offset:38528
    v_mfma_f32_32x32x16_bf16 v[56:71], v[232:235], v[140:143], v[56:71]
    ds_read_b64_tr_b16 v[212:213], v176 offset:36992
    ds_read_b64_tr_b16 v[214:215], v177 offset:38528
    ds_read_b64_tr_b16 v[216:217], v174 offset:37120
    v_mfma_f32_32x32x16_bf16 v[72:87], v[236:239], v[140:143], v[72:87]
    ds_read_b64_tr_b16 v[218:219], v175 offset:38656
    ds_read_b64_tr_b16 v[220:221], v176 offset:37120
    ds_read_b64_tr_b16 v[222:223], v177 offset:38656
    v_mfma_f32_32x32x16_bf16 v[88:103], v[240:243], v[140:143], v[88:103]
    v_mfma_f32_32x32x16_bf16 v[104:119], v[244:247], v[140:143], v[104:119]
    s_waitcnt lgkmcnt(10)
    v_mfma_f32_32x32x16_bf16 v[24:39], v[200:203], v[144:147], v[24:39]
    ds_read_b64_tr_b16 v[224:225], v174 offset:43008
    ds_read_b64_tr_b16 v[226:227], v175 offset:44544
    ds_read_b64_tr_b16 v[228:229], v176 offset:43008
    s_add_u32 m0, s45, 24576
    s_mov_b32 s44, 0
    buffer_load_dwordx4 v2, s[16:19], s44 offen nt lds
    s_waitcnt lgkmcnt(11)
    v_mfma_f32_32x32x16_bf16 v[40:55], v[204:207], v[144:147], v[40:55]
    ds_read_b64_tr_b16 v[230:231], v177 offset:44544
    ds_read_b64_tr_b16 v[232:233], v174 offset:43136
    ds_read_b64_tr_b16 v[234:235], v175 offset:44672
    s_add_u32 m0, s45, 25600
    s_mov_b32 s44, 0
    buffer_load_dwordx4 v3, s[16:19], s44 offen nt lds
    s_waitcnt lgkmcnt(12)
    v_mfma_f32_32x32x16_bf16 v[56:71], v[208:211], v[144:147], v[56:71]
    ds_read_b64_tr_b16 v[236:237], v176 offset:43136
    ds_read_b64_tr_b16 v[238:239], v177 offset:44672
    ds_read_b64_tr_b16 v[240:241], v174 offset:43264
    s_waitcnt lgkmcnt(13)
    v_mfma_f32_32x32x16_bf16 v[72:87], v[212:215], v[144:147], v[72:87]
    ds_read_b64_tr_b16 v[242:243], v175 offset:44800
    ds_read_b64_tr_b16 v[244:245], v176 offset:43264
    ds_read_b64_tr_b16 v[246:247], v177 offset:44800
    s_add_u32 m0, s45, 26624
    s_mov_b32 s44, 0
    buffer_load_dwordx4 v4, s[16:19], s44 offen nt lds
    s_waitcnt lgkmcnt(14)
    v_mfma_f32_32x32x16_bf16 v[88:103], v[216:219], v[144:147], v[88:103]
    s_waitcnt lgkmcnt(12)
    v_mfma_f32_32x32x16_bf16 v[104:119], v[220:223], v[144:147], v[104:119]
    s_waitcnt vmcnt(10) lgkmcnt(0)
    s_barrier
    v_mfma_f32_32x32x16_bf16 v[24:39], v[224:227], v[148:151], v[24:39]
    ds_read_b128 v[120:123], v178 offset:0
    ds_read_b128 v[124:127], v179 offset:0
    ds_read_b128 v[128:131], v180 offset:0
    ds_read_b128 v[132:135], v181 offset:0
    v_mfma_f32_32x32x16_bf16 v[40:55], v[228:231], v[148:151], v[40:55]
    ds_read_b64_tr_b16 v[200:201], v174 offset:0
    ds_read_b64_tr_b16 v[202:203], v175 offset:1536
    ds_read_b64_tr_b16 v[204:205], v176 offset:0
    v_mfma_f32_32x32x16_bf16 v[56:71], v[232:235], v[148:151], v[56:71]
    ds_read_b64_tr_b16 v[206:207], v177 offset:1536
    ds_read_b64_tr_b16 v[208:209], v174 offset:128
    ds_read_b64_tr_b16 v[210:211], v175 offset:1664
    v_mfma_f32_32x32x16_bf16 v[72:87], v[236:239], v[148:151], v[72:87]
    ds_read_b64_tr_b16 v[212:213], v176 offset:128
    ds_read_b64_tr_b16 v[214:215], v177 offset:1664
    ds_read_b64_tr_b16 v[216:217], v174 offset:256
    v_mfma_f32_32x32x16_bf16 v[88:103], v[240:243], v[148:151], v[88:103]
    ds_read_b64_tr_b16 v[218:219], v175 offset:1792
    ds_read_b64_tr_b16 v[220:221], v176 offset:256
    ds_read_b64_tr_b16 v[222:223], v177 offset:1792
    v_mfma_f32_32x32x16_bf16 v[104:119], v[244:247], v[148:151], v[104:119]
    s_waitcnt lgkmcnt(10)
    v_mfma_f32_32x32x16_bf16 v[24:39], v[200:203], v[120:123], v[24:39]
    ds_read_b64_tr_b16 v[224:225], v174 offset:6144
    ds_read_b64_tr_b16 v[226:227], v175 offset:7680
    ds_read_b64_tr_b16 v[228:229], v176 offset:6144
    s_add_u32 m0, s30, 0
    s_nop 0
    buffer_load_dwordx4 v170, s[4:7], s29 offen lds
    s_waitcnt lgkmcnt(11)
    v_mfma_f32_32x32x16_bf16 v[40:55], v[204:207], v[120:123], v[40:55]
    ds_read_b64_tr_b16 v[230:231], v177 offset:7680
    ds_read_b64_tr_b16 v[232:233], v174 offset:6272
    ds_read_b64_tr_b16 v[234:235], v175 offset:7808
    s_add_u32 m0, s30, 1024
    s_nop 0
    buffer_load_dwordx4 v171, s[4:7], s29 offen lds
    s_waitcnt lgkmcnt(12)
    v_mfma_f32_32x32x16_bf16 v[56:71], v[208:211], v[120:123], v[56:71]
    ds_read_b64_tr_b16 v[236:237], v176 offset:6272
    ds_read_b64_tr_b16 v[238:239], v177 offset:7808
    ds_read_b64_tr_b16 v[240:241], v174 offset:6400
    s_add_u32 m0, s30, 2048
    s_nop 0
    buffer_load_dwordx4 v172, s[4:7], s29 offen lds
    s_waitcnt lgkmcnt(13)
    v_mfma_f32_32x32x16_bf16 v[72:87], v[212:215], v[120:123], v[72:87]
    ds_read_b64_tr_b16 v[242:243], v175 offset:7936
    ds_read_b64_tr_b16 v[244:245], v176 offset:6400
    ds_read_b64_tr_b16 v[246:247], v177 offset:7936
    s_add_u32 m0, s30, 3072
    s_nop 0
    buffer_load_dwordx4 v173, s[4:7], s29 offen lds
    s_add_u32 s29, s29, 128
    s_cmp_eq_u32 s29, 1280
    s_cselect_b32 s29, 0, s29
    s_waitcnt lgkmcnt(14)
    v_mfma_f32_32x32x16_bf16 v[88:103], v[216:219], v[120:123], v[88:103]
    s_waitcnt lgkmcnt(12)
    v_mfma_f32_32x32x16_bf16 v[104:119], v[220:223], v[120:123], v[104:119]
    s_waitcnt vmcnt(63) lgkmcnt(0)
    s_barrier
    v_mfma_f32_32x32x16_bf16 v[24:39], v[224:227], v[124:127], v[24:39]
    ds_read_b64_tr_b16 v[200:201], v174 offset:12288
    ds_read_b64_tr_b16 v[202:203], v175 offset:13824
    ds_read_b64_tr_b16 v[204:205], v176 offset:12288
    v_mfma_f32_32x32x16_bf16 v[40:55], v[228:231], v[124:127], v[40:55]
    ds_read_b64_tr_b16 v[206:207], v177 offset:13824
    ds_read_b64_tr_b16 v[208:209], v174 offset:12416
    ds_read_b64_tr_b16 v[210:211], v175 offset:13952
    v_mfma_f32_32x32x16_bf16 v[56:71], v[232:235], v[124:127], v[56:71]
    ds_read_b64_tr_b16 v[212:213], v176 offset:12416
    ds_read_b64_tr_b16 v[214:215], v177 offset:13952
    ds_read_b64_tr_b16 v[216:217], v174 offset:12544
    v_mfma_f32_32x32x16_bf16 v[72:87], v[236:239], v[124:127], v[72:87]
    ds_read_b64_tr_b16 v[218:219], v175 offset:14080
    ds_read_b64_tr_b16 v[220:221], v176 offset:12544
    ds_read_b64_tr_b16 v[222:223], v177 offset:14080
    v_mfma_f32_32x32x16_bf16 v[88:103], v[240:243], v[124:127], v[88:103]
    v_mfma_f32_32x32x16_bf16 v[104:119], v[244:247], v[124:127], v[104:119]
    s_waitcnt lgkmcnt(10)
    v_mfma_f32_32x32x16_bf16 v[24:39], v[200:203], v[128:131], v[24:39]
    ds_read_b64_tr_b16 v[224:225], v174 offset:18432
    ds_read_b64_tr_b16 v[226:227], v175 offset:19968
    ds_read_b64_tr_b16 v[228:229], v176 offset:18432
    s_waitcnt lgkmcnt(11)
    v_mfma_f32_32x32x16_bf16 v[40:55], v[204:207], v[128:131], v[40:55]
    ds_read_b64_tr_b16 v[230:231], v177 offset:19968
    ds_read_b64_tr_b16 v[232:233], v174 offset:18560
    ds_read_b64_tr_b16 v[234:235], v175 offset:20096
    s_waitcnt lgkmcnt(12)
    v_mfma_f32_32x32x16_bf16 v[56:71], v[208:211], v[128:131], v[56:71]
    ds_read_b64_tr_b16 v[236:237], v176 offset:18560
    ds_read_b64_tr_b16 v[238:239], v177 offset:20096
    ds_read_b64_tr_b16 v[240:241], v174 offset:18688
    s_waitcnt lgkmcnt(13)
    v_mfma_f32_32x32x16_bf16 v[72:87], v[212:215], v[128:131], v[72:87]
    ds_read_b64_tr_b16 v[242:243], v175 offset:20224
    ds_read_b64_tr_b16 v[244:245], v176 offset:18688
    ds_read_b64_tr_b16 v[246:247], v177 offset:20224
    s_waitcnt lgkmcnt(14)
    v_mfma_f32_32x32x16_bf16 v[88:103], v[216:219], v[128:131], v[88:103]
    s_waitcnt lgkmcnt(12)
    v_mfma_f32_32x32x16_bf16 v[104:119], v[220:223], v[128:131], v[104:119]
    s_waitcnt vmcnt(7) lgkmcnt(0)
    s_barrier
    v_mfma_f32_32x32x16_bf16 v[24:39], v[224:227], v[132:135], v[24:39]
    ds_read_b128 v[136:139], v178 offset:16384
    ds_read_b128 v[140:143], v179 offset:16384
    ds_read_b128 v[144:147], v180 offset:16384
    ds_read_b128 v[148:151], v181 offset:16384
    v_mfma_f32_32x32x16_bf16 v[40:55], v[228:231], v[132:135], v[40:55]
    ds_read_b64_tr_b16 v[200:201], v174 offset:24576
    ds_read_b64_tr_b16 v[202:203], v175 offset:26112
    ds_read_b64_tr_b16 v[204:205], v176 offset:24576
    v_mfma_f32_32x32x16_bf16 v[56:71], v[232:235], v[132:135], v[56:71]
    ds_read_b64_tr_b16 v[206:207], v177 offset:26112
    ds_read_b64_tr_b16 v[208:209], v174 offset:24704
    ds_read_b64_tr_b16 v[210:211], v175 offset:26240
    v_mfma_f32_32x32x16_bf16 v[72:87], v[236:239], v[132:135], v[72:87]
    ds_read_b64_tr_b16 v[212:213], v176 offset:24704
    ds_read_b64_tr_b16 v[214:215], v177 offset:26240
    ds_read_b64_tr_b16 v[216:217], v174 offset:24832
    v_mfma_f32_32x32x16_bf16 v[88:103], v[240:243], v[132:135], v[88:103]
    ds_read_b64_tr_b16 v[218:219], v175 offset:26368
    ds_read_b64_tr_b16 v[220:221], v176 offset:24832
    ds_read_b64_tr_b16 v[222:223], v177 offset:26368
    v_mfma_f32_32x32x16_bf16 v[104:119], v[244:247], v[132:135], v[104:119]
    s_waitcnt lgkmcnt(10)
    v_mfma_f32_32x32x16_bf16 v[24:39], v[200:203], v[136:139], v[24:39]
    ds_read_b64_tr_b16 v[224:225], v174 offset:30720
    ds_read_b64_tr_b16 v[226:227], v175 offset:32256
    ds_read_b64_tr_b16 v[228:229], v176 offset:30720
    s_add_u32 m0, s30, 16384
    s_nop 0
    buffer_load_dwordx4 v170, s[4:7], s29 offen lds
    s_waitcnt lgkmcnt(11)
    v_mfma_f32_32x32x16_bf16 v[40:55], v[204:207], v[136:139], v[40:55]
    ds_read_b64_tr_b16 v[230:231], v177 offset:32256
    ds_read_b64_tr_b16 v[232:233], v174 offset:30848
    ds_read_b64_tr_b16 v[234:235], v175 offset:32384
    s_add_u32 m0, s30, 17408
    s_nop 0
    buffer_load_dwordx4 v171, s[4:7], s29 offen lds
    s_waitcnt lgkmcnt(12)
    v_mfma_f32_32x32x16_bf16 v[56:71], v[208:211], v[136:139], v[56:71]
    ds_read_b64_tr_b16 v[236:237], v176 offset:30848
    ds_read_b64_tr_b16 v[238:239], v177 offset:32384
    ds_read_b64_tr_b16 v[240:241], v174 offset:30976
    s_add_u32 m0, s30, 18432
    s_nop 0
    buffer_load_dwordx4 v172, s[4:7], s29 offen lds
    s_waitcnt lgkmcnt(13)
    v_mfma_f32_32x32x16_bf16 v[72:87], v[212:215], v[136:139], v[72:87]
    ds_read_b64_tr_b16 v[242:243], v175 offset:32512
    ds_read_b64_tr_b16 v[244:245], v176 offset:30976
    ds_read_b64_tr_b16 v[246:247], v177 offset:32512
    s_add_u32 m0, s30, 19456
    s_nop 0
    buffer_load_dwordx4 v173, s[4:7], s29 offen lds
    s_add_u32 s29, s29, 128
    s_cmp_eq_u32 s29, 1280
    s_cselect_b32 s29, 0, s29
    s_waitcnt lgkmcnt(14)
    v_mfma_f32_32x32x16_bf16 v[88:103], v[216:219], v[136:139], v[88:103]
    s_waitcnt lgkmcnt(12)
    v_mfma_f32_32x32x16_bf16 v[104:119], v[220:223], v[136:139], v[104:119]
    s_waitcnt vmcnt(63) lgkmcnt(0)
    s_barrier
    v_mfma_f32_32x32x16_bf16 v[24:39], v[224:227], v[140:143], v[24:39]
    ds_read_b64_tr_b16 v[200:201], v174 offset:36864
    ds_read_b64_tr_b16 v[202:203], v175 offset:38400
    ds_read_b64_tr_b16 v[204:205], v176 offset:36864
    v_mfma_f32_32x32x16_bf16 v[40:55], v[228:231], v[140:143], v[40:55]
    ds_read_b64_tr_b16 v[206:207], v177 offset:38400
    ds_read_b64_tr_b16 v[208:209], v174 offset:36992
    ds_read_b64_tr_b16 v[210:211], v175 offset:38528
    v_mfma_f32_32x32x16_bf16 v[56:71], v[232:235], v[140:143], v[56:71]
    ds_read_b64_tr_b16 v[212:213], v176 offset:36992
    ds_read_b64_tr_b16 v[214:215], v177 offset:38528
    ds_read_b64_tr_b16 v[216:217], v174 offset:37120
    v_mfma_f32_32x32x16_bf16 v[72:87], v[236:239], v[140:143], v[72:87]
    ds_read_b64_tr_b16 v[218:219], v175 offset:38656
    ds_read_b64_tr_b16 v[220:221], v176 offset:37120
    ds_read_b64_tr_b16 v[222:223], v177 offset:38656
    v_mfma_f32_32x32x16_bf16 v[88:103], v[240:243], v[140:143], v[88:103]
    v_mfma_f32_32x32x16_bf16 v[104:119], v[244:247], v[140:143], v[104:119]
    s_waitcnt lgkmcnt(10)
    v_mfma_f32_32x32x16_bf16 v[24:39], v[200:203], v[144:147], v[24:39]
    ds_read_b64_tr_b16 v[224:225], v174 offset:43008
    ds_read_b64_tr_b16 v[226:227], v175 offset:44544
    ds_read_b64_tr_b16 v[228:229], v176 offset:43008
    s_waitcnt lgkmcnt(11)
    v_mfma_f32_32x32x16_bf16 v[40:55], v[204:207], v[144:147], v[40:55]
    ds_read_b64_tr_b16 v[230:231], v177 offset:44544
    ds_read_b64_tr_b16 v[232:233], v174 offset:43136
    ds_read_b64_tr_b16 v[234:235], v175 offset:44672
    s_waitcnt lgkmcnt(12)
    v_mfma_f32_32x32x16_bf16 v[56:71], v[208:211], v[144:147], v[56:71]
    ds_read_b64_tr_b16 v[236:237], v176 offset:43136
    ds_read_b64_tr_b16 v[238:239], v177 offset:44672
    ds_read_b64_tr_b16 v[240:241], v174 offset:43264
    s_waitcnt lgkmcnt(13)
    v_mfma_f32_32x32x16_bf16 v[72:87], v[212:215], v[144:147], v[72:87]
    ds_read_b64_tr_b16 v[242:243], v175 offset:44800
    ds_read_b64_tr_b16 v[244:245], v176 offset:43264
    ds_read_b64_tr_b16 v[246:247], v177 offset:44800
    s_waitcnt lgkmcnt(14)
    v_mfma_f32_32x32x16_bf16 v[88:103], v[216:219], v[144:147], v[88:103]
    s_waitcnt lgkmcnt(12)
    v_mfma_f32_32x32x16_bf16 v[104:119], v[220:223], v[144:147], v[104:119]
    s_waitcnt vmcnt(4) lgkmcnt(0)
    s_barrier
    v_mfma_f32_32x32x16_bf16 v[24:39], v[224:227], v[148:151], v[24:39]
    ds_read_b128 v[120:123], v178 offset:0
    ds_read_b128 v[124:127], v179 offset:0
    ds_read_b128 v[128:131], v180 offset:0
    ds_read_b128 v[132:135], v181 offset:0
    v_mfma_f32_32x32x16_bf16 v[40:55], v[228:231], v[148:151], v[40:55]
    ds_read_b64_tr_b16 v[200:201], v174 offset:0
    ds_read_b64_tr_b16 v[202:203], v175 offset:1536
    ds_read_b64_tr_b16 v[204:205], v176 offset:0
    v_mfma_f32_32x32x16_bf16 v[56:71], v[232:235], v[148:151], v[56:71]
    ds_read_b64_tr_b16 v[206:207], v177 offset:1536
    ds_read_b64_tr_b16 v[208:209], v174 offset:128
    ds_read_b64_tr_b16 v[210:211], v175 offset:1664
    v_mfma_f32_32x32x16_bf16 v[72:87], v[236:239], v[148:151], v[72:87]
    ds_read_b64_tr_b16 v[212:213], v176 offset:128
    ds_read_b64_tr_b16 v[214:215], v177 offset:1664
    ds_read_b64_tr_b16 v[216:217], v174 offset:256
    v_mfma_f32_32x32x16_bf16 v[88:103], v[240:243], v[148:151], v[88:103]
    ds_read_b64_tr_b16 v[218:219], v175 offset:1792
    ds_read_b64_tr_b16 v[220:221], v176 offset:256
    ds_read_b64_tr_b16 v[222:223], v177 offset:1792
    v_mfma_f32_32x32x16_bf16 v[104:119], v[244:247], v[148:151], v[104:119]
    s_waitcnt lgkmcnt(10)
    v_mfma_f32_32x32x16_bf16 v[24:39], v[200:203], v[120:123], v[24:39]
    ds_read_b64_tr_b16 v[224:225], v174 offset:6144
    ds_read_b64_tr_b16 v[226:227], v175 offset:7680
    ds_read_b64_tr_b16 v[228:229], v176 offset:6144
    s_waitcnt lgkmcnt(11)
    v_mfma_f32_32x32x16_bf16 v[40:55], v[204:207], v[120:123], v[40:55]
    ds_read_b64_tr_b16 v[230:231], v177 offset:7680
    ds_read_b64_tr_b16 v[232:233], v174 offset:6272
    ds_read_b64_tr_b16 v[234:235], v175 offset:7808
    s_waitcnt lgkmcnt(12)
    v_mfma_f32_32x32x16_bf16 v[56:71], v[208:211], v[120:123], v[56:71]
    ds_read_b64_tr_b16 v[236:237], v176 offset:6272
    ds_read_b64_tr_b16 v[238:239], v177 offset:7808
    ds_read_b64_tr_b16 v[240:241], v174 offset:6400
    s_waitcnt lgkmcnt(13)
    v_mfma_f32_32x32x16_bf16 v[72:87], v[212:215], v[120:123], v[72:87]
    ds_read_b64_tr_b16 v[242:243], v175 offset:7936
    ds_read_b64_tr_b16 v[244:245], v176 offset:6400
    ds_read_b64_tr_b16 v[246:247], v177 offset:7936
    s_waitcnt lgkmcnt(14)
    v_mfma_f32_32x32x16_bf16 v[88:103], v[216:219], v[120:123], v[88:103]
    s_waitcnt lgkmcnt(12)
    v_mfma_f32_32x32x16_bf16 v[104:119], v[220:223], v[120:123], v[104:119]
    s_waitcnt vmcnt(63) lgkmcnt(0)
    s_barrier
    v_mfma_f32_32x32x16_bf16 v[24:39], v[224:227], v[124:127], v[24:39]
    ds_read_b64_tr_b16 v[200:201], v174 offset:12288
    ds_read_b64_tr_b16 v[202:203], v175 offset:13824
    ds_read_b64_tr_b16 v[204:205], v176 offset:12288
    s_add_u32 m0, s45, 36864
    s_mov_b32 s44, 12288
    buffer_load_dwordx4 v2, s[16:19], s44 offen nt lds
    v_mfma_f32_32x32x16_bf16 v[40:55], v[228:231], v[124:127], v[40:55]
    ds_read_b64_tr_b16 v[206:207], v177 offset:13824
    ds_read_b64_tr_b16 v[208:209], v174 offset:12416
    ds_read_b64_tr_b16 v[210:211], v175 offset:13952
    v_mfma_f32_32x32x16_bf16 v[56:71], v[232:235], v[124:127], v[56:71]
    ds_read_b64_tr_b16 v[212:213], v176 offset:12416
    ds_read_b64_tr_b16 v[214:215], v177 offset:13952
    ds_read_b64_tr_b16 v[216:217], v174 offset:12544
    s_add_u32 m0, s45, 37888
    s_mov_b32 s44, 12288
    buffer_load_dwordx4 v3, s[16:19], s44 offen nt lds
    v_mfma_f32_32x32x16_bf16 v[72:87], v[236:239], v[124:127], v[72:87]
    ds_read_b64_tr_b16 v[218:219], v175 offset:14080
    ds_read_b64_tr_b16 v[220:221], v176 offset:12544
    ds_read_b64_tr_b16 v[222:223], v177 offset:14080
    v_mfma_f32_32x32x16_bf16 v[88:103], v[240:243], v[124:127], v[88:103]
    s_add_u32 m0, s45, 38912
    s_mov_b32 s44, 12288
    buffer_load_dwordx4 v4, s[16:19], s44 offen nt lds
    v_mfma_f32_32x32x16_bf16 v[104:119], v[244:247], v[124:127], v[104:119]
    s_waitcnt lgkmcnt(10)
    v_mfma_f32_32x32x16_bf16 v[24:39], v[200:203], v[128:131], v[24:39]
    ds_read_b64_tr_b16 v[224:225], v174 offset:18432
    ds_read_b64_tr_b16 v[226:227], v175 offset:19968
    ds_read_b64_tr_b16 v[228:229], v176 offset:18432
    s_waitcnt lgkmcnt(11)
    v_mfma_f32_32x32x16_bf16 v[40:55], v[204:207], v[128:131], v[40:55]
    ds_read_b64_tr_b16 v[230:231], v177 offset:19968
    ds_read_b64_tr_b16 v[232:233], v174 offset:18560
    ds_read_b64_tr_b16 v[234:235], v175 offset:20096
    s_waitcnt lgkmcnt(12)
    v_mfma_f32_32x32x16_bf16 v[56:71], v[208:211], v[128:131], v[56:71]
    ds_read_b64_tr_b16 v[236:237], v176 offset:18560
    ds_read_b64_tr_b16 v[238:239], v177 offset:20096
    ds_read_b64_tr_b16 v[240:241], v174 offset:18688
    s_waitcnt lgkmcnt(13)
    v_mfma_f32_32x32x16_bf16 v[72:87], v[212:215], v[128:131], v[72:87]
    ds_read_b64_tr_b16 v[242:243], v175 offset:20224
    ds_read_b64_tr_b16 v[244:245], v176 offset:18688
    ds_read_b64_tr_b16 v[246:247], v177 offset:20224
    s_waitcnt lgkmcnt(14)
    v_mfma_f32_32x32x16_bf16 v[88:103], v[216:219], v[128:131], v[88:103]
    s_waitcnt lgkmcnt(12)
    v_mfma_f32_32x32x16_bf16 v[104:119], v[220:223], v[128:131], v[104:119]
    s_waitcnt vmcnt(3) lgkmcnt(0)
    s_barrier
    v_mfma_f32_32x32x16_bf16 v[24:39], v[224:227], v[132:135], v[24:39]
    ds_read_b128 v[136:139], v178 offset:16384
    ds_read_b128 v[140:143], v179 offset:16384
    ds_read_b128 v[144:147], v180 offset:16384
    ds_read_b128 v[148:151], v181 offset:16384
    v_mfma_f32_32x32x16_bf16 v[40:55], v[228:231], v[132:135], v[40:55]
    ds_read_b64_tr_b16 v[200:201], v174 offset:24576
    ds_read_b64_tr_b16 v[202:203], v175 offset:26112
    ds_read_b64_tr_b16 v[204:205], v176 offset:24576
    v_mfma_f32_32x32x16_bf16 v[56:71], v[232:235], v[132:135], v[56:71]
    ds_read_b64_tr_b16 v[206:207], v177 offset:26112
    ds_read_b64_tr_b16 v[208:209], v174 offset:24704
    ds_read_b64_tr_b16 v[210:211], v175 offset:26240
    v_mfma_f32_32x32x16_bf16 v[72:87], v[236:239], v[132:135], v[72:87]
    ds_read_b64_tr_b16 v[212:213], v176 offset:24704
    ds_read_b64_tr_b16 v[214:215], v177 offset:26240
    ds_read_b64_tr_b16 v[216:217], v174 offset:24832
    v_mfma_f32_32x32x16_bf16 v[88:103], v[240:243], v[132:135], v[88:103]
    ds_read_b64_tr_b16 v[218:219], v175 offset:26368
    ds_read_b64_tr_b16 v[220:221], v176 offset:24832
    ds_read_b64_tr_b16 v[222:223], v177 offset:26368
    v_mfma_f32_32x32x16_bf16 v[104:119], v[244:247], v[132:135], v[104:119]
    s_waitcnt lgkmcnt(10)
    v_mfma_f32_32x32x16_bf16 v[24:39], v[200:203], v[136:139], v[24:39]
    ds_read_b64_tr_b16 v[224:225], v174 offset:30720
    ds_read_b64_tr_b16 v[226:227], v175 offset:32256
    ds_read_b64_tr_b16 v[228:229], v176 offset:30720
    s_waitcnt lgkmcnt(11)
    v_mfma_f32_32x32x16_bf16 v[40:55], v[204:207], v[136:139], v[40:55]
    ds_read_b64_tr_b16 v[230:231], v177 offset:32256
    ds_read_b64_tr_b16 v[232:233], v174 offset:30848
    ds_read_b64_tr_b16 v[234:235], v175 offset:32384
    s_waitcnt lgkmcnt(12)
    v_mfma_f32_32x32x16_bf16 v[56:71], v[208:211], v[136:139], v[56:71]
    ds_read_b64_tr_b16 v[236:237], v176 offset:30848
    ds_read_b64_tr_b16 v[238:239], v177 offset:32384
    ds_read_b64_tr_b16 v[240:241], v174 offset:30976
    s_waitcnt lgkmcnt(13)
    v_mfma_f32_32x32x16_bf16 v[72:87], v[212:215], v[136:139], v[72:87]
    ds_read_b64_tr_b16 v[242:243], v175 offset:32512
    ds_read_b64_tr_b16 v[244:245], v176 offset:30976
    ds_read_b64_tr_b16 v[246:247], v177 offset:32512
    s_waitcnt lgkmcnt(14)
    v_mfma_f32_32x32x16_bf16 v[88:103], v[216:219], v[136:139], v[88:103]
    s_waitcnt lgkmcnt(12)
    v_mfma_f32_32x32x16_bf16 v[104:119], v[220:223], v[136:139], v[104:119]
    s_waitcnt vmcnt(63) lgkmcnt(0)
    s_barrier
    v_mfma_f32_32x32x16_bf16 v[24:39], v[224:227], v[140:143], v[24:39]
    ds_read_b64_tr_b16 v[200:201], v174 offset:36864
    ds_read_b64_tr_b16 v[202:203], v175 offset:38400
    ds_read_b64_tr_b16 v[204:205], v176 offset:36864
    s_add_u32 m0, s45, 49152
    s_mov_b32 s44, 24576
    buffer_load_dwordx4 v2, s[12:15], s44 offen nt lds
    v_mfma_f32_32x32x16_bf16 v[40:55], v[228:231], v[140:143], v[40:55]
    ds_read_b64_tr_b16 v[206:207], v177 offset:38400
    ds_read_b64_tr_b16 v[208:209], v174 offset:36992
    ds_read_b64_tr_b16 v[210:211], v175 offset:38528
    v_mfma_f32_32x32x16_bf16 v[56:71], v[232:235], v[140:143], v[56:71]
    ds_read_b64_tr_b16 v[212:213], v176 offset:36992
    ds_read_b64_tr_b16 v[214:215], v177 offset:38528
    ds_read_b64_tr_b16 v[216:217], v174 offset:37120
    s_add_u32 m0, s45, 50176
    s_mov_b32 s44, 24576
    buffer_load_dwordx4 v3, s[12:15], s44 offen nt lds
    v_mfma_f32_32x32x16_bf16 v[72:87], v[236:239], v[140:143], v[72:87]
    ds_read_b64_tr_b16 v[218:219], v175 offset:38656
    ds_read_b64_tr_b16 v[220:221], v176 offset:37120
    ds_read_b64_tr_b16 v[222:223], v177 offset:38656
    v_mfma_f32_32x32x16_bf16 v[88:103], v[240:243], v[140:143], v[88:103]
    s_add_u32 m0, s45, 51200
    s_mov_b32 s44, 24576
    buffer_load_dwordx4 v4, s[12:15], s44 offen nt lds
    v_mfma_f32_32x32x16_bf16 v[104:119], v[244:247], v[140:143], v[104:119]
    s_waitcnt lgkmcnt(10)
    v_mfma_f32_32x32x16_bf16 v[24:39], v[200:203], v[144:147], v[24:39]
    ds_read_b64_tr_b16 v[224:225], v174 offset:43008
    ds_read_b64_tr_b16 v[226:227], v175 offset:44544
    ds_read_b64_tr_b16 v[228:229], v176 offset:43008
    s_waitcnt lgkmcnt(11)
    v_mfma_f32_32x32x16_bf16 v[40:55], v[204:207], v[144:147], v[40:55]
    ds_read_b64_tr_b16 v[230:231], v177 offset:44544
    ds_read_b64_tr_b16 v[232:233], v174 offset:43136
    ds_read_b64_tr_b16 v[234:235], v175 offset:44672
    s_waitcnt lgkmcnt(12)
    v_mfma_f32_32x32x16_bf16 v[56:71], v[208:211], v[144:147], v[56:71]
    ds_read_b64_tr_b16 v[236:237], v176 offset:43136
    ds_read_b64_tr_b16 v[238:239], v177 offset:44672
    ds_read_b64_tr_b16 v[240:241], v174 offset:43264
    s_waitcnt lgkmcnt(13)
    v_mfma_f32_32x32x16_bf16 v[72:87], v[212:215], v[144:147], v[72:87]
    ds_read_b64_tr_b16 v[242:243], v175 offset:44800
    ds_read_b64_tr_b16 v[244:245], v176 offset:43264
    ds_read_b64_tr_b16 v[246:247], v177 offset:44800
    s_waitcnt lgkmcnt(14)
    v_mfma_f32_32x32x16_bf16 v[88:103], v[216:219], v[144:147], v[88:103]
    s_waitcnt lgkmcnt(12)
    v_mfma_f32_32x32x16_bf16 v[104:119], v[220:223], v[144:147], v[104:119]
    s_waitcnt vmcnt(28) lgkmcnt(0)
    s_barrier
    v_add_u32 v13, s41, v5
    v_add_u32 v14, s41, v6
    v_add_u32 v15, s41, v7
    v_add_u32 v16, s41, v8
    v_mfma_f32_32x32x16_bf16 v[24:39], v[224:227], v[148:151], v[24:39]
    ds_read_b128 v[200:203], v13 offset:0
    ds_read_b128 v[204:207], v14 offset:0
    s_add_u32 m0, s45, 61440
    s_mov_b32 s44, 36864
    buffer_load_dwordx4 v2, s[12:15], s44 offen nt lds
    v_mfma_f32_32x32x16_bf16 v[40:55], v[228:231], v[148:151], v[40:55]
    ds_read_b128 v[208:211], v15 offset:0
    ds_read_b128 v[212:215], v16 offset:0
    v_mfma_f32_32x32x16_bf16 v[56:71], v[232:235], v[148:151], v[56:71]
    ds_read_b128 v[216:219], v13 offset:128
    s_add_u32 m0, s45, 62464
    s_mov_b32 s44, 36864
    buffer_load_dwordx4 v3, s[12:15], s44 offen nt lds
    v_mfma_f32_32x32x16_bf16 v[72:87], v[236:239], v[148:151], v[72:87]
    ds_read_b128 v[220:223], v14 offset:128
    v_mfma_f32_32x32x16_bf16 v[88:103], v[240:243], v[148:151], v[88:103]
    s_add_u32 m0, s45, 63488
    s_mov_b32 s44, 36864
    buffer_load_dwordx4 v4, s[12:15], s44 offen nt lds
    v_mfma_f32_32x32x16_bf16 v[104:119], v[244:247], v[148:151], v[104:119]
L1_qj:
    s_nop 7
    s_nop 7
    v_cvt_pk_bf16_f32 v120, v24, v25
    v_cvt_pk_bf16_f32 v121, v26, v27
    v_cvt_pk_bf16_f32 v122, v28, v29
    v_cvt_pk_bf16_f32 v123, v30, v31
    v_cvt_pk_bf16_f32 v124, v32, v33
    v_cvt_pk_bf16_f32 v125, v34, v35
    v_cvt_pk_bf16_f32 v126, v36, v37
    v_cvt_pk_bf16_f32 v127, v38, v39
    v_cvt_pk_bf16_f32 v128, v40, v41
    v_cvt_pk_bf16_f32 v129, v42, v43
    v_cvt_pk_bf16_f32 v130, v44, v45
    v_cvt_pk_bf16_f32 v131, v46, v47
    v_cvt_pk_bf16_f32 v132, v48, v49
    v_cvt_pk_bf16_f32 v133, v50, v51
    v_cvt_pk_bf16_f32 v134, v52, v53
    v_cvt_pk_bf16_f32 v135, v54, v55
    v_cvt_pk_bf16_f32 v136, v56, v57
    v_cvt_pk_bf16_f32 v137, v58, v59
    v_cvt_pk_bf16_f32 v138, v60, v61
    v_cvt_pk_bf16_f32 v139, v62, v63
    v_cvt_pk_bf16_f32 v140, v64, v65
    v_cvt_pk_bf16_f32 v141, v66, v67
    v_cvt_pk_bf16_f32 v142, v68, v69
    v_cvt_pk_bf16_f32 v143, v70, v71
    v_cvt_pk_bf16_f32 v144, v72, v73
    v_cvt_pk_bf16_f32 v145, v74, v75
    v_cvt_pk_bf16_f32 v146, v76, v77
    v_cvt_pk_bf16_f32 v147, v78, v79
    v_cvt_pk_bf16_f32 v148, v80, v81
    v_cvt_pk_bf16_f32 v149, v82, v83
    v_cvt_pk_bf16_f32 v150, v84, v85
    v_cvt_pk_bf16_f32 v151, v86, v87
    v_cvt_pk_bf16_f32 v152, v88, v89
    v_cvt_pk_bf16_f32 v153, v90, v91
    v_cvt_pk_bf16_f32 v154, v92, v93
    v_cvt_pk_bf16_f32 v155, v94, v95
    v_cvt_pk_bf16_f32 v156, v96, v97
    v_cvt_pk_bf16_f32 v157, v98, v99
    v_cvt_pk_bf16_f32 v158, v100, v101
    v_cvt_pk_bf16_f32 v159, v102, v103
    v_cvt_pk_bf16_f32 v160, v104, v105
    v_cvt_pk_bf16_f32 v161, v106, v107
    v_cvt_pk_bf16_f32 v162, v108, v109
    v_cvt_pk_bf16_f32 v163, v110, v111
    v_cvt_pk_bf16_f32 v164, v112, v113
    v_cvt_pk_bf16_f32 v165, v114, v115
    v_cvt_pk_bf16_f32 v166, v116, v117
    v_cvt_pk_bf16_f32 v167, v118, v119
    v_mov_b32 v24, 0
    v_mov_b32 v25, 0
    v_mov_b32 v26, 0
    v_mov_b32 v27, 0
    v_mov_b32 v28, 0
    v_mov_b32 v29, 0
    v_mov_b32 v30, 0
    v_mov_b32 v31, 0
    v_mov_b32 v32, 0
    v_mov_b32 v33, 0
    v_mov_b32 v34, 0
    v_mov_b32 v35, 0
    v_mov_b32 v36, 0
    v_mov_b32 v37, 0
    v_mov_b32 v38, 0
    v_mov_b32 v39, 0
    v_mov_b32 v40, 0
    v_mov_b32 v41, 0
    v_mov_b32 v42, 0
    v_mov_b32 v43, 0
    v_mov_b32 v44, 0
    v_mov_b32 v45, 0
    v_mov_b32 v46, 0
    v_mov_b32 v47, 0
    v_mov_b32 v48, 0
    v_mov_b32 v49, 0
    v_mov_b32 v50, 0
    v_mov_b32 v51, 0
    v_mov_b32 v52, 0
    v_mov_b32 v53, 0
    v_mov_b32 v54, 0
    v_mov_b32 v55, 0
    v_mov_b32 v56, 0
    v_mov_b32 v57, 0
    v_mov_b32 v58, 0
    v_mov_b32 v59, 0
    v_mov_b32 v60, 0
    v_mov_b32 v61, 0
    v_mov_b32 v62, 0
    v_mov_b32 v63, 0
    v_mov_b32 v64, 0
    v_mov_b32 v65, 0
    v_mov_b32 v66, 0
    v_mov_b32 v67, 0
    v_mov_b32 v68, 0
    v_mov_b32 v69, 0
    v_mov_b32 v70, 0
    v_mov_b32 v71, 0
    v_mov_b32 v72, 0
    v_mov_b32 v73, 0
    v_mov_b32 v74, 0
    v_mov_b32 v75, 0
    v_mov_b32 v76, 0
    v_mov_b32 v77, 0
    v_mov_b32 v78, 0
    v_mov_b32 v79, 0
    v_mov_b32 v80, 0
    v_mov_b32 v81, 0
    v_mov_b32 v82, 0
    v_mov_b32 v83, 0
    v_mov_b32 v84, 0
    v_mov_b32 v85, 0
    v_mov_b32 v86, 0
    v_mov_b32 v87, 0
    v_mov_b32 v88, 0
    v_mov_b32 v89, 0
    v_mov_b32 v90, 0
    v_mov_b32 v91, 0
    v_mov_b32 v92, 0
    v_mov_b32 v93, 0
    v_mov_b32 v94, 0
    v_mov_b32 v95, 0
    v_mov_b32 v96, 0
    v_mov_b32 v97, 0
    v_mov_b32 v98, 0
    v_mov_b32 v99, 0
    v_mov_b32 v100, 0
    v_mov_b32 v101, 0
    v_mov_b32 v102, 0
    v_mov_b32 v103, 0
    v_mov_b32 v104, 0
    v_mov_b32 v105, 0
    v_mov_b32 v106, 0
    v_mov_b32 v107, 0
    v_mov_b32 v108, 0
    v_mov_b32 v109, 0
    v_mov_b32 v110, 0
    v_mov_b32 v111, 0
    v_mov_b32 v112, 0
    v_mov_b32 v113, 0
    v_mov_b32 v114, 0
    v_mov_b32 v115, 0
    v_mov_b32 v116, 0
    v_mov_b32 v117, 0
    v_mov_b32 v118, 0
    v_mov_b32 v119, 0
    v_mov_b32 v17, 0xff800000
    v_mov_b32 v18, 0
    s_mov_b32 s40, 0x3dd53b95
    s_mov_b32 s42, 24576
    s_mov_b32 s43, 49152
    s_mov_b32 s31, 0
    s_and_b32 s59, s2, 3
    s_mul_i32 s59, s59, 1966080
    s_lshr_b32 s70, s2, 3
    s_mul_i32 s70, s70, 61440
    s_add_u32 s59, s59, s70
    s_mul_i32 s70, s54, 36864
    s_add_u32 s59, s59, s70
    s_add_u32 s76, s80, s59
    s_addc_u32 s77, s81, 0
    s_mul_i32 s70, s54, 12288
    s_sub_u32 s75, 36864, s70
L1_aloop:
    s_waitcnt lgkmcnt(5)
    v_mfma_f32_32x32x16_bf16 v[168:183], v[200:203], v[120:123], 0
    ds_read_b128 v[224:227], v15 offset:128
    ds_read_b128 v[228:231], v16 offset:128
    s_waitcnt lgkmcnt(6)
    v_mfma_f32_32x32x16_bf16 v[168:183], v[204:207], v[124:127], v[168:183]
    ds_read_b128 v[232:235], v13 offset:256
    ds_read_b128 v[236:239], v14 offset:256
    s_waitcnt lgkmcnt(7)
    v_mfma_f32_32x32x16_bf16 v[168:183], v[208:211], v[128:131], v[168:183]
    ds_read_b128 v[240:243], v15 offset:256
    s_waitcnt lgkmcnt(7)
    v_mfma_f32_32x32x16_bf16 v[168:183], v[212:215], v[132:135], v[168:183]
    ds_read_b128 v[244:247], v16 offset:256
    s_waitcnt lgkmcnt(7)
    v_mfma_f32_32x32x16_bf16 v[168:183], v[216:219], v[136:139], v[168:183]
    s_waitcnt lgkmcnt(6)
    v_mfma_f32_32x32x16_bf16 v[168:183], v[220:223], v[140:143], v[168:183]
    s_waitcnt vmcnt(12) lgkmcnt(0)
    s_barrier
    s_add_u32 s44, s41, s25
    s_add_u32 s41, s41, 12288
    s_cmp_eq_u32 s41, s79
    s_cselect_b32 s41, s78, s41
    v_add_u32 v13, s41, v5
    v_add_u32 v14, s41, v6
    v_add_u32 v15, s41, v7
    v_add_u32 v16, s41, v8
    v_mfma_f32_32x32x16_bf16 v[168:183], v[224:227], v[144:147], v[168:183]
    ds_read_b128 v[200:203], v13 offset:0
    ds_read_b128 v[204:207], v14 offset:0
    s_add_u32 m0, s44, 0
    s_nop 0
    buffer_load_dwordx4 v2, s[16:19], s42 offen nt lds
    v_mfma_f32_32x32x16_bf16 v[168:183], v[228:231], v[148:151], v[168:183]
    ds_read_b128 v[208:211], v15 offset:0
    ds_read_b128 v[212:215], v16 offset:0
    v_mfma_f32_32x32x16_bf16 v[168:183], v[232:235], v[152:155], v[168:183]
    ds_read_b128 v[216:219], v13 offset:128
    s_add_u32 m0, s44, 1024
    s_nop 0
    buffer_load_dwordx4 v3, s[16:19], s42 offen nt lds
    v_mfma_f32_32x32x16_bf16 v[168:183], v[236:239], v[156:159], v[168:183]
    ds_read_b128 v[220:223], v14 offset:128
    v_mfma_f32_32x32x16_bf16 v[168:183], v[240:243], v[160:163], v[168:183]
    s_add_u32 m0, s44, 2048
    s_nop 0
    buffer_load_dwordx4 v4, s[16:19], s42 offen nt lds
    s_add_u32 s42, s42, 12288
    v_mfma_f32_32x32x16_bf16 v[168:183], v[244:247], v[164:167], v[168:183]
    s_waitcnt lgkmcnt(5)
    v_mfma_f32_32x32x16_bf16 v[184:199], v[200:203], v[120:123], 0
    ds_read_b128 v[224:227], v15 offset:128
    ds_read_b128 v[228:231], v16 offset:128
    s_waitcnt lgkmcnt(6)
    v_mfma_f32_32x32x16_bf16 v[184:199], v[204:207], v[124:127], v[184:199]
    ds_read_b128 v[232:235], v13 offset:256
    ds_read_b128 v[236:239], v14 offset:256
    s_waitcnt lgkmcnt(7)
    v_mfma_f32_32x32x16_bf16 v[184:199], v[208:211], v[128:131], v[184:199]
    ds_read_b128 v[240:243], v15 offset:256
    s_waitcnt lgkmcnt(7)
    v_mfma_f32_32x32x16_bf16 v[184:199], v[212:215], v[132:135], v[184:199]
    ds_read_b128 v[244:247], v16 offset:256
    s_waitcnt lgkmcnt(7)
    v_mfma_f32_32x32x16_bf16 v[184:199], v[216:219], v[136:139], v[184:199]
    s_waitcnt lgkmcnt(6)
    v_mfma_f32_32x32x16_bf16 v[184:199], v[220:223], v[140:143], v[184:199]
    s_waitcnt vmcnt(12) lgkmcnt(0)
    s_barrier
    s_add_u32 s44, s41, s25
    s_add_u32 s41, s41, 12288
    s_cmp_eq_u32 s41, s79
    s_cselect_b32 s41, s78, s41
    v_add_u32 v13, s41, v9
    v_add_u32 v14, s41, v10
    v_add_u32 v15, s41, v11
    v_add_u32 v16, s41, v12
    v_mfma_f32_32x32x16_bf16 v[184:199], v[224:227], v[144:147], v[184:199]
    ds_read_b64_tr_b16 v[200:201], v13 offset:0
    ds_read_b64_tr_b16 v[202:203], v14 offset:3072
    ds_read_b64_tr_b16 v[204:205], v15 offset:0
    s_add_u32 m0, s44, 0
    s_nop 0
    buffer_load_dwordx4 v2, s[16:19], s42 offen nt lds
    v_mfma_f32_32x32x16_bf16 v[184:199], v[228:231], v[148:151], v[184:199]
    ds_read_b64_tr_b16 v[206:207], v16 offset:3072
    ds_read_b64_tr_b16 v[208:209], v13 offset:128
    ds_read_b64_tr_b16 v[210:211], v14 offset:3200
    v_mfma_f32_32x32x16_bf16 v[184:199], v[232:235], v[152:155], v[184:199]
    ds_read_b64_tr_b16 v[212:213], v15 offset:128
    ds_read_b64_tr_b16 v[214:215], v16 offset:3200
    ds_read_b64_tr_b16 v[216:217], v13 offset:256
    s_add_u32 m0, s44, 1024
    s_nop 0
    buffer_load_dwordx4 v3, s[16:19], s42 offen nt lds
    v_mfma_f32_32x32x16_bf16 v[184:199], v[236:239], v[156:159], v[184:199]
    ds_read_b64_tr_b16 v[218:219], v14 offset:3328
    ds_read_b64_tr_b16 v[220:221], v15 offset:256
    ds_read_b64_tr_b16 v[222:223], v16 offset:3328
    v_mfma_f32_32x32x16_bf16 v[184:199], v[240:243], v[160:163], v[184:199]
    s_add_u32 m0, s44, 2048
    s_nop 0
    buffer_load_dwordx4 v4, s[16:19], s42 offen nt lds
    s_add_u32 s42, s42, 12288
    v_mfma_f32_32x32x16_bf16 v[184:199], v[244:247], v[164:167], v[184:199]
    v_max3_f32 v19, v168, v169, v170
    v_max3_f32 v19, v19, v171, v172
    v_max3_f32 v19, v19, v173, v174
    v_max3_f32 v19, v19, v175, v176
    v_max3_f32 v19, v19, v177, v178
    v_max3_f32 v19, v19, v179, v180
    v_max3_f32 v19, v19, v181, v182
    v_max3_f32 v19, v19, v183, v17
    s_nop 4
    v_max3_f32 v19, v19, v184, v185
    v_max3_f32 v19, v19, v186, v187
    v_max3_f32 v19, v19, v188, v189
    v_max3_f32 v19, v19, v190, v191
    v_max3_f32 v19, v19, v192, v193
    v_max3_f32 v19, v19, v194, v195
    v_max3_f32 v19, v19, v196, v197
    v_max3_f32 v19, v19, v198, v199
    v_mov_b32 v22, v19
    s_nop 1
    v_permlane32_swap_b32 v19, v22
    v_max_f32 v19, v19, v22
    v_sub_f32 v20, v17, v19
    v_mul_f32 v20, s40, v20
    v_exp_f32 v20, v20
    v_mov_b32 v17, v19
    v_mul_f32 v19, s40, v19
    v_mov_b32 v21, v20
    v_mul_f32 v18, v18, v20
    v_fma_f32 v168, v168, s40, -v19
    v_fma_f32 v169, v169, s40, -v19
    v_fma_f32 v170, v170, s40, -v19
    v_fma_f32 v171, v171, s40, -v19
    v_fma_f32 v172, v172, s40, -v19
    v_fma_f32 v173, v173, s40, -v19
    v_fma_f32 v174, v174, s40, -v19
    v_fma_f32 v175, v175, s40, -v19
    v_fma_f32 v176, v176, s40, -v19
    v_fma_f32 v177, v177, s40, -v19
    v_fma_f32 v178, v178, s40, -v19
    v_fma_f32 v179, v179, s40, -v19
    v_fma_f32 v180, v180, s40, -v19
    v_fma_f32 v181, v181, s40, -v19
    v_fma_f32 v182, v182, s40, -v19
    v_fma_f32 v183, v183, s40, -v19
    v_exp_f32 v168, v168
    v_exp_f32 v169, v169
    v_pk_mul_f32 v[24:25], v[24:25], v[20:21]
    v_exp_f32 v170, v170
    v_pk_mul_f32 v[26:27], v[26:27], v[20:21]
    v_exp_f32 v171, v171
    v_pk_mul_f32 v[28:29], v[28:29], v[20:21]
    v_exp_f32 v172, v172
    v_pk_mul_f32 v[30:31], v[30:31], v[20:21]
    v_exp_f32 v173, v173
    v_pk_mul_f32 v[32:33], v[32:33], v[20:21]
    v_exp_f32 v174, v174
    v_pk_mul_f32 v[34:35], v[34:35], v[20:21]
    v_exp_f32 v175, v175
    v_pk_mul_f32 v[36:37], v[36:37], v[20:21]
    v_exp_f32 v176, v176
    v_pk_mul_f32 v[38:39], v[38:39], v[20:21]
    v_exp_f32 v177, v177
    v_pk_mul_f32 v[40:41], v[40:41], v[20:21]
    v_exp_f32 v178, v178
    v_pk_mul_f32 v[42:43], v[42:43], v[20:21]
    v_exp_f32 v179, v179
    v_pk_mul_f32 v[44:45], v[44:45], v[20:21]
    v_exp_f32 v180, v180
    v_pk_mul_f32 v[46:47], v[46:47], v[20:21]
    v_exp_f32 v181, v181
    v_pk_mul_f32 v[48:49], v[48:49], v[20:21]
    v_exp_f32 v182, v182
    v_pk_mul_f32 v[50:51], v[50:51], v[20:21]
    v_exp_f32 v183, v183
    v_pk_mul_f32 v[52:53], v[52:53], v[20:21]
    v_pk_mul_f32 v[54:55], v[54:55], v[20:21]
    v_pk_mul_f32 v[56:57], v[56:57], v[20:21]
    v_pk_mul_f32 v[58:59], v[58:59], v[20:21]
    v_pk_mul_f32 v[60:61], v[60:61], v[20:21]
    v_pk_mul_f32 v[62:63], v[62:63], v[20:21]
    v_pk_mul_f32 v[64:65], v[64:65], v[20:21]
    v_pk_mul_f32 v[66:67], v[66:67], v[20:21]
    v_pk_mul_f32 v[68:69], v[68:69], v[20:21]
    v_pk_mul_f32 v[70:71], v[70:71], v[20:21]
    v_add_f32 v22, v168, v169
    v_add_f32 v22, v22, v170
    v_add_f32 v22, v22, v171
    v_add_f32 v22, v22, v172
    v_add_f32 v22, v22, v173
    v_add_f32 v22, v22, v174
    v_add_f32 v22, v22, v175
    v_add_f32 v22, v22, v176
    v_add_f32 v22, v22, v177
    v_add_f32 v22, v22, v178
    v_add_f32 v22, v22, v179
    v_add_f32 v22, v22, v180
    v_add_f32 v22, v22, v181
    v_add_f32 v22, v22, v182
    v_add_f32 v22, v22, v183
    v_add_f32 v18, v18, v22
    v_cvt_pk_bf16_f32 v168, v168, v169
    v_cvt_pk_bf16_f32 v169, v170, v171
    v_cvt_pk_bf16_f32 v170, v172, v173
    v_cvt_pk_bf16_f32 v171, v174, v175
    v_cvt_pk_bf16_f32 v172, v176, v177
    v_cvt_pk_bf16_f32 v173, v178, v179
    v_cvt_pk_bf16_f32 v174, v180, v181
    v_cvt_pk_bf16_f32 v175, v182, v183
    v_fma_f32 v184, v184, s40, -v19
    v_fma_f32 v185, v185, s40, -v19
    v_fma_f32 v186, v186, s40, -v19
    v_fma_f32 v187, v187, s40, -v19
    v_fma_f32 v188, v188, s40, -v19
    v_fma_f32 v189, v189, s40, -v19
    v_fma_f32 v190, v190, s40, -v19
    v_fma_f32 v191, v191, s40, -v19
    v_fma_f32 v192, v192, s40, -v19
    v_fma_f32 v193, v193, s40, -v19
    v_fma_f32 v194, v194, s40, -v19
    v_fma_f32 v195, v195, s40, -v19
    v_fma_f32 v196, v196, s40, -v19
    v_fma_f32 v197, v197, s40, -v19
    v_fma_f32 v198, v198, s40, -v19
    v_fma_f32 v199, v199, s40, -v19
    v_exp_f32 v184, v184
    v_exp_f32 v185, v185
    v_pk_mul_f32 v[72:73], v[72:73], v[20:21]
    v_exp_f32 v186, v186
    v_pk_mul_f32 v[74:75], v[74:75], v[20:21]
    v_exp_f32 v187, v187
    v_pk_mul_f32 v[76:77], v[76:77], v[20:21]
    v_exp_f32 v188, v188
    v_pk_mul_f32 v[78:79], v[78:79], v[20:21]
    v_exp_f32 v189, v189
    v_pk_mul_f32 v[80:81], v[80:81], v[20:21]
    v_exp_f32 v190, v190
    v_pk_mul_f32 v[82:83], v[82:83], v[20:21]
    v_exp_f32 v191, v191
    v_pk_mul_f32 v[84:85], v[84:85], v[20:21]
    v_exp_f32 v192, v192
    v_pk_mul_f32 v[86:87], v[86:87], v[20:21]
    v_exp_f32 v193, v193
    v_pk_mul_f32 v[88:89], v[88:89], v[20:21]
    v_exp_f32 v194, v194
    v_pk_mul_f32 v[90:91], v[90:91], v[20:21]
    v_exp_f32 v195, v195
    v_pk_mul_f32 v[92:93], v[92:93], v[20:21]
    v_exp_f32 v196, v196
    v_pk_mul_f32 v[94:95], v[94:95], v[20:21]
    v_exp_f32 v197, v197
    v_pk_mul_f32 v[96:97], v[96:97], v[20:21]
    v_exp_f32 v198, v198
    v_pk_mul_f32 v[98:99], v[98:99], v[20:21]
    v_exp_f32 v199, v199
    v_pk_mul_f32 v[100:101], v[100:101], v[20:21]
    v_pk_mul_f32 v[102:103], v[102:103], v[20:21]
    v_pk_mul_f32 v[104:105], v[104:105], v[20:21]
    v_pk_mul_f32 v[106:107], v[106:107], v[20:21]
    v_pk_mul_f32 v[108:109], v[108:109], v[20:21]
    v_pk_mul_f32 v[110:111], v[110:111], v[20:21]
    v_pk_mul_f32 v[112:113], v[112:113], v[20:21]
    v_pk_mul_f32 v[114:115], v[114:115], v[20:21]
    v_pk_mul_f32 v[116:117], v[116:117], v[20:21]
    v_pk_mul_f32 v[118:119], v[118:119], v[20:21]
    v_add_f32 v22, v184, v185
    v_add_f32 v22, v22, v186
    v_add_f32 v22, v22, v187
    v_add_f32 v22, v22, v188
    v_add_f32 v22, v22, v189
    v_add_f32 v22, v22, v190
    v_add_f32 v22, v22, v191
    v_add_f32 v22, v22, v192
    v_add_f32 v22, v22, v193
    v_add_f32 v22, v22, v194
    v_add_f32 v22, v22, v195
    v_add_f32 v22, v22, v196
    v_add_f32 v22, v22, v197
    v_add_f32 v22, v22, v198
    v_add_f32 v22, v22, v199
    v_add_f32 v18, v18, v22
    v_cvt_pk_bf16_f32 v184, v184, v185
    v_cvt_pk_bf16_f32 v185, v186, v187
    v_cvt_pk_bf16_f32 v186, v188, v189
    v_cvt_pk_bf16_f32 v187, v190, v191
    v_cvt_pk_bf16_f32 v188, v192, v193
    v_cvt_pk_bf16_f32 v189, v194, v195
    v_cvt_pk_bf16_f32 v190, v196, v197
    v_cvt_pk_bf16_f32 v191, v198, v199
    s_nop 1
    s_waitcnt lgkmcnt(10)
    v_mfma_f32_32x32x16_bf16 v[24:39], v[200:203], v[168:171], v[24:39]
    ds_read_b64_tr_b16 v[224:225], v13 offset:6144
    ds_read_b64_tr_b16 v[226:227], v14 offset:9216
    ds_read_b64_tr_b16 v[228:229], v15 offset:6144
    s_waitcnt lgkmcnt(11)
    v_mfma_f32_32x32x16_bf16 v[40:55], v[204:207], v[168:171], v[40:55]
    ds_read_b64_tr_b16 v[230:231], v16 offset:9216
    ds_read_b64_tr_b16 v[232:233], v13 offset:6272
    ds_read_b64_tr_b16 v[234:235], v14 offset:9344
    s_waitcnt lgkmcnt(12)
    v_mfma_f32_32x32x16_bf16 v[56:71], v[208:211], v[168:171], v[56:71]
    ds_read_b64_tr_b16 v[236:237], v15 offset:6272
    ds_read_b64_tr_b16 v[238:239], v16 offset:9344
    ds_read_b64_tr_b16 v[240:241], v13 offset:6400
    s_waitcnt lgkmcnt(13)
    v_mfma_f32_32x32x16_bf16 v[72:87], v[212:215], v[168:171], v[72:87]
    ds_read_b64_tr_b16 v[242:243], v14 offset:9472
    ds_read_b64_tr_b16 v[244:245], v15 offset:6400
    ds_read_b64_tr_b16 v[246:247], v16 offset:9472
    s_waitcnt lgkmcnt(14)
    v_mfma_f32_32x32x16_bf16 v[88:103], v[216:219], v[168:171], v[88:103]
    s_waitcnt lgkmcnt(12)
    v_mfma_f32_32x32x16_bf16 v[104:119], v[220:223], v[168:171], v[104:119]
    s_waitcnt vmcnt(12) lgkmcnt(0)
    s_barrier
    s_add_u32 s44, s41, s25
    s_add_u32 s41, s41, 12288
    s_cmp_eq_u32 s41, s79
    s_cselect_b32 s41, s78, s41
    v_add_u32 v13, s41, v9
    v_add_u32 v14, s41, v10
    v_add_u32 v15, s41, v11
    v_add_u32 v16, s41, v12
    v_mfma_f32_32x32x16_bf16 v[24:39], v[224:227], v[172:175], v[24:39]
    ds_read_b64_tr_b16 v[200:201], v13 offset:0
    ds_read_b64_tr_b16 v[202:203], v14 offset:3072
    ds_read_b64_tr_b16 v[204:205], v15 offset:0
    s_add_u32 m0, s44, 0
    s_nop 0
    buffer_load_dwordx4 v2, s[12:15], s43 offen nt lds
    v_mfma_f32_32x32x16_bf16 v[40:55], v[228:231], v[172:175], v[40:55]
    ds_read_b64_tr_b16 v[206:207], v16 offset:3072
    ds_read_b64_tr_b16 v[208:209], v13 offset:128
    ds_read_b64_tr_b16 v[210:211], v14 offset:3200
    v_mfma_f32_32x32x16_bf16 v[56:71], v[232:235], v[172:175], v[56:71]
    ds_read_b64_tr_b16 v[212:213], v15 offset:128
    ds_read_b64_tr_b16 v[214:215], v16 offset:3200
    ds_read_b64_tr_b16 v[216:217], v13 offset:256
    s_add_u32 m0, s44, 1024
    s_nop 0
    buffer_load_dwordx4 v3, s[12:15], s43 offen nt lds
    v_mfma_f32_32x32x16_bf16 v[72:87], v[236:239], v[172:175], v[72:87]
    ds_read_b64_tr_b16 v[218:219], v14 offset:3328
    ds_read_b64_tr_b16 v[220:221], v15 offset:256
    ds_read_b64_tr_b16 v[222:223], v16 offset:3328
    v_mfma_f32_32x32x16_bf16 v[88:103], v[240:243], v[172:175], v[88:103]
    s_add_u32 m0, s44, 2048
    s_nop 0
    buffer_load_dwordx4 v4, s[12:15], s43 offen nt lds
    s_add_u32 s43, s43, 12288
    v_mfma_f32_32x32x16_bf16 v[104:119], v[244:247], v[172:175], v[104:119]
    s_waitcnt lgkmcnt(10)
    v_mfma_f32_32x32x16_bf16 v[24:39], v[200:203], v[184:187], v[24:39]
    ds_read_b64_tr_b16 v[224:225], v13 offset:6144
    ds_read_b64_tr_b16 v[226:227], v14 offset:9216
    ds_read_b64_tr_b16 v[228:229], v15 offset:6144
    s_waitcnt lgkmcnt(11)
    v_mfma_f32_32x32x16_bf16 v[40:55], v[204:207], v[184:187], v[40:55]
    ds_read_b64_tr_b16 v[230:231], v16 offset:9216
    ds_read_b64_tr_b16 v[232:233], v13 offset:6272
    ds_read_b64_tr_b16 v[234:235], v14 offset:9344
    s_waitcnt lgkmcnt(12)
    v_mfma_f32_32x32x16_bf16 v[56:71], v[208:211], v[184:187], v[56:71]
    ds_read_b64_tr_b16 v[236:237], v15 offset:6272
    ds_read_b64_tr_b16 v[238:239], v16 offset:9344
    ds_read_b64_tr_b16 v[240:241], v13 offset:6400
    s_waitcnt lgkmcnt(13)
    v_mfma_f32_32x32x16_bf16 v[72:87], v[212:215], v[184:187], v[72:87]
    ds_read_b64_tr_b16 v[242:243], v14 offset:9472
    ds_read_b64_tr_b16 v[244:245], v15 offset:6400
    ds_read_b64_tr_b16 v[246:247], v16 offset:9472
    s_waitcnt lgkmcnt(14)
    v_mfma_f32_32x32x16_bf16 v[88:103], v[216:219], v[184:187], v[88:103]
    s_waitcnt lgkmcnt(12)
    v_mfma_f32_32x32x16_bf16 v[104:119], v[220:223], v[184:187], v[104:119]
    s_waitcnt vmcnt(12) lgkmcnt(0)
    s_barrier
    s_add_u32 s44, s41, s25
    s_add_u32 s41, s41, 12288
    s_cmp_eq_u32 s41, s79
    s_cselect_b32 s41, s78, s41
    v_add_u32 v13, s41, v5
    v_add_u32 v14, s41, v6
    v_add_u32 v15, s41, v7
    v_add_u32 v16, s41, v8
    v_mfma_f32_32x32x16_bf16 v[24:39], v[224:227], v[188:191], v[24:39]
    ds_read_b128 v[200:203], v13 offset:0
    ds_read_b128 v[204:207], v14 offset:0
    s_add_u32 m0, s44, 0
    s_nop 0
    buffer_load_dwordx4 v2, s[12:15], s43 offen nt lds
    v_mfma_f32_32x32x16_bf16 v[40:55], v[228:231], v[188:191], v[40:55]
    ds_read_b128 v[208:211], v15 offset:0
    ds_read_b128 v[212:215], v16 offset:0
    v_mfma_f32_32x32x16_bf16 v[56:71], v[232:235], v[188:191], v[56:71]
    ds_read_b128 v[216:219], v13 offset:128
    s_add_u32 m0, s44, 1024
    s_nop 0
    buffer_load_dwordx4 v3, s[12:15], s43 offen nt lds
    v_mfma_f32_32x32x16_bf16 v[72:87], v[236:239], v[188:191], v[72:87]
    ds_read_b128 v[220:223], v14 offset:128
    v_mfma_f32_32x32x16_bf16 v[88:103], v[240:243], v[188:191], v[88:103]
    s_add_u32 m0, s44, 2048
    s_nop 0
    buffer_load_dwordx4 v4, s[12:15], s43 offen nt lds
    s_add_u32 s43, s43, 12288
    v_mfma_f32_32x32x16_bf16 v[104:119], v[244:247], v[188:191], v[104:119]
    s_add_u32 s31, s31, 1
    s_cmp_lt_u32 s31, 6
    s_cbranch_scc1 L1_aloop
    s_mov_b32 s12, s76
    s_and_b32 s13, s77, 0xffff
    s_mov_b32 s14, s75
    s_mov_b32 s15, 0x00020000
    s_mov_b32 s43, 0
    s_waitcnt lgkmcnt(5)
    v_mfma_f32_32x32x16_bf16 v[168:183], v[200:203], v[120:123], 0
    ds_read_b128 v[224:227], v15 offset:128
    ds_read_b128 v[228:231], v16 offset:128
    s_waitcnt lgkmcnt(6)
    v_mfma_f32_32x32x16_bf16 v[168:183], v[204:207], v[124:127], v[168:183]
    ds_read_b128 v[232:235], v13 offset:256
    ds_read_b128 v[236:239], v14 offset:256
    s_waitcnt lgkmcnt(7)
    v_mfma_f32_32x32x16_bf16 v[168:183], v[208:211], v[128:131], v[168:183]
    ds_read_b128 v[240:243], v15 offset:256
    s_waitcnt lgkmcnt(7)
    v_mfma_f32_32x32x16_bf16 v[168:183], v[212:215], v[132:135], v[168:183]
    ds_read_b128 v[244:247], v16 offset:256
    s_waitcnt lgkmcnt(7)
    v_mfma_f32_32x32x16_bf16 v[168:183], v[216:219], v[136:139], v[168:183]
    s_waitcnt lgkmcnt(6)
    v_mfma_f32_32x32x16_bf16 v[168:183], v[220:223], v[140:143], v[168:183]
    s_waitcnt vmcnt(12) lgkmcnt(0)
    s_barrier
    s_add_u32 s44, s41, s25
    s_add_u32 s41, s41, 12288
    s_cmp_eq_u32 s41, s79
    s_cselect_b32 s41, s78, s41
    v_add_u32 v13, s41, v5
    v_add_u32 v14, s41, v6
    v_add_u32 v15, s41, v7
    v_add_u32 v16, s41, v8
    v_mfma_f32_32x32x16_bf16 v[168:183], v[224:227], v[144:147], v[168:183]
    ds_read_b128 v[200:203], v13 offset:0
    ds_read_b128 v[204:207], v14 offset:0
    s_add_u32 m0, s44, 0
    s_nop 0
    buffer_load_dwordx4 v2, s[16:19], s42 offen nt lds
    v_mfma_f32_32x32x16_bf16 v[168:183], v[228:231], v[148:151], v[168:183]
    ds_read_b128 v[208:211], v15 offset:0
    ds_read_b128 v[212:215], v16 offset:0
    v_mfma_f32_32x32x16_bf16 v[168:183], v[232:235], v[152:155], v[168:183]
    ds_read_b128 v[216:219], v13 offset:128
    s_add_u32 m0, s44, 1024
    s_nop 0
    buffer_load_dwordx4 v3, s[16:19], s42 offen nt lds
    v_mfma_f32_32x32x16_bf16 v[168:183], v[236:239], v[156:159], v[168:183]
    ds_read_b128 v[220:223], v14 offset:128
    v_mfma_f32_32x32x16_bf16 v[168:183], v[240:243], v[160:163], v[168:183]
    s_add_u32 m0, s44, 2048
    s_nop 0
    buffer_load_dwordx4 v4, s[16:19], s42 offen nt lds
    s_add_u32 s42, s42, 12288
    v_mfma_f32_32x32x16_bf16 v[168:183], v[244:247], v[164:167], v[168:183]
    s_waitcnt lgkmcnt(5)
    v_mfma_f32_32x32x16_bf16 v[184:199], v[200:203], v[120:123], 0
    ds_read_b128 v[224:227], v15 offset:128
    ds_read_b128 v[228:231], v16 offset:128
    s_waitcnt lgkmcnt(6)
    v_mfma_f32_32x32x16_bf16 v[184:199], v[204:207], v[124:127], v[184:199]
    ds_read_b128 v[232:235], v13 offset:256
    ds_read_b128 v[236:239], v14 offset:256
    s_waitcnt lgkmcnt(7)
    v_mfma_f32_32x32x16_bf16 v[184:199], v[208:211], v[128:131], v[184:199]
    ds_read_b128 v[240:243], v15 offset:256
    s_waitcnt lgkmcnt(7)
    v_mfma_f32_32x32x16_bf16 v[184:199], v[212:215], v[132:135], v[184:199]
    ds_read_b128 v[244:247], v16 offset:256
    s_waitcnt lgkmcnt(7)
    v_mfma_f32_32x32x16_bf16 v[184:199], v[216:219], v[136:139], v[184:199]
    s_waitcnt lgkmcnt(6)
    v_mfma_f32_32x32x16_bf16 v[184:199], v[220:223], v[140:143], v[184:199]
    s_waitcnt vmcnt(12) lgkmcnt(0)
    s_barrier
    s_add_u32 s44, s41, s25
    s_add_u32 s41, s41, 12288
    s_cmp_eq_u32 s41, s79
    s_cselect_b32 s41, s78, s41
    v_add_u32 v13, s41, v9
    v_add_u32 v14, s41, v10
    v_add_u32 v15, s41, v11
    v_add_u32 v16, s41, v12
    v_mfma_f32_32x32x16_bf16 v[184:199], v[224:227], v[144:147], v[184:199]
    ds_read_b64_tr_b16 v[200:201], v13 offset:0
    ds_read_b64_tr_b16 v[202:203], v14 offset:3072
    ds_read_b64_tr_b16 v[204:205], v15 offset:0
    s_add_u32 m0, s44, 0
    s_nop 0
    buffer_load_dwordx4 v2, s[16:19], s42 offen nt lds
    v_mfma_f32_32x32x16_bf16 v[184:199], v[228:231], v[148:151], v[184:199]
    ds_read_b64_tr_b16 v[206:207], v16 offset:3072
    ds_read_b64_tr_b16 v[208:209], v13 offset:128
    ds_read_b64_tr_b16 v[210:211], v14 offset:3200
    v_mfma_f32_32x32x16_bf16 v[184:199], v[232:235], v[152:155], v[184:199]
    ds_read_b64_tr_b16 v[212:213], v15 offset:128
    ds_read_b64_tr_b16 v[214:215], v16 offset:3200
    ds_read_b64_tr_b16 v[216:217], v13 offset:256
    s_add_u32 m0, s44, 1024
    s_nop 0
    buffer_load_dwordx4 v3, s[16:19], s42 offen nt lds
    v_mfma_f32_32x32x16_bf16 v[184:199], v[236:239], v[156:159], v[184:199]
    ds_read_b64_tr_b16 v[218:219], v14 offset:3328
    ds_read_b64_tr_b16 v[220:221], v15 offset:256
    ds_read_b64_tr_b16 v[222:223], v16 offset:3328
    v_mfma_f32_32x32x16_bf16 v[184:199], v[240:243], v[160:163], v[184:199]
    s_add_u32 m0, s44, 2048
    s_nop 0
    buffer_load_dwordx4 v4, s[16:19], s42 offen nt lds
    s_add_u32 s42, s42, 12288
    v_mfma_f32_32x32x16_bf16 v[184:199], v[244:247], v[164:167], v[184:199]
    v_max3_f32 v19, v168, v169, v170
    v_max3_f32 v19, v19, v171, v172
    v_max3_f32 v19, v19, v173, v174
    v_max3_f32 v19, v19, v175, v176
    v_max3_f32 v19, v19, v177, v178
    v_max3_f32 v19, v19, v179, v180
    v_max3_f32 v19, v19, v181, v182
    v_max3_f32 v19, v19, v183, v17
    s_nop 4
    v_max3_f32 v19, v19, v184, v185
    v_max3_f32 v19, v19, v186, v187
    v_max3_f32 v19, v19, v188, v189
    v_max3_f32 v19, v19, v190, v191
    v_max3_f32 v19, v19, v192, v193
    v_max3_f32 v19, v19, v194, v195
    v_max3_f32 v19, v19, v196, v197
    v_max3_f32 v19, v19, v198, v199
    v_mov_b32 v22, v19
    s_nop 1
    v_permlane32_swap_b32 v19, v22
    v_max_f32 v19, v19, v22
    v_sub_f32 v20, v17, v19
    v_mul_f32 v20, s40, v20
    v_exp_f32 v20, v20
    v_mov_b32 v17, v19
    v_mul_f32 v19, s40, v19
    v_mov_b32 v21, v20
    v_mul_f32 v18, v18, v20
    v_fma_f32 v168, v168, s40, -v19
    v_fma_f32 v169, v169, s40, -v19
    v_fma_f32 v170, v170, s40, -v19
    v_fma_f32 v171, v171, s40, -v19
    v_fma_f32 v172, v172, s40, -v19
    v_fma_f32 v173, v173, s40, -v19
    v_fma_f32 v174, v174, s40, -v19
    v_fma_f32 v175, v175, s40, -v19
    v_fma_f32 v176, v176, s40, -v19
    v_fma_f32 v177, v177, s40, -v19
    v_fma_f32 v178, v178, s40, -v19
    v_fma_f32 v179, v179, s40, -v19
    v_fma_f32 v180, v180, s40, -v19
    v_fma_f32 v181, v181, s40, -v19
    v_fma_f32 v182, v182, s40, -v19
    v_fma_f32 v183, v183, s40, -v19
    v_exp_f32 v168, v168
    v_exp_f32 v169, v169
    v_pk_mul_f32 v[24:25], v[24:25], v[20:21]
    v_exp_f32 v170, v170
    v_pk_mul_f32 v[26:27], v[26:27], v[20:21]
    v_exp_f32 v171, v171
    v_pk_mul_f32 v[28:29], v[28:29], v[20:21]
    v_exp_f32 v172, v172
    v_pk_mul_f32 v[30:31], v[30:31], v[20:21]
    v_exp_f32 v173, v173
    v_pk_mul_f32 v[32:33], v[32:33], v[20:21]
    v_exp_f32 v174, v174
    v_pk_mul_f32 v[34:35], v[34:35], v[20:21]
    v_exp_f32 v175, v175
    v_pk_mul_f32 v[36:37], v[36:37], v[20:21]
    v_exp_f32 v176, v176
    v_pk_mul_f32 v[38:39], v[38:39], v[20:21]
    v_exp_f32 v177, v177
    v_pk_mul_f32 v[40:41], v[40:41], v[20:21]
    v_exp_f32 v178, v178
    v_pk_mul_f32 v[42:43], v[42:43], v[20:21]
    v_exp_f32 v179, v179
    v_pk_mul_f32 v[44:45], v[44:45], v[20:21]
    v_exp_f32 v180, v180
    v_pk_mul_f32 v[46:47], v[46:47], v[20:21]
    v_exp_f32 v181, v181
    v_pk_mul_f32 v[48:49], v[48:49], v[20:21]
    v_exp_f32 v182, v182
    v_pk_mul_f32 v[50:51], v[50:51], v[20:21]
    v_exp_f32 v183, v183
    v_pk_mul_f32 v[52:53], v[52:53], v[20:21]
    v_pk_mul_f32 v[54:55], v[54:55], v[20:21]
    v_pk_mul_f32 v[56:57], v[56:57], v[20:21]
    v_pk_mul_f32 v[58:59], v[58:59], v[20:21]
    v_pk_mul_f32 v[60:61], v[60:61], v[20:21]
    v_pk_mul_f32 v[62:63], v[62:63], v[20:21]
    v_pk_mul_f32 v[64:65], v[64:65], v[20:21]
    v_pk_mul_f32 v[66:67], v[66:67], v[20:21]
    v_pk_mul_f32 v[68:69], v[68:69], v[20:21]
    v_pk_mul_f32 v[70:71], v[70:71], v[20:21]
    v_add_f32 v22, v168, v169
    v_add_f32 v22, v22, v170
    v_add_f32 v22, v22, v171
    v_add_f32 v22, v22, v172
    v_add_f32 v22, v22, v173
    v_add_f32 v22, v22, v174
    v_add_f32 v22, v22, v175
    v_add_f32 v22, v22, v176
    v_add_f32 v22, v22, v177
    v_add_f32 v22, v22, v178
    v_add_f32 v22, v22, v179
    v_add_f32 v22, v22, v180
    v_add_f32 v22, v22, v181
    v_add_f32 v22, v22, v182
    v_add_f32 v22, v22, v183
    v_add_f32 v18, v18, v22
    v_cvt_pk_bf16_f32 v168, v168, v169
    v_cvt_pk_bf16_f32 v169, v170, v171
    v_cvt_pk_bf16_f32 v170, v172, v173
    v_cvt_pk_bf16_f32 v171, v174, v175
    v_cvt_pk_bf16_f32 v172, v176, v177
    v_cvt_pk_bf16_f32 v173, v178, v179
    v_cvt_pk_bf16_f32 v174, v180, v181
    v_cvt_pk_bf16_f32 v175, v182, v183
    v_fma_f32 v184, v184, s40, -v19
    v_fma_f32 v185, v185, s40, -v19
    v_fma_f32 v186, v186, s40, -v19
    v_fma_f32 v187, v187, s40, -v19
    v_fma_f32 v188, v188, s40, -v19
    v_fma_f32 v189, v189, s40, -v19
    v_fma_f32 v190, v190, s40, -v19
    v_fma_f32 v191, v191, s40, -v19
    v_fma_f32 v192, v192, s40, -v19
    v_fma_f32 v193, v193, s40, -v19
    v_fma_f32 v194, v194, s40, -v19
    v_fma_f32 v195, v195, s40, -v19
    v_fma_f32 v196, v196, s40, -v19
    v_fma_f32 v197, v197, s40, -v19
    v_fma_f32 v198, v198, s40, -v19
    v_fma_f32 v199, v199, s40, -v19
    v_exp_f32 v184, v184
    v_exp_f32 v185, v185
    v_pk_mul_f32 v[72:73], v[72:73], v[20:21]
    v_exp_f32 v186, v186
    v_pk_mul_f32 v[74:75], v[74:75], v[20:21]
    v_exp_f32 v187, v187
    v_pk_mul_f32 v[76:77], v[76:77], v[20:21]
    v_exp_f32 v188, v188
    v_pk_mul_f32 v[78:79], v[78:79], v[20:21]
    v_exp_f32 v189, v189
    v_pk_mul_f32 v[80:81], v[80:81], v[20:21]
    v_exp_f32 v190, v190
    v_pk_mul_f32 v[82:83], v[82:83], v[20:21]
    v_exp_f32 v191, v191
    v_pk_mul_f32 v[84:85], v[84:85], v[20:21]
    v_exp_f32 v192, v192
    v_pk_mul_f32 v[86:87], v[86:87], v[20:21]
    v_exp_f32 v193, v193
    v_pk_mul_f32 v[88:89], v[88:89], v[20:21]
    v_exp_f32 v194, v194
    v_pk_mul_f32 v[90:91], v[90:91], v[20:21]
    v_exp_f32 v195, v195
    v_pk_mul_f32 v[92:93], v[92:93], v[20:21]
    v_exp_f32 v196, v196
    v_pk_mul_f32 v[94:95], v[94:95], v[20:21]
    v_exp_f32 v197, v197
    v_pk_mul_f32 v[96:97], v[96:97], v[20:21]
    v_exp_f32 v198, v198
    v_pk_mul_f32 v[98:99], v[98:99], v[20:21]
    v_exp_f32 v199, v199
    v_pk_mul_f32 v[100:101], v[100:101], v[20:21]
    v_pk_mul_f32 v[102:103], v[102:103], v[20:21]
    v_pk_mul_f32 v[104:105], v[104:105], v[20:21]
    v_pk_mul_f32 v[106:107], v[106:107], v[20:21]
    v_pk_mul_f32 v[108:109], v[108:109], v[20:21]
    v_pk_mul_f32 v[110:111], v[110:111], v[20:21]
    v_pk_mul_f32 v[112:113], v[112:113], v[20:21]
    v_pk_mul_f32 v[114:115], v[114:115], v[20:21]
    v_pk_mul_f32 v[116:117], v[116:117], v[20:21]
    v_pk_mul_f32 v[118:119], v[118:119], v[20:21]
    v_add_f32 v22, v184, v185
    v_add_f32 v22, v22, v186
    v_add_f32 v22, v22, v187
    v_add_f32 v22, v22, v188
    v_add_f32 v22, v22, v189
    v_add_f32 v22, v22, v190
    v_add_f32 v22, v22, v191
    v_add_f32 v22, v22, v192
    v_add_f32 v22, v22, v193
    v_add_f32 v22, v22, v194
    v_add_f32 v22, v22, v195
    v_add_f32 v22, v22, v196
    v_add_f32 v22, v22, v197
    v_add_f32 v22, v22, v198
    v_add_f32 v22, v22, v199
    v_add_f32 v18, v18, v22
    v_cvt_pk_bf16_f32 v184, v184, v185
    v_cvt_pk_bf16_f32 v185, v186, v187
    v_cvt_pk_bf16_f32 v186, v188, v189
    v_cvt_pk_bf16_f32 v187, v190, v191
    v_cvt_pk_bf16_f32 v188, v192, v193
    v_cvt_pk_bf16_f32 v189, v194, v195
    v_cvt_pk_bf16_f32 v190, v196, v197
    v_cvt_pk_bf16_f32 v191, v198, v199
    s_nop 1
    s_waitcnt lgkmcnt(10)
    v_mfma_f32_32x32x16_bf16 v[24:39], v[200:203], v[168:171], v[24:39]
    ds_read_b64_tr_b16 v[224:225], v13 offset:6144
    ds_read_b64_tr_b16 v[226:227], v14 offset:9216
    ds_read_b64_tr_b16 v[228:229], v15 offset:6144
    s_waitcnt lgkmcnt(11)
    v_mfma_f32_32x32x16_bf16 v[40:55], v[204:207], v[168:171], v[40:55]
    ds_read_b64_tr_b16 v[230:231], v16 offset:9216
    ds_read_b64_tr_b16 v[232:233], v13 offset:6272
    ds_read_b64_tr_b16 v[234:235], v14 offset:9344
    s_waitcnt lgkmcnt(12)
    v_mfma_f32_32x32x16_bf16 v[56:71], v[208:211], v[168:171], v[56:71]
    ds_read_b64_tr_b16 v[236:237], v15 offset:6272
    ds_read_b64_tr_b16 v[238:239], v16 offset:9344
    ds_read_b64_tr_b16 v[240:241], v13 offset:6400
    s_waitcnt lgkmcnt(13)
    v_mfma_f32_32x32x16_bf16 v[72:87], v[212:215], v[168:171], v[72:87]
    ds_read_b64_tr_b16 v[242:243], v14 offset:9472
    ds_read_b64_tr_b16 v[244:245], v15 offset:6400
    ds_read_b64_tr_b16 v[246:247], v16 offset:9472
    s_waitcnt lgkmcnt(14)
    v_mfma_f32_32x32x16_bf16 v[88:103], v[216:219], v[168:171], v[88:103]
    s_waitcnt lgkmcnt(12)
    v_mfma_f32_32x32x16_bf16 v[104:119], v[220:223], v[168:171], v[104:119]
    s_waitcnt vmcnt(12) lgkmcnt(0)
    s_barrier
    s_add_u32 s44, s41, s25
    s_add_u32 s41, s41, 12288
    s_cmp_eq_u32 s41, s79
    s_cselect_b32 s41, s78, s41
    v_add_u32 v13, s41, v9
    v_add_u32 v14, s41, v10
    v_add_u32 v15, s41, v11
    v_add_u32 v16, s41, v12
    v_mfma_f32_32x32x16_bf16 v[24:39], v[224:227], v[172:175], v[24:39]
    ds_read_b64_tr_b16 v[200:201], v13 offset:0
    ds_read_b64_tr_b16 v[202:203], v14 offset:3072
    ds_read_b64_tr_b16 v[204:205], v15 offset:0
    s_add_u32 m0, s44, 0
    s_nop 0
    buffer_load_dwordx4 v2, s[12:15], s43 offen lds
    v_mfma_f32_32x32x16_bf16 v[40:55], v[228:231], v[172:175], v[40:55]
    ds_read_b64_tr_b16 v[206:207], v16 offset:3072
    ds_read_b64_tr_b16 v[208:209], v13 offset:128
    ds_read_b64_tr_b16 v[210:211], v14 offset:3200
    v_mfma_f32_32x32x16_bf16 v[56:71], v[232:235], v[172:175], v[56:71]
    ds_read_b64_tr_b16 v[212:213], v15 offset:128
    ds_read_b64_tr_b16 v[214:215], v16 offset:3200
    ds_read_b64_tr_b16 v[216:217], v13 offset:256
    s_add_u32 m0, s44, 1024
    s_nop 0
    buffer_load_dwordx4 v3, s[12:15], s43 offen lds
    v_mfma_f32_32x32x16_bf16 v[72:87], v[236:239], v[172:175], v[72:87]
    ds_read_b64_tr_b16 v[218:219], v14 offset:3328
    ds_read_b64_tr_b16 v[220:221], v15 offset:256
    ds_read_b64_tr_b16 v[222:223], v16 offset:3328
    v_mfma_f32_32x32x16_bf16 v[88:103], v[240:243], v[172:175], v[88:103]
    s_add_u32 m0, s44, 2048
    s_nop 0
    buffer_load_dwordx4 v4, s[12:15], s43 offen lds
    s_add_u32 s43, s43, 12288
    v_mfma_f32_32x32x16_bf16 v[104:119], v[244:247], v[172:175], v[104:119]
    s_waitcnt lgkmcnt(10)
    v_mfma_f32_32x32x16_bf16 v[24:39], v[200:203], v[184:187], v[24:39]
    ds_read_b64_tr_b16 v[224:225], v13 offset:6144
    ds_read_b64_tr_b16 v[226:227], v14 offset:9216
    ds_read_b64_tr_b16 v[228:229], v15 offset:6144
    s_waitcnt lgkmcnt(11)
    v_mfma_f32_32x32x16_bf16 v[40:55], v[204:207], v[184:187], v[40:55]
    ds_read_b64_tr_b16 v[230:231], v16 offset:9216
    ds_read_b64_tr_b16 v[232:233], v13 offset:6272
    ds_read_b64_tr_b16 v[234:235], v14 offset:9344
    s_waitcnt lgkmcnt(12)
    v_mfma_f32_32x32x16_bf16 v[56:71], v[208:211], v[184:187], v[56:71]
    ds_read_b64_tr_b16 v[236:237], v15 offset:6272
    ds_read_b64_tr_b16 v[238:239], v16 offset:9344
    ds_read_b64_tr_b16 v[240:241], v13 offset:6400
    s_waitcnt lgkmcnt(13)
    v_mfma_f32_32x32x16_bf16 v[72:87], v[212:215], v[184:187], v[72:87]
    ds_read_b64_tr_b16 v[242:243], v14 offset:9472
    ds_read_b64_tr_b16 v[244:245], v15 offset:6400
    ds_read_b64_tr_b16 v[246:247], v16 offset:9472
    s_waitcnt lgkmcnt(14)
    v_mfma_f32_32x32x16_bf16 v[88:103], v[216:219], v[184:187], v[88:103]
    s_waitcnt lgkmcnt(12)
    v_mfma_f32_32x32x16_bf16 v[104:119], v[220:223], v[184:187], v[104:119]
    s_waitcnt vmcnt(12) lgkmcnt(0)
    s_barrier
    s_add_u32 s44, s41, s25
    s_add_u32 s41, s41, 12288
    s_cmp_eq_u32 s41, s79
    s_cselect_b32 s41, s78, s41
    v_add_u32 v13, s41, v5
    v_add_u32 v14, s41, v6
    v_add_u32 v15, s41, v7
    v_add_u32 v16, s41, v8
    v_mfma_f32_32x32x16_bf16 v[24:39], v[224:227], v[188:191], v[24:39]
    ds_read_b128 v[200:203], v13 offset:0
    ds_read_b128 v[204:207], v14 offset:0
    s_add_u32 m0, s44, 0
    s_nop 0
    buffer_load_dwordx4 v2, s[12:15], s43 offen lds
    v_mfma_f32_32x32x16_bf16 v[40:55], v[228:231], v[188:191], v[40:55]
    ds_read_b128 v[208:211], v15 offset:0
    ds_read_b128 v[212:215], v16 offset:0
    v_mfma_f32_32x32x16_bf16 v[56:71], v[232:235], v[188:191], v[56:71]
    ds_read_b128 v[216:219], v13 offset:128
    s_add_u32 m0, s44, 1024
    s_nop 0
    buffer_load_dwordx4 v3, s[12:15], s43 offen lds
    v_mfma_f32_32x32x16_bf16 v[72:87], v[236:239], v[188:191], v[72:87]
    ds_read_b128 v[220:223], v14 offset:128
    v_mfma_f32_32x32x16_bf16 v[88:103], v[240:243], v[188:191], v[88:103]
    s_add_u32 m0, s44, 2048
    s_nop 0
    buffer_load_dwordx4 v4, s[12:15], s43 offen lds
    s_add_u32 s43, s43, 12288
    v_mfma_f32_32x32x16_bf16 v[104:119], v[244:247], v[188:191], v[104:119]
    s_waitcnt lgkmcnt(5)
    v_mfma_f32_32x32x16_bf16 v[168:183], v[200:203], v[120:123], 0
    ds_read_b128 v[224:227], v15 offset:128
    ds_read_b128 v[228:231], v16 offset:128
    s_waitcnt lgkmcnt(6)
    v_mfma_f32_32x32x16_bf16 v[168:183], v[204:207], v[124:127], v[168:183]
    ds_read_b128 v[232:235], v13 offset:256
    ds_read_b128 v[236:239], v14 offset:256
    s_waitcnt lgkmcnt(7)
    v_mfma_f32_32x32x16_bf16 v[168:183], v[208:211], v[128:131], v[168:183]
    ds_read_b128 v[240:243], v15 offset:256
    s_waitcnt lgkmcnt(7)
    v_mfma_f32_32x32x16_bf16 v[168:183], v[212:215], v[132:135], v[168:183]
    ds_read_b128 v[244:247], v16 offset:256
    s_waitcnt lgkmcnt(7)
    v_mfma_f32_32x32x16_bf16 v[168:183], v[216:219], v[136:139], v[168:183]
    s_waitcnt lgkmcnt(6)
    v_mfma_f32_32x32x16_bf16 v[168:183], v[220:223], v[140:143], v[168:183]
    s_waitcnt vmcnt(12) lgkmcnt(0)
    s_barrier
    s_add_u32 s44, s41, s25
    s_add_u32 s41, s41, 12288
    s_cmp_eq_u32 s41, s79
    s_cselect_b32 s41, s78, s41
    v_add_u32 v13, s41, v5
    v_add_u32 v14, s41, v6
    v_add_u32 v15, s41, v7
    v_add_u32 v16, s41, v8
    v_mfma_f32_32x32x16_bf16 v[168:183], v[224:227], v[144:147], v[168:183]
    ds_read_b128 v[200:203], v13 offset:0
    ds_read_b128 v[204:207], v14 offset:0
    s_add_u32 m0, s44, 0
    s_nop 0
    buffer_load_dwordx4 v2, s[12:15], s43 offen lds
    v_mfma_f32_32x32x16_bf16 v[168:183], v[228:231], v[148:151], v[168:183]
    ds_read_b128 v[208:211], v15 offset:0
    ds_read_b128 v[212:215], v16 offset:0
    v_mfma_f32_32x32x16_bf16 v[168:183], v[232:235], v[152:155], v[168:183]
    ds_read_b128 v[216:219], v13 offset:128
    s_add_u32 m0, s44, 1024
    s_nop 0
    buffer_load_dwordx4 v3, s[12:15], s43 offen lds
    v_mfma_f32_32x32x16_bf16 v[168:183], v[236:239], v[156:159], v[168:183]
    ds_read_b128 v[220:223], v14 offset:128
    v_mfma_f32_32x32x16_bf16 v[168:183], v[240:243], v[160:163], v[168:183]
    s_add_u32 m0, s44, 2048
    s_nop 0
    buffer_load_dwordx4 v4, s[12:15], s43 offen lds
    s_add_u32 s43, s43, 12288
    v_mfma_f32_32x32x16_bf16 v[168:183], v[244:247], v[164:167], v[168:183]
    s_waitcnt lgkmcnt(5)
    v_mfma_f32_32x32x16_bf16 v[184:199], v[200:203], v[120:123], 0
    ds_read_b128 v[224:227], v15 offset:128
    ds_read_b128 v[228:231], v16 offset:128
    s_waitcnt lgkmcnt(6)
    v_mfma_f32_32x32x16_bf16 v[184:199], v[204:207], v[124:127], v[184:199]
    ds_read_b128 v[232:235], v13 offset:256
    ds_read_b128 v[236:239], v14 offset:256
    s_waitcnt lgkmcnt(7)
    v_mfma_f32_32x32x16_bf16 v[184:199], v[208:211], v[128:131], v[184:199]
    ds_read_b128 v[240:243], v15 offset:256
    s_waitcnt lgkmcnt(7)
    v_mfma_f32_32x32x16_bf16 v[184:199], v[212:215], v[132:135], v[184:199]
    ds_read_b128 v[244:247], v16 offset:256
    s_waitcnt lgkmcnt(7)
    v_mfma_f32_32x32x16_bf16 v[184:199], v[216:219], v[136:139], v[184:199]
    s_waitcnt lgkmcnt(6)
    v_mfma_f32_32x32x16_bf16 v[184:199], v[220:223], v[140:143], v[184:199]
    s_waitcnt vmcnt(12) lgkmcnt(0)
    s_barrier
    s_add_u32 s44, s41, s25
    s_add_u32 s41, s41, 12288
    s_cmp_eq_u32 s41, s79
    s_cselect_b32 s41, s78, s41
    v_add_u32 v13, s41, v9
    v_add_u32 v14, s41, v10
    v_add_u32 v15, s41, v11
    v_add_u32 v16, s41, v12
    v_mfma_f32_32x32x16_bf16 v[184:199], v[224:227], v[144:147], v[184:199]
    ds_read_b64_tr_b16 v[200:201], v13 offset:0
    ds_read_b64_tr_b16 v[202:203], v14 offset:3072
    ds_read_b64_tr_b16 v[204:205], v15 offset:0
    s_add_u32 m0, s44, 0
    s_nop 0
    buffer_load_dwordx4 v2, s[12:15], s43 offen lds
    v_mfma_f32_32x32x16_bf16 v[184:199], v[228:231], v[148:151], v[184:199]
    ds_read_b64_tr_b16 v[206:207], v16 offset:3072
    ds_read_b64_tr_b16 v[208:209], v13 offset:128
    ds_read_b64_tr_b16 v[210:211], v14 offset:3200
    v_mfma_f32_32x32x16_bf16 v[184:199], v[232:235], v[152:155], v[184:199]
    ds_read_b64_tr_b16 v[212:213], v15 offset:128
    ds_read_b64_tr_b16 v[214:215], v16 offset:3200
    ds_read_b64_tr_b16 v[216:217], v13 offset:256
    s_add_u32 m0, s44, 1024
    s_nop 0
    buffer_load_dwordx4 v3, s[12:15], s43 offen lds
    v_mfma_f32_32x32x16_bf16 v[184:199], v[236:239], v[156:159], v[184:199]
    ds_read_b64_tr_b16 v[218:219], v14 offset:3328
    ds_read_b64_tr_b16 v[220:221], v15 offset:256
    ds_read_b64_tr_b16 v[222:223], v16 offset:3328
    v_mfma_f32_32x32x16_bf16 v[184:199], v[240:243], v[160:163], v[184:199]
    s_add_u32 m0, s44, 2048
    s_nop 0
    buffer_load_dwordx4 v4, s[12:15], s43 offen lds
    s_add_u32 s43, s43, 12288
    v_mfma_f32_32x32x16_bf16 v[184:199], v[244:247], v[164:167], v[184:199]
    v_max3_f32 v19, v168, v169, v170
    v_max3_f32 v19, v19, v171, v172
    v_max3_f32 v19, v19, v173, v174
    v_max3_f32 v19, v19, v175, v176
    v_max3_f32 v19, v19, v177, v178
    v_max3_f32 v19, v19, v179, v180
    v_max3_f32 v19, v19, v181, v182
    v_max3_f32 v19, v19, v183, v17
    s_nop 4
    v_max3_f32 v19, v19, v184, v185
    v_max3_f32 v19, v19, v186, v187
    v_max3_f32 v19, v19, v188, v189
    v_max3_f32 v19, v19, v190, v191
    v_max3_f32 v19, v19, v192, v193
    v_max3_f32 v19, v19, v194, v195
    v_max3_f32 v19, v19, v196, v197
    v_max3_f32 v19, v19, v198, v199
    v_mov_b32 v22, v19
    s_nop 1
    v_permlane32_swap_b32 v19, v22
    v_max_f32 v19, v19, v22
    v_sub_f32 v20, v17, v19
    v_mul_f32 v20, s40, v20
    v_exp_f32 v20, v20
    v_mov_b32 v17, v19
    v_mul_f32 v19, s40, v19
    v_mov_b32 v21, v20
    v_mul_f32 v18, v18, v20
    v_fma_f32 v168, v168, s40, -v19
    v_fma_f32 v169, v169, s40, -v19
    v_fma_f32 v170, v170, s40, -v19
    v_fma_f32 v171, v171, s40, -v19
    v_fma_f32 v172, v172, s40, -v19
    v_fma_f32 v173, v173, s40, -v19
    v_fma_f32 v174, v174, s40, -v19
    v_fma_f32 v175, v175, s40, -v19
    v_fma_f32 v176, v176, s40, -v19
    v_fma_f32 v177, v177, s40, -v19
    v_fma_f32 v178, v178, s40, -v19
    v_fma_f32 v179, v179, s40, -v19
    v_fma_f32 v180, v180, s40, -v19
    v_fma_f32 v181, v181, s40, -v19
    v_fma_f32 v182, v182, s40, -v19
    v_fma_f32 v183, v183, s40, -v19
    v_exp_f32 v168, v168
    v_exp_f32 v169, v169
    v_pk_mul_f32 v[24:25], v[24:25], v[20:21]
    v_exp_f32 v170, v170
    v_pk_mul_f32 v[26:27], v[26:27], v[20:21]
    v_exp_f32 v171, v171
    v_pk_mul_f32 v[28:29], v[28:29], v[20:21]
    v_exp_f32 v172, v172
    v_pk_mul_f32 v[30:31], v[30:31], v[20:21]
    v_exp_f32 v173, v173
    v_pk_mul_f32 v[32:33], v[32:33], v[20:21]
    v_exp_f32 v174, v174
    v_pk_mul_f32 v[34:35], v[34:35], v[20:21]
    v_exp_f32 v175, v175
    v_pk_mul_f32 v[36:37], v[36:37], v[20:21]
    v_exp_f32 v176, v176
    v_pk_mul_f32 v[38:39], v[38:39], v[20:21]
    v_exp_f32 v177, v177
    v_pk_mul_f32 v[40:41], v[40:41], v[20:21]
    v_exp_f32 v178, v178
    v_pk_mul_f32 v[42:43], v[42:43], v[20:21]
    v_exp_f32 v179, v179
    v_pk_mul_f32 v[44:45], v[44:45], v[20:21]
    v_exp_f32 v180, v180
    v_pk_mul_f32 v[46:47], v[46:47], v[20:21]
    v_exp_f32 v181, v181
    v_pk_mul_f32 v[48:49], v[48:49], v[20:21]
    v_exp_f32 v182, v182
    v_pk_mul_f32 v[50:51], v[50:51], v[20:21]
    v_exp_f32 v183, v183
    v_pk_mul_f32 v[52:53], v[52:53], v[20:21]
    v_pk_mul_f32 v[54:55], v[54:55], v[20:21]
    v_pk_mul_f32 v[56:57], v[56:57], v[20:21]
    v_pk_mul_f32 v[58:59], v[58:59], v[20:21]
    v_pk_mul_f32 v[60:61], v[60:61], v[20:21]
    v_pk_mul_f32 v[62:63], v[62:63], v[20:21]
    v_pk_mul_f32 v[64:65], v[64:65], v[20:21]
    v_pk_mul_f32 v[66:67], v[66:67], v[20:21]
    v_pk_mul_f32 v[68:69], v[68:69], v[20:21]
    v_pk_mul_f32 v[70:71], v[70:71], v[20:21]
    v_add_f32 v22, v168, v169
    v_add_f32 v22, v22, v170
    v_add_f32 v22, v22, v171
    v_add_f32 v22, v22, v172
    v_add_f32 v22, v22, v173
    v_add_f32 v22, v22, v174
    v_add_f32 v22, v22, v175
    v_add_f32 v22, v22, v176
    v_add_f32 v22, v22, v177
    v_add_f32 v22, v22, v178
    v_add_f32 v22, v22, v179
    v_add_f32 v22, v22, v180
    v_add_f32 v22, v22, v181
    v_add_f32 v22, v22, v182
    v_add_f32 v22, v22, v183
    v_add_f32 v18, v18, v22
    v_cvt_pk_bf16_f32 v168, v168, v169
    v_cvt_pk_bf16_f32 v169, v170, v171
    v_cvt_pk_bf16_f32 v170, v172, v173
    v_cvt_pk_bf16_f32 v171, v174, v175
    v_cvt_pk_bf16_f32 v172, v176, v177
    v_cvt_pk_bf16_f32 v173, v178, v179
    v_cvt_pk_bf16_f32 v174, v180, v181
    v_cvt_pk_bf16_f32 v175, v182, v183
    v_fma_f32 v184, v184, s40, -v19
    v_fma_f32 v185, v185, s40, -v19
    v_fma_f32 v186, v186, s40, -v19
    v_fma_f32 v187, v187, s40, -v19
    v_fma_f32 v188, v188, s40, -v19
    v_fma_f32 v189, v189, s40, -v19
    v_fma_f32 v190, v190, s40, -v19
    v_fma_f32 v191, v191, s40, -v19
    v_fma_f32 v192, v192, s40, -v19
    v_fma_f32 v193, v193, s40, -v19
    v_fma_f32 v194, v194, s40, -v19
    v_fma_f32 v195, v195, s40, -v19
    v_fma_f32 v196, v196, s40, -v19
    v_fma_f32 v197, v197, s40, -v19
    v_fma_f32 v198, v198, s40, -v19
    v_fma_f32 v199, v199, s40, -v19
    v_exp_f32 v184, v184
    v_exp_f32 v185, v185
    v_pk_mul_f32 v[72:73], v[72:73], v[20:21]
    v_exp_f32 v186, v186
    v_pk_mul_f32 v[74:75], v[74:75], v[20:21]
    v_exp_f32 v187, v187
    v_pk_mul_f32 v[76:77], v[76:77], v[20:21]
    v_exp_f32 v188, v188
    v_pk_mul_f32 v[78:79], v[78:79], v[20:21]
    v_exp_f32 v189, v189
    v_pk_mul_f32 v[80:81], v[80:81], v[20:21]
    v_exp_f32 v190, v190
    v_pk_mul_f32 v[82:83], v[82:83], v[20:21]
    v_exp_f32 v191, v191
    v_pk_mul_f32 v[84:85], v[84:85], v[20:21]
    v_exp_f32 v192, v192
    v_pk_mul_f32 v[86:87], v[86:87], v[20:21]
    v_exp_f32 v193, v193
    v_pk_mul_f32 v[88:89], v[88:89], v[20:21]
    v_exp_f32 v194, v194
    v_pk_mul_f32 v[90:91], v[90:91], v[20:21]
    v_exp_f32 v195, v195
    v_pk_mul_f32 v[92:93], v[92:93], v[20:21]
    v_exp_f32 v196, v196
    v_pk_mul_f32 v[94:95], v[94:95], v[20:21]
    v_exp_f32 v197, v197
    v_pk_mul_f32 v[96:97], v[96:97], v[20:21]
    v_exp_f32 v198, v198
    v_pk_mul_f32 v[98:99], v[98:99], v[20:21]
    v_exp_f32 v199, v199
    v_pk_mul_f32 v[100:101], v[100:101], v[20:21]
    v_pk_mul_f32 v[102:103], v[102:103], v[20:21]
    v_pk_mul_f32 v[104:105], v[104:105], v[20:21]
    v_pk_mul_f32 v[106:107], v[106:107], v[20:21]
    v_pk_mul_f32 v[108:109], v[108:109], v[20:21]
    v_pk_mul_f32 v[110:111], v[110:111], v[20:21]
    v_pk_mul_f32 v[112:113], v[112:113], v[20:21]
    v_pk_mul_f32 v[114:115], v[114:115], v[20:21]
    v_pk_mul_f32 v[116:117], v[116:117], v[20:21]
    v_pk_mul_f32 v[118:119], v[118:119], v[20:21]
    v_add_f32 v22, v184, v185
    v_add_f32 v22, v22, v186
    v_add_f32 v22, v22, v187
    v_add_f32 v22, v22, v188
    v_add_f32 v22, v22, v189
    v_add_f32 v22, v22, v190
    v_add_f32 v22, v22, v191
    v_add_f32 v22, v22, v192
    v_add_f32 v22, v22, v193
    v_add_f32 v22, v22, v194
    v_add_f32 v22, v22, v195
    v_add_f32 v22, v22, v196
    v_add_f32 v22, v22, v197
    v_add_f32 v22, v22, v198
    v_add_f32 v22, v22, v199
    v_add_f32 v18, v18, v22
    v_cvt_pk_bf16_f32 v184, v184, v185
    v_cvt_pk_bf16_f32 v185, v186, v187
    v_cvt_pk_bf16_f32 v186, v188, v189
    v_cvt_pk_bf16_f32 v187, v190, v191
    v_cvt_pk_bf16_f32 v188, v192, v193
    v_cvt_pk_bf16_f32 v189, v194, v195
    v_cvt_pk_bf16_f32 v190, v196, v197
    v_cvt_pk_bf16_f32 v191, v198, v199
    s_nop 1
    s_waitcnt lgkmcnt(10)
    v_mfma_f32_32x32x16_bf16 v[24:39], v[200:203], v[168:171], v[24:39]
    ds_read_b64_tr_b16 v[224:225], v13 offset:6144
    ds_read_b64_tr_b16 v[226:227], v14 offset:9216
    ds_read_b64_tr_b16 v[228:229], v15 offset:6144
    s_waitcnt lgkmcnt(11)
    v_mfma_f32_32x32x16_bf16 v[40:55], v[204:207], v[168:171], v[40:55]
    ds_read_b64_tr_b16 v[230:231], v16 offset:9216
    ds_read_b64_tr_b16 v[232:233], v13 offset:6272
    ds_read_b64_tr_b16 v[234:235], v14 offset:9344
    s_waitcnt lgkmcnt(12)
    v_mfma_f32_32x32x16_bf16 v[56:71], v[208:211], v[168:171], v[56:71]
    ds_read_b64_tr_b16 v[236:237], v15 offset:6272
    ds_read_b64_tr_b16 v[238:239], v16 offset:9344
    ds_read_b64_tr_b16 v[240:241], v13 offset:6400
    s_waitcnt lgkmcnt(13)
    v_mfma_f32_32x32x16_bf16 v[72:87], v[212:215], v[168:171], v[72:87]
    ds_read_b64_tr_b16 v[242:243], v14 offset:9472
    ds_read_b64_tr_b16 v[244:245], v15 offset:6400
    ds_read_b64_tr_b16 v[246:247], v16 offset:9472
    s_waitcnt lgkmcnt(14)
    v_mfma_f32_32x32x16_bf16 v[88:103], v[216:219], v[168:171], v[88:103]
    s_waitcnt lgkmcnt(12)
    v_mfma_f32_32x32x16_bf16 v[104:119], v[220:223], v[168:171], v[104:119]
    s_waitcnt vmcnt(12) lgkmcnt(0)
    s_barrier
    s_add_u32 s44, s41, s25
    s_add_u32 s41, s41, 12288
    s_cmp_eq_u32 s41, s79
    s_cselect_b32 s41, s78, s41
    v_add_u32 v13, s41, v9
    v_add_u32 v14, s41, v10
    v_add_u32 v15, s41, v11
    v_add_u32 v16, s41, v12
    v_mfma_f32_32x32x16_bf16 v[24:39], v[224:227], v[172:175], v[24:39]
    ds_read_b64_tr_b16 v[200:201], v13 offset:0
    ds_read_b64_tr_b16 v[202:203], v14 offset:3072
    ds_read_b64_tr_b16 v[204:205], v15 offset:0
    s_add_u32 m0, s44, 0
    s_nop 0
    buffer_load_dwordx4 v2, s[12:15], s43 offen lds
    v_mfma_f32_32x32x16_bf16 v[40:55], v[228:231], v[172:175], v[40:55]
    ds_read_b64_tr_b16 v[206:207], v16 offset:3072
    ds_read_b64_tr_b16 v[208:209], v13 offset:128
    ds_read_b64_tr_b16 v[210:211], v14 offset:3200
    v_mfma_f32_32x32x16_bf16 v[56:71], v[232:235], v[172:175], v[56:71]
    ds_read_b64_tr_b16 v[212:213], v15 offset:128
    ds_read_b64_tr_b16 v[214:215], v16 offset:3200
    ds_read_b64_tr_b16 v[216:217], v13 offset:256
    s_add_u32 m0, s44, 1024
    s_nop 0
    buffer_load_dwordx4 v3, s[12:15], s43 offen lds
    v_mfma_f32_32x32x16_bf16 v[72:87], v[236:239], v[172:175], v[72:87]
    ds_read_b64_tr_b16 v[218:219], v14 offset:3328
    ds_read_b64_tr_b16 v[220:221], v15 offset:256
    ds_read_b64_tr_b16 v[222:223], v16 offset:3328
    v_mfma_f32_32x32x16_bf16 v[88:103], v[240:243], v[172:175], v[88:103]
    s_add_u32 m0, s44, 2048
    s_nop 0
    buffer_load_dwordx4 v4, s[12:15], s43 offen lds
    s_add_u32 s43, s43, 12288
    v_mfma_f32_32x32x16_bf16 v[104:119], v[244:247], v[172:175], v[104:119]
    s_waitcnt lgkmcnt(10)
    v_mfma_f32_32x32x16_bf16 v[24:39], v[200:203], v[184:187], v[24:39]
    ds_read_b64_tr_b16 v[224:225], v13 offset:6144
    ds_read_b64_tr_b16 v[226:227], v14 offset:9216
    ds_read_b64_tr_b16 v[228:229], v15 offset:6144
    s_waitcnt lgkmcnt(11)
    v_mfma_f32_32x32x16_bf16 v[40:55], v[204:207], v[184:187], v[40:55]
    ds_read_b64_tr_b16 v[230:231], v16 offset:9216
    ds_read_b64_tr_b16 v[232:233], v13 offset:6272
    ds_read_b64_tr_b16 v[234:235], v14 offset:9344
    s_waitcnt lgkmcnt(12)
    v_mfma_f32_32x32x16_bf16 v[56:71], v[208:211], v[184:187], v[56:71]
    ds_read_b64_tr_b16 v[236:237], v15 offset:6272
    ds_read_b64_tr_b16 v[238:239], v16 offset:9344
    ds_read_b64_tr_b16 v[240:241], v13 offset:6400
    s_waitcnt lgkmcnt(13)
    v_mfma_f32_32x32x16_bf16 v[72:87], v[212:215], v[184:187], v[72:87]
    ds_read_b64_tr_b16 v[242:243], v14 offset:9472
    ds_read_b64_tr_b16 v[244:245], v15 offset:6400
    ds_read_b64_tr_b16 v[246:247], v16 offset:9472
    s_waitcnt lgkmcnt(14)
    v_mfma_f32_32x32x16_bf16 v[88:103], v[216:219], v[184:187], v[88:103]
    s_waitcnt lgkmcnt(12)
    v_mfma_f32_32x32x16_bf16 v[104:119], v[220:223], v[184:187], v[104:119]
    s_waitcnt vmcnt(63) lgkmcnt(0)
    s_barrier
    s_add_u32 s44, s41, s25
    s_add_u32 s41, s41, 12288
    s_cmp_eq_u32 s41, s79
    s_cselect_b32 s41, s78, s41
    v_add_u32 v13, s41, v5
    v_add_u32 v14, s41, v6
    v_add_u32 v15, s41, v7
    v_add_u32 v16, s41, v8
    v_mfma_f32_32x32x16_bf16 v[24:39], v[224:227], v[188:191], v[24:39]
    ds_read_b128 v[200:203], v13 offset:0
    ds_read_b128 v[204:207], v14 offset:0
    s_add_u32 m0, s44, 0
    s_nop 0
    buffer_load_dwordx4 v2, s[12:15], s43 offen lds
    v_mfma_f32_32x32x16_bf16 v[40:55], v[228:231], v[188:191], v[40:55]
    ds_read_b128 v[208:211], v15 offset:0
    ds_read_b128 v[212:215], v16 offset:0
    v_mfma_f32_32x32x16_bf16 v[56:71], v[232:235], v[188:191], v[56:71]
    ds_read_b128 v[216:219], v13 offset:128
    s_add_u32 m0, s44, 1024
    s_nop 0
    buffer_load_dwordx4 v3, s[12:15], s43 offen lds
    v_mfma_f32_32x32x16_bf16 v[72:87], v[236:239], v[188:191], v[72:87]
    ds_read_b128 v[220:223], v14 offset:128
    v_mfma_f32_32x32x16_bf16 v[88:103], v[240:243], v[188:191], v[88:103]
    s_add_u32 m0, s44, 2048
    s_nop 0
    buffer_load_dwordx4 v4, s[12:15], s43 offen lds
    s_add_u32 s43, s43, 12288
    v_mfma_f32_32x32x16_bf16 v[104:119], v[244:247], v[188:191], v[104:119]
    s_lshr_b32 s46, s2, 6
    s_lshl_b32 s46, s46, 5
    v_lshlrev_b32 v250, 2, v1
    s_cmp_lg_u32 s27, 4
    s_cbranch_scc1 L1_nl
    s_mov_b64 exec, 0xff
    buffer_load_dword v251, v250, s[92:95], s46 offen sc1
    s_mov_b64 exec, -1
L1_nl:
    v_mov_b32 v22, v18
    s_nop 1
    v_permlane32_swap_b32 v18, v22
    v_add_f32 v18, v18, v22
    v_rcp_f32 v20, v18
    v_lshlrev_b32 v19, 4, v1
    s_nop 7
    v_mov_b32 v21, v20
    s_mov_b32 s44, 0
    v_pk_mul_f32 v[24:25], v[24:25], v[20:21]
    v_pk_mul_f32 v[26:27], v[26:27], v[20:21]
    v_pk_mul_f32 v[28:29], v[28:29], v[20:21]
    v_pk_mul_f32 v[30:31], v[30:31], v[20:21]
    v_cvt_pk_bf16_f32 v120, v24, v25
    v_cvt_pk_bf16_f32 v121, v26, v27
    v_cvt_pk_bf16_f32 v122, v28, v29
    v_cvt_pk_bf16_f32 v123, v30, v31
    buffer_store_dwordx4 v[120:123], v19, s[20:23], s44 offen offset:0
    v_pk_mul_f32 v[32:33], v[32:33], v[20:21]
    v_pk_mul_f32 v[34:35], v[34:35], v[20:21]
    v_pk_mul_f32 v[36:37], v[36:37], v[20:21]
    v_pk_mul_f32 v[38:39], v[38:39], v[20:21]
    v_cvt_pk_bf16_f32 v124, v32, v33
    v_cvt_pk_bf16_f32 v125, v34, v35
    v_cvt_pk_bf16_f32 v126, v36, v37
    v_cvt_pk_bf16_f32 v127, v38, v39
    buffer_store_dwordx4 v[124:127], v19, s[20:23], s44 offen offset:1024
    v_pk_mul_f32 v[40:41], v[40:41], v[20:21]
    v_pk_mul_f32 v[42:43], v[42:43], v[20:21]
    v_pk_mul_f32 v[44:45], v[44:45], v[20:21]
    v_pk_mul_f32 v[46:47], v[46:47], v[20:21]
    v_cvt_pk_bf16_f32 v128, v40, v41
    v_cvt_pk_bf16_f32 v129, v42, v43
    v_cvt_pk_bf16_f32 v130, v44, v45
    v_cvt_pk_bf16_f32 v131, v46, v47
    buffer_store_dwordx4 v[128:131], v19, s[20:23], s44 offen offset:2048
    v_pk_mul_f32 v[48:49], v[48:49], v[20:21]
    v_pk_mul_f32 v[50:51], v[50:51], v[20:21]
    v_pk_mul_f32 v[52:53], v[52:53], v[20:21]
    v_pk_mul_f32 v[54:55], v[54:55], v[20:21]
    v_cvt_pk_bf16_f32 v132, v48, v49
    v_cvt_pk_bf16_f32 v133, v50, v51
    v_cvt_pk_bf16_f32 v134, v52, v53
    v_cvt_pk_bf16_f32 v135, v54, v55
    buffer_store_dwordx4 v[132:135], v19, s[20:23], s44 offen offset:3072
    v_pk_mul_f32 v[56:57], v[56:57], v[20:21]
    v_pk_mul_f32 v[58:59], v[58:59], v[20:21]
    v_pk_mul_f32 v[60:61], v[60:61], v[20:21]
    v_pk_mul_f32 v[62:63], v[62:63], v[20:21]
    v_cvt_pk_bf16_f32 v136, v56, v57
    v_cvt_pk_bf16_f32 v137, v58, v59
    v_cvt_pk_bf16_f32 v138, v60, v61
    v_cvt_pk_bf16_f32 v139, v62, v63
    s_add_u32 s44, s44, 4096
    buffer_store_dwordx4 v[136:139], v19, s[20:23], s44 offen offset:0
    v_pk_mul_f32 v[64:65], v[64:65], v[20:21]
    v_pk_mul_f32 v[66:67], v[66:67], v[20:21]
    v_pk_mul_f32 v[68:69], v[68:69], v[20:21]
    v_pk_mul_f32 v[70:71], v[70:71], v[20:21]
    v_cvt_pk_bf16_f32 v140, v64, v65
    v_cvt_pk_bf16_f32 v141, v66, v67
    v_cvt_pk_bf16_f32 v142, v68, v69
    v_cvt_pk_bf16_f32 v143, v70, v71
    buffer_store_dwordx4 v[140:143], v19, s[20:23], s44 offen offset:1024
    v_pk_mul_f32 v[72:73], v[72:73], v[20:21]
    v_pk_mul_f32 v[74:75], v[74:75], v[20:21]
    v_pk_mul_f32 v[76:77], v[76:77], v[20:21]
    v_pk_mul_f32 v[78:79], v[78:79], v[20:21]
    v_cvt_pk_bf16_f32 v144, v72, v73
    v_cvt_pk_bf16_f32 v145, v74, v75
    v_cvt_pk_bf16_f32 v146, v76, v77
    v_cvt_pk_bf16_f32 v147, v78, v79
    buffer_store_dwordx4 v[144:147], v19, s[20:23], s44 offen offset:2048
    v_pk_mul_f32 v[80:81], v[80:81], v[20:21]
    v_pk_mul_f32 v[82:83], v[82:83], v[20:21]
    v_pk_mul_f32 v[84:85], v[84:85], v[20:21]
    v_pk_mul_f32 v[86:87], v[86:87], v[20:21]
    v_cvt_pk_bf16_f32 v148, v80, v81
    v_cvt_pk_bf16_f32 v149, v82, v83
    v_cvt_pk_bf16_f32 v150, v84, v85
    v_cvt_pk_bf16_f32 v151, v86, v87
    buffer_store_dwordx4 v[148:151], v19, s[20:23], s44 offen offset:3072
    v_pk_mul_f32 v[88:89], v[88:89], v[20:21]
    v_pk_mul_f32 v[90:91], v[90:91], v[20:21]
    v_pk_mul_f32 v[92:93], v[92:93], v[20:21]
    v_pk_mul_f32 v[94:95], v[94:95], v[20:21]
    v_cvt_pk_bf16_f32 v152, v88, v89
    v_cvt_pk_bf16_f32 v153, v90, v91
    v_cvt_pk_bf16_f32 v154, v92, v93
    v_cvt_pk_bf16_f32 v155, v94, v95
    s_add_u32 s44, s44, 4096
    buffer_store_dwordx4 v[152:155], v19, s[20:23], s44 offen offset:0
    v_pk_mul_f32 v[96:97], v[96:97], v[20:21]
    v_pk_mul_f32 v[98:99], v[98:99], v[20:21]
    v_pk_mul_f32 v[100:101], v[100:101], v[20:21]
    v_pk_mul_f32 v[102:103], v[102:103], v[20:21]
    v_cvt_pk_bf16_f32 v156, v96, v97
    v_cvt_pk_bf16_f32 v157, v98, v99
    v_cvt_pk_bf16_f32 v158, v100, v101
    v_cvt_pk_bf16_f32 v159, v102, v103
    buffer_store_dwordx4 v[156:159], v19, s[20:23], s44 offen offset:1024
    v_pk_mul_f32 v[104:105], v[104:105], v[20:21]
    v_pk_mul_f32 v[106:107], v[106:107], v[20:21]
    v_pk_mul_f32 v[108:109], v[108:109], v[20:21]
    v_pk_mul_f32 v[110:111], v[110:111], v[20:21]
    v_cvt_pk_bf16_f32 v160, v104, v105
    v_cvt_pk_bf16_f32 v161, v106, v107
    v_cvt_pk_bf16_f32 v162, v108, v109
    v_cvt_pk_bf16_f32 v163, v110, v111
    buffer_store_dwordx4 v[160:163], v19, s[20:23], s44 offen offset:2048
    v_pk_mul_f32 v[112:113], v[112:113], v[20:21]
    v_pk_mul_f32 v[114:115], v[114:115], v[20:21]
    v_pk_mul_f32 v[116:117], v[116:117], v[20:21]
    v_pk_mul_f32 v[118:119], v[118:119], v[20:21]
    v_cvt_pk_bf16_f32 v164, v112, v113
    v_cvt_pk_bf16_f32 v165, v114, v115
    v_cvt_pk_bf16_f32 v166, v116, v117
    v_cvt_pk_bf16_f32 v167, v118, v119
    buffer_store_dwordx4 v[164:167], v19, s[20:23], s44 offen offset:3072
    s_mov_b64 s[36:37], s[84:85]
    s_mov_b64 s[38:39], s[52:53]
    s_lshr_b32 s55, s2, 3
    s_and_b32 s57, s2, 3
    s_lshr_b32 s58, s55, 3
    s_and_b32 s59, s55, 4
    s_add_u32 s58, s58, s59
    s_and_b32 s59, s55, 3
    s_mul_i32 s25, s27, 5120
    s_mul_i32 s60, s27, 20480
    v_add_u32 v10, 0, v1
    v_mul_u32_u24 v11, 3277, v10
    v_lshrrev_b32 v11, 16, v11
    v_mul_u32_u24 v12, 20, v11
    v_sub_u32 v12, v10, v12
    v_bfe_u32 v13, v11, 2, 1
    v_lshlrev_b32 v13, 1, v13
    v_xor_b32 v12, v12, v13
    v_mul_u32_u24 v11, 1280, v11
    v_lshl_add_u32 v11, v12, 4, v11
    v_add_u32 v2, s60, v11
    v_add_u32 v10, 64, v1
    v_mul_u32_u24 v11, 3277, v10
    v_lshrrev_b32 v11, 16, v11
    v_mul_u32_u24 v12, 20, v11
    v_sub_u32 v12, v10, v12
    v_bfe_u32 v13, v11, 2, 1
    v_lshlrev_b32 v13, 1, v13
    v_xor_b32 v12, v12, v13
    v_mul_u32_u24 v11, 1280, v11
    v_lshl_add_u32 v11, v12, 4, v11
    v_add_u32 v3, s60, v11
    v_add_u32 v10, 128, v1
    v_mul_u32_u24 v11, 3277, v10
    v_lshrrev_b32 v11, 16, v11
    v_mul_u32_u24 v12, 20, v11
    v_sub_u32 v12, v10, v12
    v_bfe_u32 v13, v11, 2, 1
    v_lshlrev_b32 v13, 1, v13
    v_xor_b32 v12, v12, v13
    v_mul_u32_u24 v11, 1280, v11
    v_lshl_add_u32 v11, v12, 4, v11
    v_add_u32 v4, s60, v11
    v_add_u32 v10, 192, v1
    v_mul_u32_u24 v11, 3277, v10
    v_lshrrev_b32 v11, 16, v11
    v_mul_u32_u24 v12, 20, v11
    v_sub_u32 v12, v10, v12
    v_bfe_u32 v13, v11, 2, 1
    v_lshlrev_b32 v13, 1, v13
    v_xor_b32 v12, v12, v13
    v_mul_u32_u24 v11, 1280, v11
    v_lshl_add_u32 v11, v12, 4, v11
    v_add_u32 v5, s60, v11
    v_add_u32 v10, 256, v1
    v_mul_u32_u24 v11, 3277, v10
    v_lshrrev_b32 v11, 16, v11
    v_mul_u32_u24 v12, 20, v11
    v_sub_u32 v12, v10, v12
    v_bfe_u32 v13, v11, 2, 1
    v_lshlrev_b32 v13, 1, v13
    v_xor_b32 v12, v12, v13
    v_mul_u32_u24 v11, 1280, v11
    v_lshl_add_u32 v11, v12, 4, v11
    v_add_u32 v6, s60, v11
    v_lshrrev_b32 v10, 4, v1
    v_and_b32 v11, 15, v1
    v_lshlrev_b32 v11, 4, v11
    v_lshl_add_u32 v7, v10, 9, v11
    s_mov_b64 s[62:63], s[80:81]
    s_mul_i32 s60, s57, 1966080
    s_mul_i32 s61, s59, 320
    s_add_u32 s60, s60, s61
    s_add_u32 s62, s62, s60
    s_addc_u32 s63, s63, 0
    s_sub_u32 s64, 1966080, s61
    s_mov_b32 s4, s62
    s_and_b32 s5, s63, 0xffff
    s_mov_b32 s6, s64
    s_mov_b32 s7, 0x00020000
    s_lshl_b32 s60, s56, 3
    s_add_u32 s60, s60, s58
    s_lshl_b32 s60, s60, 2
    s_add_u32 s60, s60, s24
    s_lshl_b32 s60, s60, 2
    s_add_u32 s60, s60, s57
    s_mul_i32 s60, s60, 98304
    s_add_u32 s66, s38, s60
    s_addc_u32 s67, s39, 0
    s_mov_b32 s8, s66
    s_and_b32 s9, s67, 0xffff
    s_mov_b32 s10, 0x18000
    s_mov_b32 s11, 0x00020000
    s_add_u32 s28, s58, s59
    s_lshl_b32 s29, s54, 12
    s_add_u32 s60, s28, 0
    s_and_b32 s60, s60, 3
    s_mul_i32 s68, s60, 163840
    s_lshl_b32 s60, s60, 13
    s_add_u32 s72, s60, s29
    s_add_u32 s60, s28, 1
    s_and_b32 s60, s60, 3
    s_mul_i32 s69, s60, 163840
    s_lshl_b32 s60, s60, 13
    s_add_u32 s73, s60, s29
    s_add_u32 s60, s28, 2
    s_and_b32 s60, s60, 3
    s_mul_i32 s70, s60, 163840
    s_lshl_b32 s60, s60, 13
    s_add_u32 s74, s60, s29
    s_add_u32 s60, s28, 3
    s_and_b32 s60, s60, 3
    s_mul_i32 s71, s60, 163840
    s_lshl_b32 s60, s60, 13
    s_add_u32 s75, s60, s29
    s_getreg_b32 s83, hwreg(HW_REG_XCC_ID, 0, 4)
    s_and_b32 s83, s83, 7
    s_lshl_b32 s83, s83, 2
    s_lshl_b32 s83, 8, s83
    s_cmp_lg_u32 s54, 0
    s_cbranch_scc1 L2_nb
    s_waitcnt vmcnt(12) lgkmcnt(0)
    s_barrier
    s_add_u32 s60, s68, 81920
    s_add_u32 m0, s25, 0
    s_nop 0
    buffer_load_dwordx4 v2, s[4:7], s68 offen lds
    s_add_u32 m0, s25, 1024
    s_nop 0
    buffer_load_dwordx4 v3, s[4:7], s68 offen lds
    s_add_u32 m0, s25, 2048
    s_nop 0
    buffer_load_dwordx4 v4, s[4:7], s68 offen lds
    s_add_u32 m0, s25, 3072
    s_nop 0
    buffer_load_dwordx4 v5, s[4:7], s68 offen lds
    s_add_u32 m0, s25, 4096
    s_nop 0
    buffer_load_dwordx4 v6, s[4:7], s68 offen lds
    s_add_u32 m0, s25, 20480
    s_nop 0
    buffer_load_dwordx4 v2, s[4:7], s60 offen lds
    s_add_u32 m0, s25, 21504
    s_nop 0
    buffer_load_dwordx4 v3, s[4:7], s60 offen lds
    s_add_u32 m0, s25, 22528
    s_nop 0
    buffer_load_dwordx4 v4, s[4:7], s60 offen lds
    s_add_u32 m0, s25, 23552
    s_nop 0
    buffer_load_dwordx4 v5, s[4:7], s60 offen lds
    s_add_u32 m0, s25, 24576
    s_nop 0
    buffer_load_dwordx4 v6, s[4:7], s60 offen lds
    s_barrier
    s_barrier
    s_barrier
    s_barrier
    s_barrier
    s_barrier
    s_barrier
L2_nb:
    s_add_u32 s68, s68, 655360
    v_lshrrev_b32 v10, 5, v1
    v_bfe_u32 v11, v1, 4, 1
    v_lshlrev_b32 v10, 4, v10
    v_lshl_add_u32 v10, v11, 2, v10
    v_bfe_u32 v12, v1, 2, 2
    v_add_u32 v10, v10, v12
    s_lshl_b32 s60, s54, 6
    v_add_u32 v10, s60, v10
    v_mul_u32_u24 v10, 320, v10
    v_and_b32 v12, 3, v1
    v_lshl_add_u32 v10, v12, 3, v10
    v_lshlrev_b32 v11, 5, v11
    v_add_u32 v240, v10, v11
    v_sub_u32 v10, v10, v11
    v_add_u32 v241, 32, v10
    v_add_u32 v242, 40960, v240
    v_add_u32 v243, 40960, v241
    v_add_u32 v244, 81920, v240
    v_add_u32 v245, 81920, v241
    v_add_u32 v246, 122880, v240
    v_add_u32 v247, 122880, v241
    v_mov_b32 v16, 0
    v_mov_b32 v17, 0
    v_mov_b32 v18, 0
    v_mov_b32 v19, 0
    v_mov_b32 v20, 0
    v_mov_b32 v21, 0
    v_mov_b32 v22, 0
    v_mov_b32 v23, 0
    v_mov_b32 v24, 0
    v_mov_b32 v25, 0
    v_mov_b32 v26, 0
    v_mov_b32 v27, 0
    v_mov_b32 v28, 0
    v_mov_b32 v29, 0
    v_mov_b32 v30, 0
    v_mov_b32 v31, 0
    v_mov_b32 v32, 0
    v_mov_b32 v33, 0
    v_mov_b32 v34, 0
    v_mov_b32 v35, 0
    v_mov_b32 v36, 0
    v_mov_b32 v37, 0
    v_mov_b32 v38, 0
    v_mov_b32 v39, 0
    v_mov_b32 v40, 0
    v_mov_b32 v41, 0
    v_mov_b32 v42, 0
    v_mov_b32 v43, 0
    v_mov_b32 v44, 0
    v_mov_b32 v45, 0
    v_mov_b32 v46, 0
    v_mov_b32 v47, 0
    v_mov_b32 v48, 0
    v_mov_b32 v49, 0
    v_mov_b32 v50, 0
    v_mov_b32 v51, 0
    v_mov_b32 v52, 0
    v_mov_b32 v53, 0
    v_mov_b32 v54, 0
    v_mov_b32 v55, 0
    v_mov_b32 v56, 0
    v_mov_b32 v57, 0
    v_mov_b32 v58, 0
    v_mov_b32 v59, 0
    v_mov_b32 v60, 0
    v_mov_b32 v61, 0
    v_mov_b32 v62, 0
    v_mov_b32 v63, 0
    v_mov_b32 v64, 0
    v_mov_b32 v65, 0
    v_mov_b32 v66, 0
    v_mov_b32 v67, 0
    v_mov_b32 v68, 0
    v_mov_b32 v69, 0
    v_mov_b32 v70, 0
    v_mov_b32 v71, 0
    v_mov_b32 v72, 0
    v_mov_b32 v73, 0
    v_mov_b32 v74, 0
    v_mov_b32 v75, 0
    v_mov_b32 v76, 0
    v_mov_b32 v77, 0
    v_mov_b32 v78, 0
    v_mov_b32 v79, 0
    v_mov_b32 v80, 0
    v_mov_b32 v81, 0
    v_mov_b32 v82, 0
    v_mov_b32 v83, 0
    v_mov_b32 v84, 0
    v_mov_b32 v85, 0
    v_mov_b32 v86, 0
    v_mov_b32 v87, 0
    v_mov_b32 v88, 0
    v_mov_b32 v89, 0
    v_mov_b32 v90, 0
    v_mov_b32 v91, 0
    v_mov_b32 v92, 0
    v_mov_b32 v93, 0
    v_mov_b32 v94, 0
    v_mov_b32 v95, 0
    s_waitcnt vmcnt(0) lgkmcnt(0)
    s_barrier
    s_cmp_lg_u32 s27, 4
    s_cbranch_scc1 L2_np0
    s_mov_b64 exec, 0xff
    s_mov_b32 s50, 0
    s_mov_b32 s47, 0x0f0f0f0f
L2_ipoll:
    v_lshrrev_b32 v11, 4, v251
    v_and_b32 v11, s47, v11
    v_and_b32 v12, s47, v251
    v_add_u32 v11, v11, v12
    v_sad_u8 v11, v11, 0, 0
    v_cmp_ne_u32 vcc, 8, v11
    s_add_u32 s50, s50, 1
    s_cmp_gt_u32 s50, 0x8000
    s_cbranch_scc1 L2_igo
    s_cbranch_vccz L2_igo
    buffer_load_dword v251, v250, s[92:95], s46 offen sc1
    s_waitcnt vmcnt(0)
    s_branch L2_ipoll
L2_igo:
    s_and_b32 s47, s2, 7
    v_readlane_b32 s82, v251, s47
    s_lshl_b32 s47, s2, 7
    v_mov_b32 v11, 1
    v_mov_b32 v12, 0
    s_mov_b64 exec, 1
    s_cmp_eq_u32 s82, s83
    s_cbranch_scc1 L2_fast1
    buffer_wbl2 sc1
    s_waitcnt vmcnt(0)
    buffer_store_dword v11, v12, s[88:91], s47 offen sc1
    s_branch L2_fl
L2_fast1:
    buffer_store_dword v11, v12, s[88:91], s47 offen
L2_fl:
    s_mov_b64 exec, -1
L2_np0:
    s_add_u32 m0, s25, 40960
    s_nop 0
    buffer_load_dwordx4 v2, s[4:7], s69 offen lds
    s_add_u32 m0, s25, 41984
    s_nop 0
    buffer_load_dwordx4 v3, s[4:7], s69 offen lds
    s_add_u32 m0, s25, 43008
    s_nop 0
    buffer_load_dwordx4 v4, s[4:7], s69 offen lds
    s_add_u32 m0, s25, 44032
    s_nop 0
    buffer_load_dwordx4 v5, s[4:7], s69 offen lds
    s_add_u32 m0, s25, 45056
    s_nop 0
    buffer_load_dwordx4 v6, s[4:7], s69 offen lds
    s_add_u32 s69, s69, 655360
    s_cmp_eq_u32 s27, 4
    s_cbranch_scc1 L2_pl
    s_add_u32 m0, s25, 81920
    s_nop 0
    buffer_load_dwordx4 v2, s[4:7], s70 offen lds
    s_add_u32 m0, s25, 82944
    s_nop 0
    buffer_load_dwordx4 v3, s[4:7], s70 offen lds
    s_add_u32 m0, s25, 83968
    s_nop 0
    buffer_load_dwordx4 v4, s[4:7], s70 offen lds
    s_add_u32 m0, s25, 84992
    s_nop 0
    buffer_load_dwordx4 v5, s[4:7], s70 offen lds
    s_add_u32 m0, s25, 86016
    s_nop 0
    buffer_load_dwordx4 v6, s[4:7], s70 offen lds
    s_add_u32 s70, s70, 655360
    s_add_u32 m0, s25, 122880
    s_nop 0
    buffer_load_dwordx4 v2, s[4:7], s71 offen lds
    s_add_u32 m0, s25, 123904
    s_nop 0
    buffer_load_dwordx4 v3, s[4:7], s71 offen lds
    s_add_u32 m0, s25, 124928
    s_nop 0
    buffer_load_dwordx4 v4, s[4:7], s71 offen lds
    s_add_u32 m0, s25, 125952
    s_nop 0
    buffer_load_dwordx4 v5, s[4:7], s71 offen lds
    s_add_u32 m0, s25, 126976
    s_nop 0
    buffer_load_dwordx4 v6, s[4:7], s71 offen lds
    s_add_u32 s71, s71, 655360
    s_branch L2_np
L2_pl:
    s_mov_b64 exec, 0xff
    s_and_b32 s46, s2, 0xc7
    s_lshl_b32 s46, s46, 7
    v_lshlrev_b32 v12, 10, v1
L2_opoll:
    buffer_load_dword v11, v12, s[88:91], s46 offen sc1
    s_add_u32 s50, s50, 1
    s_waitcnt vmcnt(0)
    v_cmp_ne_u32 vcc, 1, v11
    s_cmp_gt_u32 s50, 0x8000
    s_cbranch_scc1 L2_ogo
    s_cbranch_vccnz L2_opoll
L2_ogo:
    s_cmp_eq_u32 s82, s83
    s_cbranch_scc1 L2_fast2
    buffer_inv sc1
    s_waitcnt vmcnt(0)
L2_fast2:
    s_mov_b64 exec, -1
L2_np:
    s_barrier
    buffer_load_dwordx4 v[176:179], v7, s[8:11], s72 offen offset:0 sc1
    buffer_load_dwordx4 v[180:183], v7, s[8:11], s72 offen offset:256 sc1
    buffer_load_dwordx4 v[184:187], v7, s[8:11], s72 offen offset:2048 sc1
    buffer_load_dwordx4 v[188:191], v7, s[8:11], s72 offen offset:2304 sc1
    s_add_u32 s72, s72, 32768
    buffer_load_dwordx4 v[192:195], v7, s[8:11], s73 offen offset:0 sc1
    buffer_load_dwordx4 v[196:199], v7, s[8:11], s73 offen offset:256 sc1
    buffer_load_dwordx4 v[200:203], v7, s[8:11], s73 offen offset:2048 sc1
    buffer_load_dwordx4 v[204:207], v7, s[8:11], s73 offen offset:2304 sc1
    s_add_u32 s73, s73, 32768
    ds_read_b64_tr_b16 v[96:97], v240 offset:0
    ds_read_b64_tr_b16 v[98:99], v240 offset:2560
    ds_read_b64_tr_b16 v[100:101], v241 offset:0
    ds_read_b64_tr_b16 v[102:103], v241 offset:2560
    ds_read_b64_tr_b16 v[104:105], v240 offset:64
    ds_read_b64_tr_b16 v[106:107], v240 offset:2624
    ds_read_b64_tr_b16 v[108:109], v241 offset:64
    ds_read_b64_tr_b16 v[110:111], v241 offset:2624
    ds_read_b64_tr_b16 v[112:113], v240 offset:128
    ds_read_b64_tr_b16 v[114:115], v240 offset:2688
    ds_read_b64_tr_b16 v[116:117], v241 offset:128
    ds_read_b64_tr_b16 v[118:119], v241 offset:2688
    ds_read_b64_tr_b16 v[120:121], v240 offset:192
    ds_read_b64_tr_b16 v[122:123], v240 offset:2752
    ds_read_b64_tr_b16 v[124:125], v241 offset:192
    ds_read_b64_tr_b16 v[126:127], v241 offset:2752
    ds_read_b64_tr_b16 v[128:129], v240 offset:256
    ds_read_b64_tr_b16 v[130:131], v240 offset:2816
    ds_read_b64_tr_b16 v[132:133], v241 offset:256
    ds_read_b64_tr_b16 v[134:135], v241 offset:2816
    s_waitcnt vmcnt(4)
    s_cmp_lg_u32 s27, 4
    s_cbranch_scc1 L2_nw
    s_add_u32 m0, s25, 81920
    s_nop 0
    buffer_load_dwordx4 v2, s[4:7], s70 offen lds
    s_add_u32 m0, s25, 82944
    s_nop 0
    buffer_load_dwordx4 v3, s[4:7], s70 offen lds
    s_add_u32 m0, s25, 83968
    s_nop 0
    buffer_load_dwordx4 v4, s[4:7], s70 offen lds
    s_add_u32 m0, s25, 84992
    s_nop 0
    buffer_load_dwordx4 v5, s[4:7], s70 offen lds
    s_add_u32 m0, s25, 86016
    s_nop 0
    buffer_load_dwordx4 v6, s[4:7], s70 offen lds
    s_add_u32 s70, s70, 655360
    s_add_u32 m0, s25, 122880
    s_nop 0
    buffer_load_dwordx4 v2, s[4:7], s71 offen lds
    s_add_u32 m0, s25, 123904
    s_nop 0
    buffer_load_dwordx4 v3, s[4:7], s71 offen lds
    s_add_u32 m0, s25, 124928
    s_nop 0
    buffer_load_dwordx4 v4, s[4:7], s71 offen lds
    s_add_u32 m0, s25, 125952
    s_nop 0
    buffer_load_dwordx4 v5, s[4:7], s71 offen lds
    s_add_u32 m0, s25, 126976
    s_nop 0
    buffer_load_dwordx4 v6, s[4:7], s71 offen lds
    s_add_u32 s71, s71, 655360
L2_nw:
    s_waitcnt lgkmcnt(15)
    v_mfma_f32_16x16x32_bf16 v[16:19], v[96:99], v[176:179], v[16:19]
    ds_read_b64_tr_b16 v[136:137], v240 offset:10240
    ds_read_b64_tr_b16 v[138:139], v240 offset:12800
    buffer_load_dwordx4 v[208:211], v7, s[8:11], s74 offen offset:0 sc1
    v_mfma_f32_16x16x32_bf16 v[56:59], v[96:99], v[180:183], v[56:59]
    ds_read_b64_tr_b16 v[140:141], v241 offset:10240
    v_mfma_f32_16x16x32_bf16 v[20:23], v[100:103], v[176:179], v[20:23]
    ds_read_b64_tr_b16 v[142:143], v241 offset:12800
    buffer_load_dwordx4 v[212:215], v7, s[8:11], s74 offen offset:256 sc1
    v_mfma_f32_16x16x32_bf16 v[60:63], v[100:103], v[180:183], v[60:63]
    ds_read_b64_tr_b16 v[144:145], v240 offset:10304
    s_waitcnt lgkmcnt(15)
    v_mfma_f32_16x16x32_bf16 v[24:27], v[104:107], v[176:179], v[24:27]
    ds_read_b64_tr_b16 v[146:147], v240 offset:12864
    ds_read_b64_tr_b16 v[148:149], v241 offset:10304
    buffer_load_dwordx4 v[216:219], v7, s[8:11], s74 offen offset:2048 sc1
    v_mfma_f32_16x16x32_bf16 v[64:67], v[104:107], v[180:183], v[64:67]
    ds_read_b64_tr_b16 v[150:151], v241 offset:12864
    v_mfma_f32_16x16x32_bf16 v[28:31], v[108:111], v[176:179], v[28:31]
    ds_read_b64_tr_b16 v[152:153], v240 offset:10368
    buffer_load_dwordx4 v[220:223], v7, s[8:11], s74 offen offset:2304 sc1
    s_add_u32 s74, s74, 32768
    v_mfma_f32_16x16x32_bf16 v[68:71], v[108:111], v[180:183], v[68:71]
    ds_read_b64_tr_b16 v[154:155], v240 offset:12928
    v_mfma_f32_16x16x32_bf16 v[32:35], v[112:115], v[176:179], v[32:35]
    ds_read_b64_tr_b16 v[156:157], v241 offset:10368
    ds_read_b64_tr_b16 v[158:159], v241 offset:12928
    buffer_load_dwordx4 v[224:227], v7, s[8:11], s75 offen offset:0 sc1
    v_mfma_f32_16x16x32_bf16 v[72:75], v[112:115], v[180:183], v[72:75]
    ds_read_b64_tr_b16 v[160:161], v240 offset:10432
    s_waitcnt lgkmcnt(15)
    v_mfma_f32_16x16x32_bf16 v[36:39], v[116:119], v[176:179], v[36:39]
    ds_read_b64_tr_b16 v[162:163], v240 offset:12992
    buffer_load_dwordx4 v[228:231], v7, s[8:11], s75 offen offset:256 sc1
    v_mfma_f32_16x16x32_bf16 v[76:79], v[116:119], v[180:183], v[76:79]
    ds_read_b64_tr_b16 v[164:165], v241 offset:10432
    v_mfma_f32_16x16x32_bf16 v[40:43], v[120:123], v[176:179], v[40:43]
    ds_read_b64_tr_b16 v[166:167], v241 offset:12992
    ds_read_b64_tr_b16 v[168:169], v240 offset:10496
    buffer_load_dwordx4 v[232:235], v7, s[8:11], s75 offen offset:2048 sc1
    v_mfma_f32_16x16x32_bf16 v[80:83], v[120:123], v[180:183], v[80:83]
    ds_read_b64_tr_b16 v[170:171], v240 offset:13056
    v_mfma_f32_16x16x32_bf16 v[44:47], v[124:127], v[176:179], v[44:47]
    ds_read_b64_tr_b16 v[172:173], v241 offset:10496
    buffer_load_dwordx4 v[236:239], v7, s[8:11], s75 offen offset:2304 sc1
    s_add_u32 s75, s75, 32768
    v_mfma_f32_16x16x32_bf16 v[84:87], v[124:127], v[180:183], v[84:87]
    ds_read_b64_tr_b16 v[174:175], v241 offset:13056
    v_mfma_f32_16x16x32_bf16 v[48:51], v[128:131], v[176:179], v[48:51]
    v_mfma_f32_16x16x32_bf16 v[88:91], v[128:131], v[180:183], v[88:91]
    s_waitcnt lgkmcnt(15)
    v_mfma_f32_16x16x32_bf16 v[52:55], v[132:135], v[176:179], v[52:55]
    v_mfma_f32_16x16x32_bf16 v[92:95], v[132:135], v[180:183], v[92:95]
    s_waitcnt vmcnt(8) lgkmcnt(0)
    s_barrier
    v_mfma_f32_16x16x32_bf16 v[16:19], v[136:139], v[184:187], v[16:19]
    ds_read_b64_tr_b16 v[96:97], v242 offset:0
    ds_read_b64_tr_b16 v[98:99], v242 offset:2560
    v_mfma_f32_16x16x32_bf16 v[56:59], v[136:139], v[188:191], v[56:59]
    ds_read_b64_tr_b16 v[100:101], v243 offset:0
    s_add_u32 m0, s25, 0
    s_nop 0
    buffer_load_dwordx4 v2, s[4:7], s68 offen lds
    v_mfma_f32_16x16x32_bf16 v[20:23], v[140:143], v[184:187], v[20:23]
    ds_read_b64_tr_b16 v[102:103], v243 offset:2560
    v_mfma_f32_16x16x32_bf16 v[60:63], v[140:143], v[188:191], v[60:63]
    ds_read_b64_tr_b16 v[104:105], v242 offset:64
    v_mfma_f32_16x16x32_bf16 v[24:27], v[144:147], v[184:187], v[24:27]
    ds_read_b64_tr_b16 v[106:107], v242 offset:2624
    ds_read_b64_tr_b16 v[108:109], v243 offset:64
    v_mfma_f32_16x16x32_bf16 v[64:67], v[144:147], v[188:191], v[64:67]
    ds_read_b64_tr_b16 v[110:111], v243 offset:2624
    s_add_u32 m0, s25, 1024
    s_nop 0
    buffer_load_dwordx4 v3, s[4:7], s68 offen lds
    v_mfma_f32_16x16x32_bf16 v[28:31], v[148:151], v[184:187], v[28:31]
    ds_read_b64_tr_b16 v[112:113], v242 offset:128
    v_mfma_f32_16x16x32_bf16 v[68:71], v[148:151], v[188:191], v[68:71]
    ds_read_b64_tr_b16 v[114:115], v242 offset:2688
    v_mfma_f32_16x16x32_bf16 v[32:35], v[152:155], v[184:187], v[32:35]
    ds_read_b64_tr_b16 v[116:117], v243 offset:128
    ds_read_b64_tr_b16 v[118:119], v243 offset:2688
    v_mfma_f32_16x16x32_bf16 v[72:75], v[152:155], v[188:191], v[72:75]
    ds_read_b64_tr_b16 v[120:121], v242 offset:192
    s_add_u32 m0, s25, 2048
    s_nop 0
    buffer_load_dwordx4 v4, s[4:7], s68 offen lds
    v_mfma_f32_16x16x32_bf16 v[36:39], v[156:159], v[184:187], v[36:39]
    ds_read_b64_tr_b16 v[122:123], v242 offset:2752
    v_mfma_f32_16x16x32_bf16 v[76:79], v[156:159], v[188:191], v[76:79]
    ds_read_b64_tr_b16 v[124:125], v243 offset:192
    v_mfma_f32_16x16x32_bf16 v[40:43], v[160:163], v[184:187], v[40:43]
    ds_read_b64_tr_b16 v[126:127], v243 offset:2752
    ds_read_b64_tr_b16 v[128:129], v242 offset:256
    v_mfma_f32_16x16x32_bf16 v[80:83], v[160:163], v[188:191], v[80:83]
    ds_read_b64_tr_b16 v[130:131], v242 offset:2816
    s_add_u32 m0, s25, 3072
    s_nop 0
    buffer_load_dwordx4 v5, s[4:7], s68 offen lds
    v_mfma_f32_16x16x32_bf16 v[44:47], v[164:167], v[184:187], v[44:47]
    ds_read_b64_tr_b16 v[132:133], v243 offset:256
    v_mfma_f32_16x16x32_bf16 v[84:87], v[164:167], v[188:191], v[84:87]
    ds_read_b64_tr_b16 v[134:135], v243 offset:2816
    v_mfma_f32_16x16x32_bf16 v[48:51], v[168:171], v[184:187], v[48:51]
    v_mfma_f32_16x16x32_bf16 v[88:91], v[168:171], v[188:191], v[88:91]
    s_add_u32 m0, s25, 4096
    s_nop 0
    buffer_load_dwordx4 v6, s[4:7], s68 offen lds
    s_add_u32 s68, s68, 655360
    v_mfma_f32_16x16x32_bf16 v[52:55], v[172:175], v[184:187], v[52:55]
    v_mfma_f32_16x16x32_bf16 v[92:95], v[172:175], v[188:191], v[92:95]
    s_waitcnt lgkmcnt(15)
    v_mfma_f32_16x16x32_bf16 v[16:19], v[96:99], v[192:195], v[16:19]
    ds_read_b64_tr_b16 v[136:137], v242 offset:10240
    ds_read_b64_tr_b16 v[138:139], v242 offset:12800
    v_mfma_f32_16x16x32_bf16 v[56:59], v[96:99], v[196:199], v[56:59]
    ds_read_b64_tr_b16 v[140:141], v243 offset:10240
    v_mfma_f32_16x16x32_bf16 v[20:23], v[100:103], v[192:195], v[20:23]
    ds_read_b64_tr_b16 v[142:143], v243 offset:12800
    buffer_load_dwordx4 v[176:179], v7, s[8:11], s72 offen offset:0 sc1
    v_mfma_f32_16x16x32_bf16 v[60:63], v[100:103], v[196:199], v[60:63]
    ds_read_b64_tr_b16 v[144:145], v242 offset:10304
    s_waitcnt lgkmcnt(15)
    v_mfma_f32_16x16x32_bf16 v[24:27], v[104:107], v[192:195], v[24:27]
    ds_read_b64_tr_b16 v[146:147], v242 offset:12864
    ds_read_b64_tr_b16 v[148:149], v243 offset:10304
    v_mfma_f32_16x16x32_bf16 v[64:67], v[104:107], v[196:199], v[64:67]
    ds_read_b64_tr_b16 v[150:151], v243 offset:12864
    v_mfma_f32_16x16x32_bf16 v[28:31], v[108:111], v[192:195], v[28:31]
    ds_read_b64_tr_b16 v[152:153], v242 offset:10368
    buffer_load_dwordx4 v[180:183], v7, s[8:11], s72 offen offset:256 sc1
    v_mfma_f32_16x16x32_bf16 v[68:71], v[108:111], v[196:199], v[68:71]
    ds_read_b64_tr_b16 v[154:155], v242 offset:12928
    v_mfma_f32_16x16x32_bf16 v[32:35], v[112:115], v[192:195], v[32:35]
    ds_read_b64_tr_b16 v[156:157], v243 offset:10368
    ds_read_b64_tr_b16 v[158:159], v243 offset:12928
    v_mfma_f32_16x16x32_bf16 v[72:75], v[112:115], v[196:199], v[72:75]
    ds_read_b64_tr_b16 v[160:161], v242 offset:10432
    s_waitcnt lgkmcnt(15)
    v_mfma_f32_16x16x32_bf16 v[36:39], v[116:119], v[192:195], v[36:39]
    ds_read_b64_tr_b16 v[162:163], v242 offset:12992
    buffer_load_dwordx4 v[184:187], v7, s[8:11], s72 offen offset:2048 sc1
    v_mfma_f32_16x16x32_bf16 v[76:79], v[116:119], v[196:199], v[76:79]
    ds_read_b64_tr_b16 v[164:165], v243 offset:10432
    v_mfma_f32_16x16x32_bf16 v[40:43], v[120:123], v[192:195], v[40:43]
    ds_read_b64_tr_b16 v[166:167], v243 offset:12992
    ds_read_b64_tr_b16 v[168:169], v242 offset:10496
    v_mfma_f32_16x16x32_bf16 v[80:83], v[120:123], v[196:199], v[80:83]
    ds_read_b64_tr_b16 v[170:171], v242 offset:13056
    v_mfma_f32_16x16x32_bf16 v[44:47], v[124:127], v[192:195], v[44:47]
    ds_read_b64_tr_b16 v[172:173], v243 offset:10496
    buffer_load_dwordx4 v[188:191], v7, s[8:11], s72 offen offset:2304 sc1
    s_add_u32 s72, s72, 32768
    v_mfma_f32_16x16x32_bf16 v[84:87], v[124:127], v[196:199], v[84:87]
    ds_read_b64_tr_b16 v[174:175], v243 offset:13056
    v_mfma_f32_16x16x32_bf16 v[48:51], v[128:131], v[192:195], v[48:51]
    v_mfma_f32_16x16x32_bf16 v[88:91], v[128:131], v[196:199], v[88:91]
    s_waitcnt lgkmcnt(15)
    v_mfma_f32_16x16x32_bf16 v[52:55], v[132:135], v[192:195], v[52:55]
    v_mfma_f32_16x16x32_bf16 v[92:95], v[132:135], v[196:199], v[92:95]
    s_waitcnt vmcnt(13) lgkmcnt(0)
    s_barrier
    v_mfma_f32_16x16x32_bf16 v[16:19], v[136:139], v[200:203], v[16:19]
    ds_read_b64_tr_b16 v[96:97], v244 offset:0
    ds_read_b64_tr_b16 v[98:99], v244 offset:2560
    v_mfma_f32_16x16x32_bf16 v[56:59], v[136:139], v[204:207], v[56:59]
    ds_read_b64_tr_b16 v[100:101], v245 offset:0
    s_add_u32 m0, s25, 40960
    s_nop 0
    buffer_load_dwordx4 v2, s[4:7], s69 offen lds
    v_mfma_f32_16x16x32_bf16 v[20:23], v[140:143], v[200:203], v[20:23]
    ds_read_b64_tr_b16 v[102:103], v245 offset:2560
    v_mfma_f32_16x16x32_bf16 v[60:63], v[140:143], v[204:207], v[60:63]
    ds_read_b64_tr_b16 v[104:105], v244 offset:64
    v_mfma_f32_16x16x32_bf16 v[24:27], v[144:147], v[200:203], v[24:27]
    ds_read_b64_tr_b16 v[106:107], v244 offset:2624
    ds_read_b64_tr_b16 v[108:109], v245 offset:64
    v_mfma_f32_16x16x32_bf16 v[64:67], v[144:147], v[204:207], v[64:67]
    ds_read_b64_tr_b16 v[110:111], v245 offset:2624
    s_add_u32 m0, s25, 41984
    s_nop 0
    buffer_load_dwordx4 v3, s[4:7], s69 offen lds
    v_mfma_f32_16x16x32_bf16 v[28:31], v[148:151], v[200:203], v[28:31]
    ds_read_b64_tr_b16 v[112:113], v244 offset:128
    v_mfma_f32_16x16x32_bf16 v[68:71], v[148:151], v[204:207], v[68:71]
    ds_read_b64_tr_b16 v[114:115], v244 offset:2688
    v_mfma_f32_16x16x32_bf16 v[32:35], v[152:155], v[200:203], v[32:35]
    ds_read_b64_tr_b16 v[116:117], v245 offset:128
    ds_read_b64_tr_b16 v[118:119], v245 offset:2688
    v_mfma_f32_16x16x32_bf16 v[72:75], v[152:155], v[204:207], v[72:75]
    ds_read_b64_tr_b16 v[120:121], v244 offset:192
    s_add_u32 m0, s25, 43008
    s_nop 0
    buffer_load_dwordx4 v4, s[4:7], s69 offen lds
    v_mfma_f32_16x16x32_bf16 v[36:39], v[156:159], v[200:203], v[36:39]
    ds_read_b64_tr_b16 v[122:123], v244 offset:2752
    v_mfma_f32_16x16x32_bf16 v[76:79], v[156:159], v[204:207], v[76:79]
    ds_read_b64_tr_b16 v[124:125], v245 offset:192
    v_mfma_f32_16x16x32_bf16 v[40:43], v[160:163], v[200:203], v[40:43]
    ds_read_b64_tr_b16 v[126:127], v245 offset:2752
    ds_read_b64_tr_b16 v[128:129], v244 offset:256
    v_mfma_f32_16x16x32_bf16 v[80:83], v[160:163], v[204:207], v[80:83]
    ds_read_b64_tr_b16 v[130:131], v244 offset:2816
    s_add_u32 m0, s25, 44032
    s_nop 0
    buffer_load_dwordx4 v5, s[4:7], s69 offen lds
    v_mfma_f32_16x16x32_bf16 v[44:47], v[164:167], v[200:203], v[44:47]
    ds_read_b64_tr_b16 v[132:133], v245 offset:256
    v_mfma_f32_16x16x32_bf16 v[84:87], v[164:167], v[204:207], v[84:87]
    ds_read_b64_tr_b16 v[134:135], v245 offset:2816
    v_mfma_f32_16x16x32_bf16 v[48:51], v[168:171], v[200:203], v[48:51]
    v_mfma_f32_16x16x32_bf16 v[88:91], v[168:171], v[204:207], v[88:91]
    s_add_u32 m0, s25, 45056
    s_nop 0
    buffer_load_dwordx4 v6, s[4:7], s69 offen lds
    s_add_u32 s69, s69, 655360
    v_mfma_f32_16x16x32_bf16 v[52:55], v[172:175], v[200:203], v[52:55]
    v_mfma_f32_16x16x32_bf16 v[92:95], v[172:175], v[204:207], v[92:95]
    s_waitcnt lgkmcnt(15)
    v_mfma_f32_16x16x32_bf16 v[16:19], v[96:99], v[208:211], v[16:19]
    ds_read_b64_tr_b16 v[136:137], v244 offset:10240
    ds_read_b64_tr_b16 v[138:139], v244 offset:12800
    v_mfma_f32_16x16x32_bf16 v[56:59], v[96:99], v[212:215], v[56:59]
    ds_read_b64_tr_b16 v[140:141], v245 offset:10240
    v_mfma_f32_16x16x32_bf16 v[20:23], v[100:103], v[208:211], v[20:23]
    ds_read_b64_tr_b16 v[142:143], v245 offset:12800
    buffer_load_dwordx4 v[192:195], v7, s[8:11], s73 offen offset:0 sc1
    v_mfma_f32_16x16x32_bf16 v[60:63], v[100:103], v[212:215], v[60:63]
    ds_read_b64_tr_b16 v[144:145], v244 offset:10304
    s_waitcnt lgkmcnt(15)
    v_mfma_f32_16x16x32_bf16 v[24:27], v[104:107], v[208:211], v[24:27]
    ds_read_b64_tr_b16 v[146:147], v244 offset:12864
    ds_read_b64_tr_b16 v[148:149], v245 offset:10304
    v_mfma_f32_16x16x32_bf16 v[64:67], v[104:107], v[212:215], v[64:67]
    ds_read_b64_tr_b16 v[150:151], v245 offset:12864
    v_mfma_f32_16x16x32_bf16 v[28:31], v[108:111], v[208:211], v[28:31]
    ds_read_b64_tr_b16 v[152:153], v244 offset:10368
    buffer_load_dwordx4 v[196:199], v7, s[8:11], s73 offen offset:256 sc1
    v_mfma_f32_16x16x32_bf16 v[68:71], v[108:111], v[212:215], v[68:71]
    ds_read_b64_tr_b16 v[154:155], v244 offset:12928
    v_mfma_f32_16x16x32_bf16 v[32:35], v[112:115], v[208:211], v[32:35]
    ds_read_b64_tr_b16 v[156:157], v245 offset:10368
    ds_read_b64_tr_b16 v[158:159], v245 offset:12928
    v_mfma_f32_16x16x32_bf16 v[72:75], v[112:115], v[212:215], v[72:75]
    ds_read_b64_tr_b16 v[160:161], v244 offset:10432
    s_waitcnt lgkmcnt(15)
    v_mfma_f32_16x16x32_bf16 v[36:39], v[116:119], v[208:211], v[36:39]
    ds_read_b64_tr_b16 v[162:163], v244 offset:12992
    buffer_load_dwordx4 v[200:203], v7, s[8:11], s73 offen offset:2048 sc1
    v_mfma_f32_16x16x32_bf16 v[76:79], v[116:119], v[212:215], v[76:79]
    ds_read_b64_tr_b16 v[164:165], v245 offset:10432
    v_mfma_f32_16x16x32_bf16 v[40:43], v[120:123], v[208:211], v[40:43]
    ds_read_b64_tr_b16 v[166:167], v245 offset:12992
    ds_read_b64_tr_b16 v[168:169], v244 offset:10496
    v_mfma_f32_16x16x32_bf16 v[80:83], v[120:123], v[212:215], v[80:83]
    ds_read_b64_tr_b16 v[170:171], v244 offset:13056
    v_mfma_f32_16x16x32_bf16 v[44:47], v[124:127], v[208:211], v[44:47]
    ds_read_b64_tr_b16 v[172:173], v245 offset:10496
    buffer_load_dwordx4 v[204:207], v7, s[8:11], s73 offen offset:2304 sc1
    s_add_u32 s73, s73, 32768
    v_mfma_f32_16x16x32_bf16 v[84:87], v[124:127], v[212:215], v[84:87]
    ds_read_b64_tr_b16 v[174:175], v245 offset:13056
    v_mfma_f32_16x16x32_bf16 v[48:51], v[128:131], v[208:211], v[48:51]
    v_mfma_f32_16x16x32_bf16 v[88:91], v[128:131], v[212:215], v[88:91]
    s_waitcnt lgkmcnt(15)
    v_mfma_f32_16x16x32_bf16 v[52:55], v[132:135], v[208:211], v[52:55]
    v_mfma_f32_16x16x32_bf16 v[92:95], v[132:135], v[212:215], v[92:95]
    s_waitcnt vmcnt(18) lgkmcnt(0)
    s_barrier
    v_mfma_f32_16x16x32_bf16 v[16:19], v[136:139], v[216:219], v[16:19]
    ds_read_b64_tr_b16 v[96:97], v246 offset:0
    ds_read_b64_tr_b16 v[98:99], v246 offset:2560
    v_mfma_f32_16x16x32_bf16 v[56:59], v[136:139], v[220:223], v[56:59]
    ds_read_b64_tr_b16 v[100:101], v247 offset:0
    s_add_u32 m0, s25, 81920
    s_nop 0
    buffer_load_dwordx4 v2, s[4:7], s70 offen lds
    v_mfma_f32_16x16x32_bf16 v[20:23], v[140:143], v[216:219], v[20:23]
    ds_read_b64_tr_b16 v[102:103], v247 offset:2560
    v_mfma_f32_16x16x32_bf16 v[60:63], v[140:143], v[220:223], v[60:63]
    ds_read_b64_tr_b16 v[104:105], v246 offset:64
    v_mfma_f32_16x16x32_bf16 v[24:27], v[144:147], v[216:219], v[24:27]
    ds_read_b64_tr_b16 v[106:107], v246 offset:2624
    ds_read_b64_tr_b16 v[108:109], v247 offset:64
    v_mfma_f32_16x16x32_bf16 v[64:67], v[144:147], v[220:223], v[64:67]
    ds_read_b64_tr_b16 v[110:111], v247 offset:2624
    s_add_u32 m0, s25, 82944
    s_nop 0
    buffer_load_dwordx4 v3, s[4:7], s70 offen lds
    v_mfma_f32_16x16x32_bf16 v[28:31], v[148:151], v[216:219], v[28:31]
    ds_read_b64_tr_b16 v[112:113], v246 offset:128
    v_mfma_f32_16x16x32_bf16 v[68:71], v[148:151], v[220:223], v[68:71]
    ds_read_b64_tr_b16 v[114:115], v246 offset:2688
    v_mfma_f32_16x16x32_bf16 v[32:35], v[152:155], v[216:219], v[32:35]
    ds_read_b64_tr_b16 v[116:117], v247 offset:128
    ds_read_b64_tr_b16 v[118:119], v247 offset:2688
    v_mfma_f32_16x16x32_bf16 v[72:75], v[152:155], v[220:223], v[72:75]
    ds_read_b64_tr_b16 v[120:121], v246 offset:192
    s_add_u32 m0, s25, 83968
    s_nop 0
    buffer_load_dwordx4 v4, s[4:7], s70 offen lds
    v_mfma_f32_16x16x32_bf16 v[36:39], v[156:159], v[216:219], v[36:39]
    ds_read_b64_tr_b16 v[122:123], v246 offset:2752
    v_mfma_f32_16x16x32_bf16 v[76:79], v[156:159], v[220:223], v[76:79]
    ds_read_b64_tr_b16 v[124:125], v247 offset:192
    v_mfma_f32_16x16x32_bf16 v[40:43], v[160:163], v[216:219], v[40:43]
    ds_read_b64_tr_b16 v[126:127], v247 offset:2752
    ds_read_b64_tr_b16 v[128:129], v246 offset:256
    v_mfma_f32_16x16x32_bf16 v[80:83], v[160:163], v[220:223], v[80:83]
    ds_read_b64_tr_b16 v[130:131], v246 offset:2816
    s_add_u32 m0, s25, 84992
    s_nop 0
    buffer_load_dwordx4 v5, s[4:7], s70 offen lds
    v_mfma_f32_16x16x32_bf16 v[44:47], v[164:167], v[216:219], v[44:47]
    ds_read_b64_tr_b16 v[132:133], v247 offset:256
    v_mfma_f32_16x16x32_bf16 v[84:87], v[164:167], v[220:223], v[84:87]
    ds_read_b64_tr_b16 v[134:135], v247 offset:2816
    v_mfma_f32_16x16x32_bf16 v[48:51], v[168:171], v[216:219], v[48:51]
    v_mfma_f32_16x16x32_bf16 v[88:91], v[168:171], v[220:223], v[88:91]
    s_add_u32 m0, s25, 86016
    s_nop 0
    buffer_load_dwordx4 v6, s[4:7], s70 offen lds
    s_add_u32 s70, s70, 655360
    v_mfma_f32_16x16x32_bf16 v[52:55], v[172:175], v[216:219], v[52:55]
    v_mfma_f32_16x16x32_bf16 v[92:95], v[172:175], v[220:223], v[92:95]
    s_waitcnt lgkmcnt(15)
    v_mfma_f32_16x16x32_bf16 v[16:19], v[96:99], v[224:227], v[16:19]
    ds_read_b64_tr_b16 v[136:137], v246 offset:10240
    ds_read_b64_tr_b16 v[138:139], v246 offset:12800
    v_mfma_f32_16x16x32_bf16 v[56:59], v[96:99], v[228:231], v[56:59]
    ds_read_b64_tr_b16 v[140:141], v247 offset:10240
    v_mfma_f32_16x16x32_bf16 v[20:23], v[100:103], v[224:227], v[20:23]
    ds_read_b64_tr_b16 v[142:143], v247 offset:12800
    buffer_load_dwordx4 v[208:211], v7, s[8:11], s74 offen offset:0 sc1
    v_mfma_f32_16x16x32_bf16 v[60:63], v[100:103], v[228:231], v[60:63]
    ds_read_b64_tr_b16 v[144:145], v246 offset:10304
    s_waitcnt lgkmcnt(15)
    v_mfma_f32_16x16x32_bf16 v[24:27], v[104:107], v[224:227], v[24:27]
    ds_read_b64_tr_b16 v[146:147], v246 offset:12864
    ds_read_b64_tr_b16 v[148:149], v247 offset:10304
    v_mfma_f32_16x16x32_bf16 v[64:67], v[104:107], v[228:231], v[64:67]
    ds_read_b64_tr_b16 v[150:151], v247 offset:12864
    v_mfma_f32_16x16x32_bf16 v[28:31], v[108:111], v[224:227], v[28:31]
    ds_read_b64_tr_b16 v[152:153], v246 offset:10368
    buffer_load_dwordx4 v[212:215], v7, s[8:11], s74 offen offset:256 sc1
    v_mfma_f32_16x16x32_bf16 v[68:71], v[108:111], v[228:231], v[68:71]
    ds_read_b64_tr_b16 v[154:155], v246 offset:12928
    v_mfma_f32_16x16x32_bf16 v[32:35], v[112:115], v[224:227], v[32:35]
    ds_read_b64_tr_b16 v[156:157], v247 offset:10368
    ds_read_b64_tr_b16 v[158:159], v247 offset:12928
    v_mfma_f32_16x16x32_bf16 v[72:75], v[112:115], v[228:231], v[72:75]
    ds_read_b64_tr_b16 v[160:161], v246 offset:10432
    s_waitcnt lgkmcnt(15)
    v_mfma_f32_16x16x32_bf16 v[36:39], v[116:119], v[224:227], v[36:39]
    ds_read_b64_tr_b16 v[162:163], v246 offset:12992
    buffer_load_dwordx4 v[216:219], v7, s[8:11], s74 offen offset:2048 sc1
    v_mfma_f32_16x16x32_bf16 v[76:79], v[116:119], v[228:231], v[76:79]
    ds_read_b64_tr_b16 v[164:165], v247 offset:10432
    v_mfma_f32_16x16x32_bf16 v[40:43], v[120:123], v[224:227], v[40:43]
    ds_read_b64_tr_b16 v[166:167], v247 offset:12992
    ds_read_b64_tr_b16 v[168:169], v246 offset:10496
    v_mfma_f32_16x16x32_bf16 v[80:83], v[120:123], v[228:231], v[80:83]
    ds_read_b64_tr_b16 v[170:171], v246 offset:13056
    v_mfma_f32_16x16x32_bf16 v[44:47], v[124:127], v[224:227], v[44:47]
    ds_read_b64_tr_b16 v[172:173], v247 offset:10496
    buffer_load_dwordx4 v[220:223], v7, s[8:11], s74 offen offset:2304 sc1
    s_add_u32 s74, s74, 32768
    v_mfma_f32_16x16x32_bf16 v[84:87], v[124:127], v[228:231], v[84:87]
    ds_read_b64_tr_b16 v[174:175], v247 offset:13056
    v_mfma_f32_16x16x32_bf16 v[48:51], v[128:131], v[224:227], v[48:51]
    v_mfma_f32_16x16x32_bf16 v[88:91], v[128:131], v[228:231], v[88:91]
    s_waitcnt lgkmcnt(15)
    v_mfma_f32_16x16x32_bf16 v[52:55], v[132:135], v[224:227], v[52:55]
    v_mfma_f32_16x16x32_bf16 v[92:95], v[132:135], v[228:231], v[92:95]
    s_waitcnt vmcnt(18) lgkmcnt(0)
    s_barrier
    v_mfma_f32_16x16x32_bf16 v[16:19], v[136:139], v[232:235], v[16:19]
    ds_read_b64_tr_b16 v[96:97], v240 offset:0
    ds_read_b64_tr_b16 v[98:99], v240 offset:2560
    v_mfma_f32_16x16x32_bf16 v[56:59], v[136:139], v[236:239], v[56:59]
    ds_read_b64_tr_b16 v[100:101], v241 offset:0
    s_add_u32 m0, s25, 122880
    s_nop 0
    buffer_load_dwordx4 v2, s[4:7], s71 offen lds
    v_mfma_f32_16x16x32_bf16 v[20:23], v[140:143], v[232:235], v[20:23]
    ds_read_b64_tr_b16 v[102:103], v241 offset:2560
    v_mfma_f32_16x16x32_bf16 v[60:63], v[140:143], v[236:239], v[60:63]
    ds_read_b64_tr_b16 v[104:105], v240 offset:64
    v_mfma_f32_16x16x32_bf16 v[24:27], v[144:147], v[232:235], v[24:27]
    ds_read_b64_tr_b16 v[106:107], v240 offset:2624
    ds_read_b64_tr_b16 v[108:109], v241 offset:64
    v_mfma_f32_16x16x32_bf16 v[64:67], v[144:147], v[236:239], v[64:67]
    ds_read_b64_tr_b16 v[110:111], v241 offset:2624
    s_add_u32 m0, s25, 123904
    s_nop 0
    buffer_load_dwordx4 v3, s[4:7], s71 offen lds
    v_mfma_f32_16x16x32_bf16 v[28:31], v[148:151], v[232:235], v[28:31]
    ds_read_b64_tr_b16 v[112:113], v240 offset:128
    v_mfma_f32_16x16x32_bf16 v[68:71], v[148:151], v[236:239], v[68:71]
    ds_read_b64_tr_b16 v[114:115], v240 offset:2688
    v_mfma_f32_16x16x32_bf16 v[32:35], v[152:155], v[232:235], v[32:35]
    ds_read_b64_tr_b16 v[116:117], v241 offset:128
    ds_read_b64_tr_b16 v[118:119], v241 offset:2688
    v_mfma_f32_16x16x32_bf16 v[72:75], v[152:155], v[236:239], v[72:75]
    ds_read_b64_tr_b16 v[120:121], v240 offset:192
    s_add_u32 m0, s25, 124928
    s_nop 0
    buffer_load_dwordx4 v4, s[4:7], s71 offen lds
    v_mfma_f32_16x16x32_bf16 v[36:39], v[156:159], v[232:235], v[36:39]
    ds_read_b64_tr_b16 v[122:123], v240 offset:2752
    v_mfma_f32_16x16x32_bf16 v[76:79], v[156:159], v[236:239], v[76:79]
    ds_read_b64_tr_b16 v[124:125], v241 offset:192
    v_mfma_f32_16x16x32_bf16 v[40:43], v[160:163], v[232:235], v[40:43]
    ds_read_b64_tr_b16 v[126:127], v241 offset:2752
    ds_read_b64_tr_b16 v[128:129], v240 offset:256
    v_mfma_f32_16x16x32_bf16 v[80:83], v[160:163], v[236:239], v[80:83]
    ds_read_b64_tr_b16 v[130:131], v240 offset:2816
    s_add_u32 m0, s25, 125952
    s_nop 0
    buffer_load_dwordx4 v5, s[4:7], s71 offen lds
    v_mfma_f32_16x16x32_bf16 v[44:47], v[164:167], v[232:235], v[44:47]
    ds_read_b64_tr_b16 v[132:133], v241 offset:256
    v_mfma_f32_16x16x32_bf16 v[84:87], v[164:167], v[236:239], v[84:87]
    ds_read_b64_tr_b16 v[134:135], v241 offset:2816
    v_mfma_f32_16x16x32_bf16 v[48:51], v[168:171], v[232:235], v[48:51]
    v_mfma_f32_16x16x32_bf16 v[88:91], v[168:171], v[236:239], v[88:91]
    s_add_u32 m0, s25, 126976
    s_nop 0
    buffer_load_dwordx4 v6, s[4:7], s71 offen lds
    s_add_u32 s71, s71, 655360
    v_mfma_f32_16x16x32_bf16 v[52:55], v[172:175], v[232:235], v[52:55]
    v_mfma_f32_16x16x32_bf16 v[92:95], v[172:175], v[236:239], v[92:95]
    s_waitcnt lgkmcnt(15)
    v_mfma_f32_16x16x32_bf16 v[16:19], v[96:99], v[176:179], v[16:19]
    ds_read_b64_tr_b16 v[136:137], v240 offset:10240
    ds_read_b64_tr_b16 v[138:139], v240 offset:12800
    v_mfma_f32_16x16x32_bf16 v[56:59], v[96:99], v[180:183], v[56:59]
    ds_read_b64_tr_b16 v[140:141], v241 offset:10240
    v_mfma_f32_16x16x32_bf16 v[20:23], v[100:103], v[176:179], v[20:23]
    ds_read_b64_tr_b16 v[142:143], v241 offset:12800
    buffer_load_dwordx4 v[224:227], v7, s[8:11], s75 offen offset:0 sc1
    v_mfma_f32_16x16x32_bf16 v[60:63], v[100:103], v[180:183], v[60:63]
    ds_read_b64_tr_b16 v[144:145], v240 offset:10304
    s_waitcnt lgkmcnt(15)
    v_mfma_f32_16x16x32_bf16 v[24:27], v[104:107], v[176:179], v[24:27]
    ds_read_b64_tr_b16 v[146:147], v240 offset:12864
    ds_read_b64_tr_b16 v[148:149], v241 offset:10304
    v_mfma_f32_16x16x32_bf16 v[64:67], v[104:107], v[180:183], v[64:67]
    ds_read_b64_tr_b16 v[150:151], v241 offset:12864
    v_mfma_f32_16x16x32_bf16 v[28:31], v[108:111], v[176:179], v[28:31]
    ds_read_b64_tr_b16 v[152:153], v240 offset:10368
    buffer_load_dwordx4 v[228:231], v7, s[8:11], s75 offen offset:256 sc1
    v_mfma_f32_16x16x32_bf16 v[68:71], v[108:111], v[180:183], v[68:71]
    ds_read_b64_tr_b16 v[154:155], v240 offset:12928
    v_mfma_f32_16x16x32_bf16 v[32:35], v[112:115], v[176:179], v[32:35]
    ds_read_b64_tr_b16 v[156:157], v241 offset:10368
    ds_read_b64_tr_b16 v[158:159], v241 offset:12928
    v_mfma_f32_16x16x32_bf16 v[72:75], v[112:115], v[180:183], v[72:75]
    ds_read_b64_tr_b16 v[160:161], v240 offset:10432
    s_waitcnt lgkmcnt(15)
    v_mfma_f32_16x16x32_bf16 v[36:39], v[116:119], v[176:179], v[36:39]
    ds_read_b64_tr_b16 v[162:163], v240 offset:12992
    buffer_load_dwordx4 v[232:235], v7, s[8:11], s75 offen offset:2048 sc1
    v_mfma_f32_16x16x32_bf16 v[76:79], v[116:119], v[180:183], v[76:79]
    ds_read_b64_tr_b16 v[164:165], v241 offset:10432
    v_mfma_f32_16x16x32_bf16 v[40:43], v[120:123], v[176:179], v[40:43]
    ds_read_b64_tr_b16 v[166:167], v241 offset:12992
    ds_read_b64_tr_b16 v[168:169], v240 offset:10496
    v_mfma_f32_16x16x32_bf16 v[80:83], v[120:123], v[180:183], v[80:83]
    ds_read_b64_tr_b16 v[170:171], v240 offset:13056
    v_mfma_f32_16x16x32_bf16 v[44:47], v[124:127], v[176:179], v[44:47]
    ds_read_b64_tr_b16 v[172:173], v241 offset:10496
    buffer_load_dwordx4 v[236:239], v7, s[8:11], s75 offen offset:2304 sc1
    s_add_u32 s75, s75, 32768
    v_mfma_f32_16x16x32_bf16 v[84:87], v[124:127], v[180:183], v[84:87]
    ds_read_b64_tr_b16 v[174:175], v241 offset:13056
    v_mfma_f32_16x16x32_bf16 v[48:51], v[128:131], v[176:179], v[48:51]
    v_mfma_f32_16x16x32_bf16 v[88:91], v[128:131], v[180:183], v[88:91]
    s_waitcnt lgkmcnt(15)
    v_mfma_f32_16x16x32_bf16 v[52:55], v[132:135], v[176:179], v[52:55]
    v_mfma_f32_16x16x32_bf16 v[92:95], v[132:135], v[180:183], v[92:95]
    s_waitcnt vmcnt(18) lgkmcnt(0)
    s_barrier
    v_mfma_f32_16x16x32_bf16 v[16:19], v[136:139], v[184:187], v[16:19]
    ds_read_b64_tr_b16 v[96:97], v242 offset:0
    ds_read_b64_tr_b16 v[98:99], v242 offset:2560
    v_mfma_f32_16x16x32_bf16 v[56:59], v[136:139], v[188:191], v[56:59]
    ds_read_b64_tr_b16 v[100:101], v243 offset:0
    s_add_u32 m0, s25, 0
    s_nop 0
    buffer_load_dwordx4 v2, s[4:7], s68 offen lds
    v_mfma_f32_16x16x32_bf16 v[20:23], v[140:143], v[184:187], v[20:23]
    ds_read_b64_tr_b16 v[102:103], v243 offset:2560
    v_mfma_f32_16x16x32_bf16 v[60:63], v[140:143], v[188:191], v[60:63]
    ds_read_b64_tr_b16 v[104:105], v242 offset:64
    v_mfma_f32_16x16x32_bf16 v[24:27], v[144:147], v[184:187], v[24:27]
    ds_read_b64_tr_b16 v[106:107], v242 offset:2624
    ds_read_b64_tr_b16 v[108:109], v243 offset:64
    v_mfma_f32_16x16x32_bf16 v[64:67], v[144:147], v[188:191], v[64:67]
    ds_read_b64_tr_b16 v[110:111], v243 offset:2624
    s_add_u32 m0, s25, 1024
    s_nop 0
    buffer_load_dwordx4 v3, s[4:7], s68 offen lds
    v_mfma_f32_16x16x32_bf16 v[28:31], v[148:151], v[184:187], v[28:31]
    ds_read_b64_tr_b16 v[112:113], v242 offset:128
    v_mfma_f32_16x16x32_bf16 v[68:71], v[148:151], v[188:191], v[68:71]
    ds_read_b64_tr_b16 v[114:115], v242 offset:2688
    v_mfma_f32_16x16x32_bf16 v[32:35], v[152:155], v[184:187], v[32:35]
    ds_read_b64_tr_b16 v[116:117], v243 offset:128
    ds_read_b64_tr_b16 v[118:119], v243 offset:2688
    v_mfma_f32_16x16x32_bf16 v[72:75], v[152:155], v[188:191], v[72:75]
    ds_read_b64_tr_b16 v[120:121], v242 offset:192
    s_add_u32 m0, s25, 2048
    s_nop 0
    buffer_load_dwordx4 v4, s[4:7], s68 offen lds
    v_mfma_f32_16x16x32_bf16 v[36:39], v[156:159], v[184:187], v[36:39]
    ds_read_b64_tr_b16 v[122:123], v242 offset:2752
    v_mfma_f32_16x16x32_bf16 v[76:79], v[156:159], v[188:191], v[76:79]
    ds_read_b64_tr_b16 v[124:125], v243 offset:192
    v_mfma_f32_16x16x32_bf16 v[40:43], v[160:163], v[184:187], v[40:43]
    ds_read_b64_tr_b16 v[126:127], v243 offset:2752
    ds_read_b64_tr_b16 v[128:129], v242 offset:256
    v_mfma_f32_16x16x32_bf16 v[80:83], v[160:163], v[188:191], v[80:83]
    ds_read_b64_tr_b16 v[130:131], v242 offset:2816
    s_add_u32 m0, s25, 3072
    s_nop 0
    buffer_load_dwordx4 v5, s[4:7], s68 offen lds
    v_mfma_f32_16x16x32_bf16 v[44:47], v[164:167], v[184:187], v[44:47]
    ds_read_b64_tr_b16 v[132:133], v243 offset:256
    v_mfma_f32_16x16x32_bf16 v[84:87], v[164:167], v[188:191], v[84:87]
    ds_read_b64_tr_b16 v[134:135], v243 offset:2816
    v_mfma_f32_16x16x32_bf16 v[48:51], v[168:171], v[184:187], v[48:51]
    v_mfma_f32_16x16x32_bf16 v[88:91], v[168:171], v[188:191], v[88:91]
    s_add_u32 m0, s25, 4096
    s_nop 0
    buffer_load_dwordx4 v6, s[4:7], s68 offen lds
    s_add_u32 s68, s68, 655360
    v_mfma_f32_16x16x32_bf16 v[52:55], v[172:175], v[184:187], v[52:55]
    v_mfma_f32_16x16x32_bf16 v[92:95], v[172:175], v[188:191], v[92:95]
    s_waitcnt lgkmcnt(15)
    v_mfma_f32_16x16x32_bf16 v[16:19], v[96:99], v[192:195], v[16:19]
    ds_read_b64_tr_b16 v[136:137], v242 offset:10240
    ds_read_b64_tr_b16 v[138:139], v242 offset:12800
    v_mfma_f32_16x16x32_bf16 v[56:59], v[96:99], v[196:199], v[56:59]
    ds_read_b64_tr_b16 v[140:141], v243 offset:10240
    v_mfma_f32_16x16x32_bf16 v[20:23], v[100:103], v[192:195], v[20:23]
    ds_read_b64_tr_b16 v[142:143], v243 offset:12800
    buffer_load_dwordx4 v[176:179], v7, s[8:11], s72 offen offset:0 sc1
    v_mfma_f32_16x16x32_bf16 v[60:63], v[100:103], v[196:199], v[60:63]
    ds_read_b64_tr_b16 v[144:145], v242 offset:10304
    s_waitcnt lgkmcnt(15)
    v_mfma_f32_16x16x32_bf16 v[24:27], v[104:107], v[192:195], v[24:27]
    ds_read_b64_tr_b16 v[146:147], v242 offset:12864
    ds_read_b64_tr_b16 v[148:149], v243 offset:10304
    v_mfma_f32_16x16x32_bf16 v[64:67], v[104:107], v[196:199], v[64:67]
    ds_read_b64_tr_b16 v[150:151], v243 offset:12864
    v_mfma_f32_16x16x32_bf16 v[28:31], v[108:111], v[192:195], v[28:31]
    ds_read_b64_tr_b16 v[152:153], v242 offset:10368
    buffer_load_dwordx4 v[180:183], v7, s[8:11], s72 offen offset:256 sc1
    v_mfma_f32_16x16x32_bf16 v[68:71], v[108:111], v[196:199], v[68:71]
    ds_read_b64_tr_b16 v[154:155], v242 offset:12928
    v_mfma_f32_16x16x32_bf16 v[32:35], v[112:115], v[192:195], v[32:35]
    ds_read_b64_tr_b16 v[156:157], v243 offset:10368
    ds_read_b64_tr_b16 v[158:159], v243 offset:12928
    v_mfma_f32_16x16x32_bf16 v[72:75], v[112:115], v[196:199], v[72:75]
    ds_read_b64_tr_b16 v[160:161], v242 offset:10432
    s_waitcnt lgkmcnt(15)
    v_mfma_f32_16x16x32_bf16 v[36:39], v[116:119], v[192:195], v[36:39]
    ds_read_b64_tr_b16 v[162:163], v242 offset:12992
    buffer_load_dwordx4 v[184:187], v7, s[8:11], s72 offen offset:2048 sc1
    v_mfma_f32_16x16x32_bf16 v[76:79], v[116:119], v[196:199], v[76:79]
    ds_read_b64_tr_b16 v[164:165], v243 offset:10432
    v_mfma_f32_16x16x32_bf16 v[40:43], v[120:123], v[192:195], v[40:43]
    ds_read_b64_tr_b16 v[166:167], v243 offset:12992
    ds_read_b64_tr_b16 v[168:169], v242 offset:10496
    v_mfma_f32_16x16x32_bf16 v[80:83], v[120:123], v[196:199], v[80:83]
    ds_read_b64_tr_b16 v[170:171], v242 offset:13056
    v_mfma_f32_16x16x32_bf16 v[44:47], v[124:127], v[192:195], v[44:47]
    ds_read_b64_tr_b16 v[172:173], v243 offset:10496
    buffer_load_dwordx4 v[188:191], v7, s[8:11], s72 offen offset:2304 sc1
    s_add_u32 s72, s72, 32768
    v_mfma_f32_16x16x32_bf16 v[84:87], v[124:127], v[196:199], v[84:87]
    ds_read_b64_tr_b16 v[174:175], v243 offset:13056
    v_mfma_f32_16x16x32_bf16 v[48:51], v[128:131], v[192:195], v[48:51]
    v_mfma_f32_16x16x32_bf16 v[88:91], v[128:131], v[196:199], v[88:91]
    s_waitcnt lgkmcnt(15)
    v_mfma_f32_16x16x32_bf16 v[52:55], v[132:135], v[192:195], v[52:55]
    v_mfma_f32_16x16x32_bf16 v[92:95], v[132:135], v[196:199], v[92:95]
    s_waitcnt vmcnt(18) lgkmcnt(0)
    s_barrier
    v_mfma_f32_16x16x32_bf16 v[16:19], v[136:139], v[200:203], v[16:19]
    ds_read_b64_tr_b16 v[96:97], v244 offset:0
    ds_read_b64_tr_b16 v[98:99], v244 offset:2560
    v_mfma_f32_16x16x32_bf16 v[56:59], v[136:139], v[204:207], v[56:59]
    ds_read_b64_tr_b16 v[100:101], v245 offset:0
    s_add_u32 m0, s25, 40960
    s_nop 0
    buffer_load_dwordx4 v2, s[4:7], s69 offen lds
    v_mfma_f32_16x16x32_bf16 v[20:23], v[140:143], v[200:203], v[20:23]
    ds_read_b64_tr_b16 v[102:103], v245 offset:2560
    v_mfma_f32_16x16x32_bf16 v[60:63], v[140:143], v[204:207], v[60:63]
    ds_read_b64_tr_b16 v[104:105], v244 offset:64
    v_mfma_f32_16x16x32_bf16 v[24:27], v[144:147], v[200:203], v[24:27]
    ds_read_b64_tr_b16 v[106:107], v244 offset:2624
    ds_read_b64_tr_b16 v[108:109], v245 offset:64
    v_mfma_f32_16x16x32_bf16 v[64:67], v[144:147], v[204:207], v[64:67]
    ds_read_b64_tr_b16 v[110:111], v245 offset:2624
    s_add_u32 m0, s25, 41984
    s_nop 0
    buffer_load_dwordx4 v3, s[4:7], s69 offen lds
    v_mfma_f32_16x16x32_bf16 v[28:31], v[148:151], v[200:203], v[28:31]
    ds_read_b64_tr_b16 v[112:113], v244 offset:128
    v_mfma_f32_16x16x32_bf16 v[68:71], v[148:151], v[204:207], v[68:71]
    ds_read_b64_tr_b16 v[114:115], v244 offset:2688
    v_mfma_f32_16x16x32_bf16 v[32:35], v[152:155], v[200:203], v[32:35]
    ds_read_b64_tr_b16 v[116:117], v245 offset:128
    ds_read_b64_tr_b16 v[118:119], v245 offset:2688
    v_mfma_f32_16x16x32_bf16 v[72:75], v[152:155], v[204:207], v[72:75]
    ds_read_b64_tr_b16 v[120:121], v244 offset:192
    s_add_u32 m0, s25, 43008
    s_nop 0
    buffer_load_dwordx4 v4, s[4:7], s69 offen lds
    v_mfma_f32_16x16x32_bf16 v[36:39], v[156:159], v[200:203], v[36:39]
    ds_read_b64_tr_b16 v[122:123], v244 offset:2752
    v_mfma_f32_16x16x32_bf16 v[76:79], v[156:159], v[204:207], v[76:79]
    ds_read_b64_tr_b16 v[124:125], v245 offset:192
    v_mfma_f32_16x16x32_bf16 v[40:43], v[160:163], v[200:203], v[40:43]
    ds_read_b64_tr_b16 v[126:127], v245 offset:2752
    ds_read_b64_tr_b16 v[128:129], v244 offset:256
    v_mfma_f32_16x16x32_bf16 v[80:83], v[160:163], v[204:207], v[80:83]
    ds_read_b64_tr_b16 v[130:131], v244 offset:2816
    s_add_u32 m0, s25, 44032
    s_nop 0
    buffer_load_dwordx4 v5, s[4:7], s69 offen lds
    v_mfma_f32_16x16x32_bf16 v[44:47], v[164:167], v[200:203], v[44:47]
    ds_read_b64_tr_b16 v[132:133], v245 offset:256
    v_mfma_f32_16x16x32_bf16 v[84:87], v[164:167], v[204:207], v[84:87]
    ds_read_b64_tr_b16 v[134:135], v245 offset:2816
    v_mfma_f32_16x16x32_bf16 v[48:51], v[168:171], v[200:203], v[48:51]
    v_mfma_f32_16x16x32_bf16 v[88:91], v[168:171], v[204:207], v[88:91]
    s_add_u32 m0, s25, 45056
    s_nop 0
    buffer_load_dwordx4 v6, s[4:7], s69 offen lds
    s_add_u32 s69, s69, 655360
    v_mfma_f32_16x16x32_bf16 v[52:55], v[172:175], v[200:203], v[52:55]
    v_mfma_f32_16x16x32_bf16 v[92:95], v[172:175], v[204:207], v[92:95]
    s_waitcnt lgkmcnt(15)
    v_mfma_f32_16x16x32_bf16 v[16:19], v[96:99], v[208:211], v[16:19]
    ds_read_b64_tr_b16 v[136:137], v244 offset:10240
    ds_read_b64_tr_b16 v[138:139], v244 offset:12800
    v_mfma_f32_16x16x32_bf16 v[56:59], v[96:99], v[212:215], v[56:59]
    ds_read_b64_tr_b16 v[140:141], v245 offset:10240
    v_mfma_f32_16x16x32_bf16 v[20:23], v[100:103], v[208:211], v[20:23]
    ds_read_b64_tr_b16 v[142:143], v245 offset:12800
    buffer_load_dwordx4 v[192:195], v7, s[8:11], s73 offen offset:0 sc1
    v_mfma_f32_16x16x32_bf16 v[60:63], v[100:103], v[212:215], v[60:63]
    ds_read_b64_tr_b16 v[144:145], v244 offset:10304
    s_waitcnt lgkmcnt(15)
    v_mfma_f32_16x16x32_bf16 v[24:27], v[104:107], v[208:211], v[24:27]
    ds_read_b64_tr_b16 v[146:147], v244 offset:12864
    ds_read_b64_tr_b16 v[148:149], v245 offset:10304
    v_mfma_f32_16x16x32_bf16 v[64:67], v[104:107], v[212:215], v[64:67]
    ds_read_b64_tr_b16 v[150:151], v245 offset:12864
    v_mfma_f32_16x16x32_bf16 v[28:31], v[108:111], v[208:211], v[28:31]
    ds_read_b64_tr_b16 v[152:153], v244 offset:10368
    buffer_load_dwordx4 v[196:199], v7, s[8:11], s73 offen offset:256 sc1
    v_mfma_f32_16x16x32_bf16 v[68:71], v[108:111], v[212:215], v[68:71]
    ds_read_b64_tr_b16 v[154:155], v244 offset:12928
    v_mfma_f32_16x16x32_bf16 v[32:35], v[112:115], v[208:211], v[32:35]
    ds_read_b64_tr_b16 v[156:157], v245 offset:10368
    ds_read_b64_tr_b16 v[158:159], v245 offset:12928
    v_mfma_f32_16x16x32_bf16 v[72:75], v[112:115], v[212:215], v[72:75]
    ds_read_b64_tr_b16 v[160:161], v244 offset:10432
    s_waitcnt lgkmcnt(15)
    v_mfma_f32_16x16x32_bf16 v[36:39], v[116:119], v[208:211], v[36:39]
    ds_read_b64_tr_b16 v[162:163], v244 offset:12992
    buffer_load_dwordx4 v[200:203], v7, s[8:11], s73 offen offset:2048 sc1
    v_mfma_f32_16x16x32_bf16 v[76:79], v[116:119], v[212:215], v[76:79]
    ds_read_b64_tr_b16 v[164:165], v245 offset:10432
    v_mfma_f32_16x16x32_bf16 v[40:43], v[120:123], v[208:211], v[40:43]
    ds_read_b64_tr_b16 v[166:167], v245 offset:12992
    ds_read_b64_tr_b16 v[168:169], v244 offset:10496
    v_mfma_f32_16x16x32_bf16 v[80:83], v[120:123], v[212:215], v[80:83]
    ds_read_b64_tr_b16 v[170:171], v244 offset:13056
    v_mfma_f32_16x16x32_bf16 v[44:47], v[124:127], v[208:211], v[44:47]
    ds_read_b64_tr_b16 v[172:173], v245 offset:10496
    buffer_load_dwordx4 v[204:207], v7, s[8:11], s73 offen offset:2304 sc1
    s_add_u32 s73, s73, 32768
    v_mfma_f32_16x16x32_bf16 v[84:87], v[124:127], v[212:215], v[84:87]
    ds_read_b64_tr_b16 v[174:175], v245 offset:13056
    v_mfma_f32_16x16x32_bf16 v[48:51], v[128:131], v[208:211], v[48:51]
    v_mfma_f32_16x16x32_bf16 v[88:91], v[128:131], v[212:215], v[88:91]
    s_waitcnt lgkmcnt(15)
    v_mfma_f32_16x16x32_bf16 v[52:55], v[132:135], v[208:211], v[52:55]
    v_mfma_f32_16x16x32_bf16 v[92:95], v[132:135], v[212:215], v[92:95]
    s_waitcnt vmcnt(18) lgkmcnt(0)
    s_barrier
    v_mfma_f32_16x16x32_bf16 v[16:19], v[136:139], v[216:219], v[16:19]
    ds_read_b64_tr_b16 v[96:97], v246 offset:0
    ds_read_b64_tr_b16 v[98:99], v246 offset:2560
    v_mfma_f32_16x16x32_bf16 v[56:59], v[136:139], v[220:223], v[56:59]
    ds_read_b64_tr_b16 v[100:101], v247 offset:0
    s_add_u32 m0, s25, 81920
    s_nop 0
    buffer_load_dwordx4 v2, s[4:7], s70 offen lds
    v_mfma_f32_16x16x32_bf16 v[20:23], v[140:143], v[216:219], v[20:23]
    ds_read_b64_tr_b16 v[102:103], v247 offset:2560
    v_mfma_f32_16x16x32_bf16 v[60:63], v[140:143], v[220:223], v[60:63]
    ds_read_b64_tr_b16 v[104:105], v246 offset:64
    v_mfma_f32_16x16x32_bf16 v[24:27], v[144:147], v[216:219], v[24:27]
    ds_read_b64_tr_b16 v[106:107], v246 offset:2624
    ds_read_b64_tr_b16 v[108:109], v247 offset:64
    v_mfma_f32_16x16x32_bf16 v[64:67], v[144:147], v[220:223], v[64:67]
    ds_read_b64_tr_b16 v[110:111], v247 offset:2624
    s_add_u32 m0, s25, 82944
    s_nop 0
    buffer_load_dwordx4 v3, s[4:7], s70 offen lds
    v_mfma_f32_16x16x32_bf16 v[28:31], v[148:151], v[216:219], v[28:31]
    ds_read_b64_tr_b16 v[112:113], v246 offset:128
    v_mfma_f32_16x16x32_bf16 v[68:71], v[148:151], v[220:223], v[68:71]
    ds_read_b64_tr_b16 v[114:115], v246 offset:2688
    v_mfma_f32_16x16x32_bf16 v[32:35], v[152:155], v[216:219], v[32:35]
    ds_read_b64_tr_b16 v[116:117], v247 offset:128
    ds_read_b64_tr_b16 v[118:119], v247 offset:2688
    v_mfma_f32_16x16x32_bf16 v[72:75], v[152:155], v[220:223], v[72:75]
    ds_read_b64_tr_b16 v[120:121], v246 offset:192
    s_add_u32 m0, s25, 83968
    s_nop 0
    buffer_load_dwordx4 v4, s[4:7], s70 offen lds
    v_mfma_f32_16x16x32_bf16 v[36:39], v[156:159], v[216:219], v[36:39]
    ds_read_b64_tr_b16 v[122:123], v246 offset:2752
    v_mfma_f32_16x16x32_bf16 v[76:79], v[156:159], v[220:223], v[76:79]
    ds_read_b64_tr_b16 v[124:125], v247 offset:192
    v_mfma_f32_16x16x32_bf16 v[40:43], v[160:163], v[216:219], v[40:43]
    ds_read_b64_tr_b16 v[126:127], v247 offset:2752
    ds_read_b64_tr_b16 v[128:129], v246 offset:256
    v_mfma_f32_16x16x32_bf16 v[80:83], v[160:163], v[220:223], v[80:83]
    ds_read_b64_tr_b16 v[130:131], v246 offset:2816
    s_add_u32 m0, s25, 84992
    s_nop 0
    buffer_load_dwordx4 v5, s[4:7], s70 offen lds
    v_mfma_f32_16x16x32_bf16 v[44:47], v[164:167], v[216:219], v[44:47]
    ds_read_b64_tr_b16 v[132:133], v247 offset:256
    v_mfma_f32_16x16x32_bf16 v[84:87], v[164:167], v[220:223], v[84:87]
    ds_read_b64_tr_b16 v[134:135], v247 offset:2816
    v_mfma_f32_16x16x32_bf16 v[48:51], v[168:171], v[216:219], v[48:51]
    v_mfma_f32_16x16x32_bf16 v[88:91], v[168:171], v[220:223], v[88:91]
    s_add_u32 m0, s25, 86016
    s_nop 0
    buffer_load_dwordx4 v6, s[4:7], s70 offen lds
    s_add_u32 s70, s70, 655360
    v_mfma_f32_16x16x32_bf16 v[52:55], v[172:175], v[216:219], v[52:55]
    v_mfma_f32_16x16x32_bf16 v[92:95], v[172:175], v[220:223], v[92:95]
    s_waitcnt lgkmcnt(15)
    v_mfma_f32_16x16x32_bf16 v[16:19], v[96:99], v[224:227], v[16:19]
    ds_read_b64_tr_b16 v[136:137], v246 offset:10240
    ds_read_b64_tr_b16 v[138:139], v246 offset:12800
    v_mfma_f32_16x16x32_bf16 v[56:59], v[96:99], v[228:231], v[56:59]
    ds_read_b64_tr_b16 v[140:141], v247 offset:10240
    v_mfma_f32_16x16x32_bf16 v[20:23], v[100:103], v[224:227], v[20:23]
    ds_read_b64_tr_b16 v[142:143], v247 offset:12800
    buffer_load_dwordx4 v[208:211], v7, s[8:11], s74 offen offset:0 sc1
    v_mfma_f32_16x16x32_bf16 v[60:63], v[100:103], v[228:231], v[60:63]
    ds_read_b64_tr_b16 v[144:145], v246 offset:10304
    s_waitcnt lgkmcnt(15)
    v_mfma_f32_16x16x32_bf16 v[24:27], v[104:107], v[224:227], v[24:27]
    ds_read_b64_tr_b16 v[146:147], v246 offset:12864
    ds_read_b64_tr_b16 v[148:149], v247 offset:10304
    v_mfma_f32_16x16x32_bf16 v[64:67], v[104:107], v[228:231], v[64:67]
    ds_read_b64_tr_b16 v[150:151], v247 offset:12864
    v_mfma_f32_16x16x32_bf16 v[28:31], v[108:111], v[224:227], v[28:31]
    ds_read_b64_tr_b16 v[152:153], v246 offset:10368
    buffer_load_dwordx4 v[212:215], v7, s[8:11], s74 offen offset:256 sc1
    v_mfma_f32_16x16x32_bf16 v[68:71], v[108:111], v[228:231], v[68:71]
    ds_read_b64_tr_b16 v[154:155], v246 offset:12928
    v_mfma_f32_16x16x32_bf16 v[32:35], v[112:115], v[224:227], v[32:35]
    ds_read_b64_tr_b16 v[156:157], v247 offset:10368
    ds_read_b64_tr_b16 v[158:159], v247 offset:12928
    v_mfma_f32_16x16x32_bf16 v[72:75], v[112:115], v[228:231], v[72:75]
    ds_read_b64_tr_b16 v[160:161], v246 offset:10432
    s_waitcnt lgkmcnt(15)
    v_mfma_f32_16x16x32_bf16 v[36:39], v[116:119], v[224:227], v[36:39]
    ds_read_b64_tr_b16 v[162:163], v246 offset:12992
    buffer_load_dwordx4 v[216:219], v7, s[8:11], s74 offen offset:2048 sc1
    v_mfma_f32_16x16x32_bf16 v[76:79], v[116:119], v[228:231], v[76:79]
    ds_read_b64_tr_b16 v[164:165], v247 offset:10432
    v_mfma_f32_16x16x32_bf16 v[40:43], v[120:123], v[224:227], v[40:43]
    ds_read_b64_tr_b16 v[166:167], v247 offset:12992
    ds_read_b64_tr_b16 v[168:169], v246 offset:10496
    v_mfma_f32_16x16x32_bf16 v[80:83], v[120:123], v[228:231], v[80:83]
    ds_read_b64_tr_b16 v[170:171], v246 offset:13056
    v_mfma_f32_16x16x32_bf16 v[44:47], v[124:127], v[224:227], v[44:47]
    ds_read_b64_tr_b16 v[172:173], v247 offset:10496
    buffer_load_dwordx4 v[220:223], v7, s[8:11], s74 offen offset:2304 sc1
    s_add_u32 s74, s74, 32768
    v_mfma_f32_16x16x32_bf16 v[84:87], v[124:127], v[228:231], v[84:87]
    ds_read_b64_tr_b16 v[174:175], v247 offset:13056
    v_mfma_f32_16x16x32_bf16 v[48:51], v[128:131], v[224:227], v[48:51]
    v_mfma_f32_16x16x32_bf16 v[88:91], v[128:131], v[228:231], v[88:91]
    s_waitcnt lgkmcnt(15)
    v_mfma_f32_16x16x32_bf16 v[52:55], v[132:135], v[224:227], v[52:55]
    v_mfma_f32_16x16x32_bf16 v[92:95], v[132:135], v[228:231], v[92:95]
    s_waitcnt vmcnt(18) lgkmcnt(0)
    s_barrier
    v_mfma_f32_16x16x32_bf16 v[16:19], v[136:139], v[232:235], v[16:19]
    ds_read_b64_tr_b16 v[96:97], v240 offset:0
    ds_read_b64_tr_b16 v[98:99], v240 offset:2560
    v_mfma_f32_16x16x32_bf16 v[56:59], v[136:139], v[236:239], v[56:59]
    ds_read_b64_tr_b16 v[100:101], v241 offset:0
    s_add_u32 m0, s25, 122880
    s_nop 0
    buffer_load_dwordx4 v2, s[4:7], s71 offen lds
    v_mfma_f32_16x16x32_bf16 v[20:23], v[140:143], v[232:235], v[20:23]
    ds_read_b64_tr_b16 v[102:103], v241 offset:2560
    v_mfma_f32_16x16x32_bf16 v[60:63], v[140:143], v[236:239], v[60:63]
    ds_read_b64_tr_b16 v[104:105], v240 offset:64
    v_mfma_f32_16x16x32_bf16 v[24:27], v[144:147], v[232:235], v[24:27]
    ds_read_b64_tr_b16 v[106:107], v240 offset:2624
    ds_read_b64_tr_b16 v[108:109], v241 offset:64
    v_mfma_f32_16x16x32_bf16 v[64:67], v[144:147], v[236:239], v[64:67]
    ds_read_b64_tr_b16 v[110:111], v241 offset:2624
    s_add_u32 m0, s25, 123904
    s_nop 0
    buffer_load_dwordx4 v3, s[4:7], s71 offen lds
    v_mfma_f32_16x16x32_bf16 v[28:31], v[148:151], v[232:235], v[28:31]
    ds_read_b64_tr_b16 v[112:113], v240 offset:128
    v_mfma_f32_16x16x32_bf16 v[68:71], v[148:151], v[236:239], v[68:71]
    ds_read_b64_tr_b16 v[114:115], v240 offset:2688
    v_mfma_f32_16x16x32_bf16 v[32:35], v[152:155], v[232:235], v[32:35]
    ds_read_b64_tr_b16 v[116:117], v241 offset:128
    ds_read_b64_tr_b16 v[118:119], v241 offset:2688
    v_mfma_f32_16x16x32_bf16 v[72:75], v[152:155], v[236:239], v[72:75]
    ds_read_b64_tr_b16 v[120:121], v240 offset:192
    s_add_u32 m0, s25, 124928
    s_nop 0
    buffer_load_dwordx4 v4, s[4:7], s71 offen lds
    v_mfma_f32_16x16x32_bf16 v[36:39], v[156:159], v[232:235], v[36:39]
    ds_read_b64_tr_b16 v[122:123], v240 offset:2752
    v_mfma_f32_16x16x32_bf16 v[76:79], v[156:159], v[236:239], v[76:79]
    ds_read_b64_tr_b16 v[124:125], v241 offset:192
    v_mfma_f32_16x16x32_bf16 v[40:43], v[160:163], v[232:235], v[40:43]
    ds_read_b64_tr_b16 v[126:127], v241 offset:2752
    ds_read_b64_tr_b16 v[128:129], v240 offset:256
    v_mfma_f32_16x16x32_bf16 v[80:83], v[160:163], v[236:239], v[80:83]
    ds_read_b64_tr_b16 v[130:131], v240 offset:2816
    s_add_u32 m0, s25, 125952
    s_nop 0
    buffer_load_dwordx4 v5, s[4:7], s71 offen lds
    v_mfma_f32_16x16x32_bf16 v[44:47], v[164:167], v[232:235], v[44:47]
    ds_read_b64_tr_b16 v[132:133], v241 offset:256
    v_mfma_f32_16x16x32_bf16 v[84:87], v[164:167], v[236:239], v[84:87]
    ds_read_b64_tr_b16 v[134:135], v241 offset:2816
    v_mfma_f32_16x16x32_bf16 v[48:51], v[168:171], v[232:235], v[48:51]
    v_mfma_f32_16x16x32_bf16 v[88:91], v[168:171], v[236:239], v[88:91]
    s_add_u32 m0, s25, 126976
    s_nop 0
    buffer_load_dwordx4 v6, s[4:7], s71 offen lds
    s_add_u32 s71, s71, 655360
    v_mfma_f32_16x16x32_bf16 v[52:55], v[172:175], v[232:235], v[52:55]
    v_mfma_f32_16x16x32_bf16 v[92:95], v[172:175], v[236:239], v[92:95]
    s_waitcnt lgkmcnt(15)
    v_mfma_f32_16x16x32_bf16 v[16:19], v[96:99], v[176:179], v[16:19]
    ds_read_b64_tr_b16 v[136:137], v240 offset:10240
    ds_read_b64_tr_b16 v[138:139], v240 offset:12800
    v_mfma_f32_16x16x32_bf16 v[56:59], v[96:99], v[180:183], v[56:59]
    ds_read_b64_tr_b16 v[140:141], v241 offset:10240
    v_mfma_f32_16x16x32_bf16 v[20:23], v[100:103], v[176:179], v[20:23]
    ds_read_b64_tr_b16 v[142:143], v241 offset:12800
    buffer_load_dwordx4 v[224:227], v7, s[8:11], s75 offen offset:0 sc1
    v_mfma_f32_16x16x32_bf16 v[60:63], v[100:103], v[180:183], v[60:63]
    ds_read_b64_tr_b16 v[144:145], v240 offset:10304
    s_waitcnt lgkmcnt(15)
    v_mfma_f32_16x16x32_bf16 v[24:27], v[104:107], v[176:179], v[24:27]
    ds_read_b64_tr_b16 v[146:147], v240 offset:12864
    ds_read_b64_tr_b16 v[148:149], v241 offset:10304
    v_mfma_f32_16x16x32_bf16 v[64:67], v[104:107], v[180:183], v[64:67]
    ds_read_b64_tr_b16 v[150:151], v241 offset:12864
    v_mfma_f32_16x16x32_bf16 v[28:31], v[108:111], v[176:179], v[28:31]
    ds_read_b64_tr_b16 v[152:153], v240 offset:10368
    buffer_load_dwordx4 v[228:231], v7, s[8:11], s75 offen offset:256 sc1
    v_mfma_f32_16x16x32_bf16 v[68:71], v[108:111], v[180:183], v[68:71]
    ds_read_b64_tr_b16 v[154:155], v240 offset:12928
    v_mfma_f32_16x16x32_bf16 v[32:35], v[112:115], v[176:179], v[32:35]
    ds_read_b64_tr_b16 v[156:157], v241 offset:10368
    ds_read_b64_tr_b16 v[158:159], v241 offset:12928
    v_mfma_f32_16x16x32_bf16 v[72:75], v[112:115], v[180:183], v[72:75]
    ds_read_b64_tr_b16 v[160:161], v240 offset:10432
    s_waitcnt lgkmcnt(15)
    v_mfma_f32_16x16x32_bf16 v[36:39], v[116:119], v[176:179], v[36:39]
    ds_read_b64_tr_b16 v[162:163], v240 offset:12992
    buffer_load_dwordx4 v[232:235], v7, s[8:11], s75 offen offset:2048 sc1
    v_mfma_f32_16x16x32_bf16 v[76:79], v[116:119], v[180:183], v[76:79]
    ds_read_b64_tr_b16 v[164:165], v241 offset:10432
    v_mfma_f32_16x16x32_bf16 v[40:43], v[120:123], v[176:179], v[40:43]
    ds_read_b64_tr_b16 v[166:167], v241 offset:12992
    ds_read_b64_tr_b16 v[168:169], v240 offset:10496
    v_mfma_f32_16x16x32_bf16 v[80:83], v[120:123], v[180:183], v[80:83]
    ds_read_b64_tr_b16 v[170:171], v240 offset:13056
    v_mfma_f32_16x16x32_bf16 v[44:47], v[124:127], v[176:179], v[44:47]
    ds_read_b64_tr_b16 v[172:173], v241 offset:10496
    buffer_load_dwordx4 v[236:239], v7, s[8:11], s75 offen offset:2304 sc1
    s_add_u32 s75, s75, 32768
    v_mfma_f32_16x16x32_bf16 v[84:87], v[124:127], v[180:183], v[84:87]
    ds_read_b64_tr_b16 v[174:175], v241 offset:13056
    v_mfma_f32_16x16x32_bf16 v[48:51], v[128:131], v[176:179], v[48:51]
    v_mfma_f32_16x16x32_bf16 v[88:91], v[128:131], v[180:183], v[88:91]
    s_waitcnt lgkmcnt(15)
    v_mfma_f32_16x16x32_bf16 v[52:55], v[132:135], v[176:179], v[52:55]
    v_mfma_f32_16x16x32_bf16 v[92:95], v[132:135], v[180:183], v[92:95]
    s_waitcnt vmcnt(18) lgkmcnt(0)
    s_barrier
    v_mfma_f32_16x16x32_bf16 v[16:19], v[136:139], v[184:187], v[16:19]
    ds_read_b64_tr_b16 v[96:97], v242 offset:0
    ds_read_b64_tr_b16 v[98:99], v242 offset:2560
    v_mfma_f32_16x16x32_bf16 v[56:59], v[136:139], v[188:191], v[56:59]
    ds_read_b64_tr_b16 v[100:101], v243 offset:0
    v_mfma_f32_16x16x32_bf16 v[20:23], v[140:143], v[184:187], v[20:23]
    ds_read_b64_tr_b16 v[102:103], v243 offset:2560
    v_mfma_f32_16x16x32_bf16 v[60:63], v[140:143], v[188:191], v[60:63]
    ds_read_b64_tr_b16 v[104:105], v242 offset:64
    v_mfma_f32_16x16x32_bf16 v[24:27], v[144:147], v[184:187], v[24:27]
    ds_read_b64_tr_b16 v[106:107], v242 offset:2624
    ds_read_b64_tr_b16 v[108:109], v243 offset:64
    v_mfma_f32_16x16x32_bf16 v[64:67], v[144:147], v[188:191], v[64:67]
    ds_read_b64_tr_b16 v[110:111], v243 offset:2624
    v_mfma_f32_16x16x32_bf16 v[28:31], v[148:151], v[184:187], v[28:31]
    ds_read_b64_tr_b16 v[112:113], v242 offset:128
    v_mfma_f32_16x16x32_bf16 v[68:71], v[148:151], v[188:191], v[68:71]
    ds_read_b64_tr_b16 v[114:115], v242 offset:2688
    v_mfma_f32_16x16x32_bf16 v[32:35], v[152:155], v[184:187], v[32:35]
    ds_read_b64_tr_b16 v[116:117], v243 offset:128
    ds_read_b64_tr_b16 v[118:119], v243 offset:2688
    v_mfma_f32_16x16x32_bf16 v[72:75], v[152:155], v[188:191], v[72:75]
    ds_read_b64_tr_b16 v[120:121], v242 offset:192
    v_mfma_f32_16x16x32_bf16 v[36:39], v[156:159], v[184:187], v[36:39]
    ds_read_b64_tr_b16 v[122:123], v242 offset:2752
    v_mfma_f32_16x16x32_bf16 v[76:79], v[156:159], v[188:191], v[76:79]
    ds_read_b64_tr_b16 v[124:125], v243 offset:192
    v_mfma_f32_16x16x32_bf16 v[40:43], v[160:163], v[184:187], v[40:43]
    ds_read_b64_tr_b16 v[126:127], v243 offset:2752
    ds_read_b64_tr_b16 v[128:129], v242 offset:256
    v_mfma_f32_16x16x32_bf16 v[80:83], v[160:163], v[188:191], v[80:83]
    ds_read_b64_tr_b16 v[130:131], v242 offset:2816
    v_mfma_f32_16x16x32_bf16 v[44:47], v[164:167], v[184:187], v[44:47]
    ds_read_b64_tr_b16 v[132:133], v243 offset:256
    v_mfma_f32_16x16x32_bf16 v[84:87], v[164:167], v[188:191], v[84:87]
    ds_read_b64_tr_b16 v[134:135], v243 offset:2816
    v_mfma_f32_16x16x32_bf16 v[48:51], v[168:171], v[184:187], v[48:51]
    v_mfma_f32_16x16x32_bf16 v[88:91], v[168:171], v[188:191], v[88:91]
    v_mfma_f32_16x16x32_bf16 v[52:55], v[172:175], v[184:187], v[52:55]
    v_mfma_f32_16x16x32_bf16 v[92:95], v[172:175], v[188:191], v[92:95]
    s_waitcnt lgkmcnt(15)
    v_mfma_f32_16x16x32_bf16 v[16:19], v[96:99], v[192:195], v[16:19]
    ds_read_b64_tr_b16 v[136:137], v242 offset:10240
    ds_read_b64_tr_b16 v[138:139], v242 offset:12800
    v_mfma_f32_16x16x32_bf16 v[56:59], v[96:99], v[196:199], v[56:59]
    ds_read_b64_tr_b16 v[140:141], v243 offset:10240
    v_mfma_f32_16x16x32_bf16 v[20:23], v[100:103], v[192:195], v[20:23]
    ds_read_b64_tr_b16 v[142:143], v243 offset:12800
    v_mfma_f32_16x16x32_bf16 v[60:63], v[100:103], v[196:199], v[60:63]
    ds_read_b64_tr_b16 v[144:145], v242 offset:10304
    s_waitcnt lgkmcnt(15)
    v_mfma_f32_16x16x32_bf16 v[24:27], v[104:107], v[192:195], v[24:27]
    ds_read_b64_tr_b16 v[146:147], v242 offset:12864
    ds_read_b64_tr_b16 v[148:149], v243 offset:10304
    v_mfma_f32_16x16x32_bf16 v[64:67], v[104:107], v[196:199], v[64:67]
    ds_read_b64_tr_b16 v[150:151], v243 offset:12864
    v_mfma_f32_16x16x32_bf16 v[28:31], v[108:111], v[192:195], v[28:31]
    ds_read_b64_tr_b16 v[152:153], v242 offset:10368
    v_mfma_f32_16x16x32_bf16 v[68:71], v[108:111], v[196:199], v[68:71]
    ds_read_b64_tr_b16 v[154:155], v242 offset:12928
    v_mfma_f32_16x16x32_bf16 v[32:35], v[112:115], v[192:195], v[32:35]
    ds_read_b64_tr_b16 v[156:157], v243 offset:10368
    ds_read_b64_tr_b16 v[158:159], v243 offset:12928
    v_mfma_f32_16x16x32_bf16 v[72:75], v[112:115], v[196:199], v[72:75]
    ds_read_b64_tr_b16 v[160:161], v242 offset:10432
    s_waitcnt lgkmcnt(15)
    v_mfma_f32_16x16x32_bf16 v[36:39], v[116:119], v[192:195], v[36:39]
    ds_read_b64_tr_b16 v[162:163], v242 offset:12992
    v_mfma_f32_16x16x32_bf16 v[76:79], v[116:119], v[196:199], v[76:79]
    ds_read_b64_tr_b16 v[164:165], v243 offset:10432
    v_mfma_f32_16x16x32_bf16 v[40:43], v[120:123], v[192:195], v[40:43]
    ds_read_b64_tr_b16 v[166:167], v243 offset:12992
    ds_read_b64_tr_b16 v[168:169], v242 offset:10496
    v_mfma_f32_16x16x32_bf16 v[80:83], v[120:123], v[196:199], v[80:83]
    ds_read_b64_tr_b16 v[170:171], v242 offset:13056
    v_mfma_f32_16x16x32_bf16 v[44:47], v[124:127], v[192:195], v[44:47]
    ds_read_b64_tr_b16 v[172:173], v243 offset:10496
    v_mfma_f32_16x16x32_bf16 v[84:87], v[124:127], v[196:199], v[84:87]
    ds_read_b64_tr_b16 v[174:175], v243 offset:13056
    v_mfma_f32_16x16x32_bf16 v[48:51], v[128:131], v[192:195], v[48:51]
    v_mfma_f32_16x16x32_bf16 v[88:91], v[128:131], v[196:199], v[88:91]
    s_waitcnt lgkmcnt(15)
    v_mfma_f32_16x16x32_bf16 v[52:55], v[132:135], v[192:195], v[52:55]
    v_mfma_f32_16x16x32_bf16 v[92:95], v[132:135], v[196:199], v[92:95]
    s_waitcnt vmcnt(9) lgkmcnt(0)
    s_barrier
    v_mfma_f32_16x16x32_bf16 v[16:19], v[136:139], v[200:203], v[16:19]
    ds_read_b64_tr_b16 v[96:97], v244 offset:0
    ds_read_b64_tr_b16 v[98:99], v244 offset:2560
    v_mfma_f32_16x16x32_bf16 v[56:59], v[136:139], v[204:207], v[56:59]
    ds_read_b64_tr_b16 v[100:101], v245 offset:0
    v_mfma_f32_16x16x32_bf16 v[20:23], v[140:143], v[200:203], v[20:23]
    ds_read_b64_tr_b16 v[102:103], v245 offset:2560
    v_mfma_f32_16x16x32_bf16 v[60:63], v[140:143], v[204:207], v[60:63]
    ds_read_b64_tr_b16 v[104:105], v244 offset:64
    v_mfma_f32_16x16x32_bf16 v[24:27], v[144:147], v[200:203], v[24:27]
    ds_read_b64_tr_b16 v[106:107], v244 offset:2624
    ds_read_b64_tr_b16 v[108:109], v245 offset:64
    v_mfma_f32_16x16x32_bf16 v[64:67], v[144:147], v[204:207], v[64:67]
    ds_read_b64_tr_b16 v[110:111], v245 offset:2624
    v_mfma_f32_16x16x32_bf16 v[28:31], v[148:151], v[200:203], v[28:31]
    ds_read_b64_tr_b16 v[112:113], v244 offset:128
    v_mfma_f32_16x16x32_bf16 v[68:71], v[148:151], v[204:207], v[68:71]
    ds_read_b64_tr_b16 v[114:115], v244 offset:2688
    v_mfma_f32_16x16x32_bf16 v[32:35], v[152:155], v[200:203], v[32:35]
    ds_read_b64_tr_b16 v[116:117], v245 offset:128
    ds_read_b64_tr_b16 v[118:119], v245 offset:2688
    v_mfma_f32_16x16x32_bf16 v[72:75], v[152:155], v[204:207], v[72:75]
    ds_read_b64_tr_b16 v[120:121], v244 offset:192
    v_mfma_f32_16x16x32_bf16 v[36:39], v[156:159], v[200:203], v[36:39]
    ds_read_b64_tr_b16 v[122:123], v244 offset:2752
    v_mfma_f32_16x16x32_bf16 v[76:79], v[156:159], v[204:207], v[76:79]
    ds_read_b64_tr_b16 v[124:125], v245 offset:192
    v_mfma_f32_16x16x32_bf16 v[40:43], v[160:163], v[200:203], v[40:43]
    ds_read_b64_tr_b16 v[126:127], v245 offset:2752
    ds_read_b64_tr_b16 v[128:129], v244 offset:256
    v_mfma_f32_16x16x32_bf16 v[80:83], v[160:163], v[204:207], v[80:83]
    ds_read_b64_tr_b16 v[130:131], v244 offset:2816
    v_mfma_f32_16x16x32_bf16 v[44:47], v[164:167], v[200:203], v[44:47]
    ds_read_b64_tr_b16 v[132:133], v245 offset:256
    v_mfma_f32_16x16x32_bf16 v[84:87], v[164:167], v[204:207], v[84:87]
    ds_read_b64_tr_b16 v[134:135], v245 offset:2816
    v_mfma_f32_16x16x32_bf16 v[48:51], v[168:171], v[200:203], v[48:51]
    v_mfma_f32_16x16x32_bf16 v[88:91], v[168:171], v[204:207], v[88:91]
    v_mfma_f32_16x16x32_bf16 v[52:55], v[172:175], v[200:203], v[52:55]
    v_mfma_f32_16x16x32_bf16 v[92:95], v[172:175], v[204:207], v[92:95]
    s_waitcnt lgkmcnt(15)
    v_mfma_f32_16x16x32_bf16 v[16:19], v[96:99], v[208:211], v[16:19]
    ds_read_b64_tr_b16 v[136:137], v244 offset:10240
    ds_read_b64_tr_b16 v[138:139], v244 offset:12800
    v_mfma_f32_16x16x32_bf16 v[56:59], v[96:99], v[212:215], v[56:59]
    ds_read_b64_tr_b16 v[140:141], v245 offset:10240
    v_mfma_f32_16x16x32_bf16 v[20:23], v[100:103], v[208:211], v[20:23]
    ds_read_b64_tr_b16 v[142:143], v245 offset:12800
    v_mfma_f32_16x16x32_bf16 v[60:63], v[100:103], v[212:215], v[60:63]
    ds_read_b64_tr_b16 v[144:145], v244 offset:10304
    s_waitcnt lgkmcnt(15)
    v_mfma_f32_16x16x32_bf16 v[24:27], v[104:107], v[208:211], v[24:27]
    ds_read_b64_tr_b16 v[146:147], v244 offset:12864
    ds_read_b64_tr_b16 v[148:149], v245 offset:10304
    v_mfma_f32_16x16x32_bf16 v[64:67], v[104:107], v[212:215], v[64:67]
    ds_read_b64_tr_b16 v[150:151], v245 offset:12864
    v_mfma_f32_16x16x32_bf16 v[28:31], v[108:111], v[208:211], v[28:31]
    ds_read_b64_tr_b16 v[152:153], v244 offset:10368
    v_mfma_f32_16x16x32_bf16 v[68:71], v[108:111], v[212:215], v[68:71]
    ds_read_b64_tr_b16 v[154:155], v244 offset:12928
    v_mfma_f32_16x16x32_bf16 v[32:35], v[112:115], v[208:211], v[32:35]
    ds_read_b64_tr_b16 v[156:157], v245 offset:10368
    ds_read_b64_tr_b16 v[158:159], v245 offset:12928
    v_mfma_f32_16x16x32_bf16 v[72:75], v[112:115], v[212:215], v[72:75]
    ds_read_b64_tr_b16 v[160:161], v244 offset:10432
    s_waitcnt lgkmcnt(15)
    v_mfma_f32_16x16x32_bf16 v[36:39], v[116:119], v[208:211], v[36:39]
    ds_read_b64_tr_b16 v[162:163], v244 offset:12992
    v_mfma_f32_16x16x32_bf16 v[76:79], v[116:119], v[212:215], v[76:79]
    ds_read_b64_tr_b16 v[164:165], v245 offset:10432
    v_mfma_f32_16x16x32_bf16 v[40:43], v[120:123], v[208:211], v[40:43]
    ds_read_b64_tr_b16 v[166:167], v245 offset:12992
    ds_read_b64_tr_b16 v[168:169], v244 offset:10496
    v_mfma_f32_16x16x32_bf16 v[80:83], v[120:123], v[212:215], v[80:83]
    ds_read_b64_tr_b16 v[170:171], v244 offset:13056
    v_mfma_f32_16x16x32_bf16 v[44:47], v[124:127], v[208:211], v[44:47]
    ds_read_b64_tr_b16 v[172:173], v245 offset:10496
    v_mfma_f32_16x16x32_bf16 v[84:87], v[124:127], v[212:215], v[84:87]
    ds_read_b64_tr_b16 v[174:175], v245 offset:13056
    v_mfma_f32_16x16x32_bf16 v[48:51], v[128:131], v[208:211], v[48:51]
    v_mfma_f32_16x16x32_bf16 v[88:91], v[128:131], v[212:215], v[88:91]
    s_waitcnt lgkmcnt(15)
    v_mfma_f32_16x16x32_bf16 v[52:55], v[132:135], v[208:211], v[52:55]
    v_mfma_f32_16x16x32_bf16 v[92:95], v[132:135], v[212:215], v[92:95]
    s_waitcnt vmcnt(0) lgkmcnt(0)
    s_barrier
    v_mfma_f32_16x16x32_bf16 v[16:19], v[136:139], v[216:219], v[16:19]
    ds_read_b64_tr_b16 v[96:97], v246 offset:0
    ds_read_b64_tr_b16 v[98:99], v246 offset:2560
    v_mfma_f32_16x16x32_bf16 v[56:59], v[136:139], v[220:223], v[56:59]
    ds_read_b64_tr_b16 v[100:101], v247 offset:0
    v_mfma_f32_16x16x32_bf16 v[20:23], v[140:143], v[216:219], v[20:23]
    ds_read_b64_tr_b16 v[102:103], v247 offset:2560
    v_mfma_f32_16x16x32_bf16 v[60:63], v[140:143], v[220:223], v[60:63]
    ds_read_b64_tr_b16 v[104:105], v246 offset:64
    v_mfma_f32_16x16x32_bf16 v[24:27], v[144:147], v[216:219], v[24:27]
    ds_read_b64_tr_b16 v[106:107], v246 offset:2624
    ds_read_b64_tr_b16 v[108:109], v247 offset:64
    v_mfma_f32_16x16x32_bf16 v[64:67], v[144:147], v[220:223], v[64:67]
    ds_read_b64_tr_b16 v[110:111], v247 offset:2624
    v_mfma_f32_16x16x32_bf16 v[28:31], v[148:151], v[216:219], v[28:31]
    ds_read_b64_tr_b16 v[112:113], v246 offset:128
    v_mfma_f32_16x16x32_bf16 v[68:71], v[148:151], v[220:223], v[68:71]
    ds_read_b64_tr_b16 v[114:115], v246 offset:2688
    v_mfma_f32_16x16x32_bf16 v[32:35], v[152:155], v[216:219], v[32:35]
    ds_read_b64_tr_b16 v[116:117], v247 offset:128
    ds_read_b64_tr_b16 v[118:119], v247 offset:2688
    v_mfma_f32_16x16x32_bf16 v[72:75], v[152:155], v[220:223], v[72:75]
    ds_read_b64_tr_b16 v[120:121], v246 offset:192
    v_mfma_f32_16x16x32_bf16 v[36:39], v[156:159], v[216:219], v[36:39]
    ds_read_b64_tr_b16 v[122:123], v246 offset:2752
    v_mfma_f32_16x16x32_bf16 v[76:79], v[156:159], v[220:223], v[76:79]
    ds_read_b64_tr_b16 v[124:125], v247 offset:192
    v_mfma_f32_16x16x32_bf16 v[40:43], v[160:163], v[216:219], v[40:43]
    ds_read_b64_tr_b16 v[126:127], v247 offset:2752
    ds_read_b64_tr_b16 v[128:129], v246 offset:256
    v_mfma_f32_16x16x32_bf16 v[80:83], v[160:163], v[220:223], v[80:83]
    ds_read_b64_tr_b16 v[130:131], v246 offset:2816
    v_mfma_f32_16x16x32_bf16 v[44:47], v[164:167], v[216:219], v[44:47]
    ds_read_b64_tr_b16 v[132:133], v247 offset:256
    v_mfma_f32_16x16x32_bf16 v[84:87], v[164:167], v[220:223], v[84:87]
    ds_read_b64_tr_b16 v[134:135], v247 offset:2816
    v_mfma_f32_16x16x32_bf16 v[48:51], v[168:171], v[216:219], v[48:51]
    v_mfma_f32_16x16x32_bf16 v[88:91], v[168:171], v[220:223], v[88:91]
    v_mfma_f32_16x16x32_bf16 v[52:55], v[172:175], v[216:219], v[52:55]
    v_mfma_f32_16x16x32_bf16 v[92:95], v[172:175], v[220:223], v[92:95]
    s_waitcnt lgkmcnt(15)
    v_mfma_f32_16x16x32_bf16 v[16:19], v[96:99], v[224:227], v[16:19]
    ds_read_b64_tr_b16 v[136:137], v246 offset:10240
    ds_read_b64_tr_b16 v[138:139], v246 offset:12800
    v_mfma_f32_16x16x32_bf16 v[56:59], v[96:99], v[228:231], v[56:59]
    ds_read_b64_tr_b16 v[140:141], v247 offset:10240
    v_mfma_f32_16x16x32_bf16 v[20:23], v[100:103], v[224:227], v[20:23]
    ds_read_b64_tr_b16 v[142:143], v247 offset:12800
    v_mfma_f32_16x16x32_bf16 v[60:63], v[100:103], v[228:231], v[60:63]
    ds_read_b64_tr_b16 v[144:145], v246 offset:10304
    s_waitcnt lgkmcnt(15)
    v_mfma_f32_16x16x32_bf16 v[24:27], v[104:107], v[224:227], v[24:27]
    ds_read_b64_tr_b16 v[146:147], v246 offset:12864
    ds_read_b64_tr_b16 v[148:149], v247 offset:10304
    v_mfma_f32_16x16x32_bf16 v[64:67], v[104:107], v[228:231], v[64:67]
    ds_read_b64_tr_b16 v[150:151], v247 offset:12864
    v_mfma_f32_16x16x32_bf16 v[28:31], v[108:111], v[224:227], v[28:31]
    ds_read_b64_tr_b16 v[152:153], v246 offset:10368
    v_mfma_f32_16x16x32_bf16 v[68:71], v[108:111], v[228:231], v[68:71]
    ds_read_b64_tr_b16 v[154:155], v246 offset:12928
    v_mfma_f32_16x16x32_bf16 v[32:35], v[112:115], v[224:227], v[32:35]
    ds_read_b64_tr_b16 v[156:157], v247 offset:10368
    ds_read_b64_tr_b16 v[158:159], v247 offset:12928
    v_mfma_f32_16x16x32_bf16 v[72:75], v[112:115], v[228:231], v[72:75]
    ds_read_b64_tr_b16 v[160:161], v246 offset:10432
    s_waitcnt lgkmcnt(15)
    v_mfma_f32_16x16x32_bf16 v[36:39], v[116:119], v[224:227], v[36:39]
    ds_read_b64_tr_b16 v[162:163], v246 offset:12992
    v_mfma_f32_16x16x32_bf16 v[76:79], v[116:119], v[228:231], v[76:79]
    ds_read_b64_tr_b16 v[164:165], v247 offset:10432
    v_mfma_f32_16x16x32_bf16 v[40:43], v[120:123], v[224:227], v[40:43]
    ds_read_b64_tr_b16 v[166:167], v247 offset:12992
    ds_read_b64_tr_b16 v[168:169], v246 offset:10496
    v_mfma_f32_16x16x32_bf16 v[80:83], v[120:123], v[228:231], v[80:83]
    ds_read_b64_tr_b16 v[170:171], v246 offset:13056
    v_mfma_f32_16x16x32_bf16 v[44:47], v[124:127], v[224:227], v[44:47]
    ds_read_b64_tr_b16 v[172:173], v247 offset:10496
    v_mfma_f32_16x16x32_bf16 v[84:87], v[124:127], v[228:231], v[84:87]
    ds_read_b64_tr_b16 v[174:175], v247 offset:13056
    v_mfma_f32_16x16x32_bf16 v[48:51], v[128:131], v[224:227], v[48:51]
    v_mfma_f32_16x16x32_bf16 v[88:91], v[128:131], v[228:231], v[88:91]
    s_waitcnt lgkmcnt(15)
    v_mfma_f32_16x16x32_bf16 v[52:55], v[132:135], v[224:227], v[52:55]
    v_mfma_f32_16x16x32_bf16 v[92:95], v[132:135], v[228:231], v[92:95]
    v_mfma_f32_16x16x32_bf16 v[16:19], v[136:139], v[232:235], v[16:19]
    v_mfma_f32_16x16x32_bf16 v[56:59], v[136:139], v[236:239], v[56:59]
    v_mfma_f32_16x16x32_bf16 v[20:23], v[140:143], v[232:235], v[20:23]
    v_mfma_f32_16x16x32_bf16 v[60:63], v[140:143], v[236:239], v[60:63]
    s_waitcnt lgkmcnt(14)
    v_mfma_f32_16x16x32_bf16 v[24:27], v[144:147], v[232:235], v[24:27]
    v_mfma_f32_16x16x32_bf16 v[64:67], v[144:147], v[236:239], v[64:67]
    s_waitcnt lgkmcnt(12)
    v_mfma_f32_16x16x32_bf16 v[28:31], v[148:151], v[232:235], v[28:31]
    v_mfma_f32_16x16x32_bf16 v[68:71], v[148:151], v[236:239], v[68:71]
    s_waitcnt lgkmcnt(10)
    v_mfma_f32_16x16x32_bf16 v[32:35], v[152:155], v[232:235], v[32:35]
    v_mfma_f32_16x16x32_bf16 v[72:75], v[152:155], v[236:239], v[72:75]
    s_waitcnt lgkmcnt(8)
    v_mfma_f32_16x16x32_bf16 v[36:39], v[156:159], v[232:235], v[36:39]
    v_mfma_f32_16x16x32_bf16 v[76:79], v[156:159], v[236:239], v[76:79]
    s_waitcnt lgkmcnt(6)
    v_mfma_f32_16x16x32_bf16 v[40:43], v[160:163], v[232:235], v[40:43]
    v_mfma_f32_16x16x32_bf16 v[80:83], v[160:163], v[236:239], v[80:83]
    s_waitcnt lgkmcnt(4)
    v_mfma_f32_16x16x32_bf16 v[44:47], v[164:167], v[232:235], v[44:47]
    v_mfma_f32_16x16x32_bf16 v[84:87], v[164:167], v[236:239], v[84:87]
    s_waitcnt lgkmcnt(2)
    v_mfma_f32_16x16x32_bf16 v[48:51], v[168:171], v[232:235], v[48:51]
    v_mfma_f32_16x16x32_bf16 v[88:91], v[168:171], v[236:239], v[88:91]
    s_waitcnt lgkmcnt(0)
    v_mfma_f32_16x16x32_bf16 v[52:55], v[172:175], v[232:235], v[52:55]
    v_mfma_f32_16x16x32_bf16 v[92:95], v[172:175], v[236:239], v[92:95]
    s_lshl_b32 s60, s56, 3
    s_add_u32 s60, s60, s58
    s_lshl_b32 s60, s60, 2
    s_add_u32 s60, s60, s59
    s_lshl_b32 s61, s60, 3
    s_add_u32 s61, s61, s27
    s_mul_i32 s61, s61, 40960
    s_add_u32 s61, s61, 0x2000000
    s_add_u32 s66, s38, s61
    s_addc_u32 s67, s39, 0
    s_mov_b32 s12, s66
    s_and_b32 s13, s67, 0xffff
    s_mov_b32 s14, 0xa000
    s_mov_b32 s15, 0x00020000
    v_lshlrev_b32 v10, 4, v1
    s_mul_i32 s44, s27, 10240
    v_add_u32 v11, s44, v10
    s_xor_b32 s44, s27, 4
    s_mul_i32 s44, s44, 10240
    v_add_u32 v12, s44, v10
    v_lshlrev_b32 v13, 3, v1
    s_waitcnt vmcnt(0) lgkmcnt(0)
    s_barrier
    s_cmp_eq_u32 s54, 0
    s_cbranch_scc1 L2_g0
    ds_write_b128 v11, v[16:19] offset:0
    ds_write_b128 v11, v[20:23] offset:1024
    ds_write_b128 v11, v[24:27] offset:2048
    ds_write_b128 v11, v[28:31] offset:3072
    ds_write_b128 v11, v[32:35] offset:4096
    ds_write_b128 v11, v[36:39] offset:5120
    ds_write_b128 v11, v[40:43] offset:6144
    ds_write_b128 v11, v[44:47] offset:7168
    ds_write_b128 v11, v[48:51] offset:8192
    ds_write_b128 v11, v[52:55] offset:9216
    v_mov_b32 v16, v56
    v_mov_b32 v17, v57
    v_mov_b32 v18, v58
    v_mov_b32 v19, v59
    v_mov_b32 v20, v60
    v_mov_b32 v21, v61
    v_mov_b32 v22, v62
    v_mov_b32 v23, v63
    v_mov_b32 v24, v64
    v_mov_b32 v25, v65
    v_mov_b32 v26, v66
    v_mov_b32 v27, v67
    v_mov_b32 v28, v68
    v_mov_b32 v29, v69
    v_mov_b32 v30, v70
    v_mov_b32 v31, v71
    v_mov_b32 v32, v72
    v_mov_b32 v33, v73
    v_mov_b32 v34, v74
    v_mov_b32 v35, v75
    v_mov_b32 v36, v76
    v_mov_b32 v37, v77
    v_mov_b32 v38, v78
    v_mov_b32 v39, v79
    v_mov_b32 v40, v80
    v_mov_b32 v41, v81
    v_mov_b32 v42, v82
    v_mov_b32 v43, v83
    v_mov_b32 v44, v84
    v_mov_b32 v45, v85
    v_mov_b32 v46, v86
    v_mov_b32 v47, v87
    v_mov_b32 v48, v88
    v_mov_b32 v49, v89
    v_mov_b32 v50, v90
    v_mov_b32 v51, v91
    v_mov_b32 v52, v92
    v_mov_b32 v53, v93
    v_mov_b32 v54, v94
    v_mov_b32 v55, v95
    s_branch L2_gj
L2_g0:
    ds_write_b128 v11, v[56:59] offset:0
    ds_write_b128 v11, v[60:63] offset:1024
    ds_write_b128 v11, v[64:67] offset:2048
    ds_write_b128 v11, v[68:71] offset:3072
    ds_write_b128 v11, v[72:75] offset:4096
    ds_write_b128 v11, v[76:79] offset:5120
    ds_write_b128 v11, v[80:83] offset:6144
    ds_write_b128 v11, v[84:87] offset:7168
    ds_write_b128 v11, v[88:91] offset:8192
    ds_write_b128 v11, v[92:95] offset:9216
L2_gj:
    s_waitcnt vmcnt(0) lgkmcnt(0)
    s_barrier
    ds_read_b128 v[96:99], v12 offset:0
    ds_read_b128 v[100:103], v12 offset:1024
    ds_read_b128 v[104:107], v12 offset:2048
    ds_read_b128 v[108:111], v12 offset:3072
    ds_read_b128 v[112:115], v12 offset:4096
    ds_read_b128 v[116:119], v12 offset:5120
    ds_read_b128 v[120:123], v12 offset:6144
    ds_read_b128 v[124:127], v12 offset:7168
    ds_read_b128 v[128:131], v12 offset:8192
    ds_read_b128 v[132:135], v12 offset:9216
    s_mul_i32 s44, s57, 2560
    s_waitcnt lgkmcnt(7)
    v_pk_add_f32 v[16:17], v[16:17], v[96:97]
    v_pk_add_f32 v[18:19], v[18:19], v[98:99]
    v_pk_add_f32 v[20:21], v[20:21], v[100:101]
    v_pk_add_f32 v[22:23], v[22:23], v[102:103]
    v_pk_add_f32 v[24:25], v[24:25], v[104:105]
    s_cmp_eq_u32 s57, 0
    s_cbranch_scc1 L2_own0
    buffer_store_dwordx4 v[16:19], v10, s[12:15], s44 offen sc1
    buffer_store_dwordx4 v[20:23], v10, s[12:15], s44 offen offset:1024 sc1
    buffer_store_dwordx2 v[24:25], v13, s[12:15], s44 offen offset:2048 sc1
    s_branch L2_ownj0
L2_own0:
    v_mov_b32 v172, v16
    v_mov_b32 v173, v17
    v_mov_b32 v174, v18
    v_mov_b32 v175, v19
    v_mov_b32 v176, v20
    v_mov_b32 v177, v21
    v_mov_b32 v178, v22
    v_mov_b32 v179, v23
    v_mov_b32 v180, v24
    v_mov_b32 v181, v25
L2_ownj0:
    s_add_u32 s44, s44, 10240
    s_waitcnt lgkmcnt(5)
    v_pk_add_f32 v[26:27], v[26:27], v[106:107]
    v_pk_add_f32 v[28:29], v[28:29], v[108:109]
    v_pk_add_f32 v[30:31], v[30:31], v[110:111]
    v_pk_add_f32 v[32:33], v[32:33], v[112:113]
    v_pk_add_f32 v[34:35], v[34:35], v[114:115]
    s_cmp_eq_u32 s57, 1
    s_cbranch_scc1 L2_own1
    buffer_store_dwordx4 v[26:29], v10, s[12:15], s44 offen sc1
    buffer_store_dwordx4 v[30:33], v10, s[12:15], s44 offen offset:1024 sc1
    buffer_store_dwordx2 v[34:35], v13, s[12:15], s44 offen offset:2048 sc1
    s_branch L2_ownj1
L2_own1:
    v_mov_b32 v172, v26
    v_mov_b32 v173, v27
    v_mov_b32 v174, v28
    v_mov_b32 v175, v29
    v_mov_b32 v176, v30
    v_mov_b32 v177, v31
    v_mov_b32 v178, v32
    v_mov_b32 v179, v33
    v_mov_b32 v180, v34
    v_mov_b32 v181, v35
L2_ownj1:
    s_add_u32 s44, s44, 10240
    s_waitcnt lgkmcnt(2)
    v_pk_add_f32 v[36:37], v[36:37], v[116:117]
    v_pk_add_f32 v[38:39], v[38:39], v[118:119]
    v_pk_add_f32 v[40:41], v[40:41], v[120:121]
    v_pk_add_f32 v[42:43], v[42:43], v[122:123]
    v_pk_add_f32 v[44:45], v[44:45], v[124:125]
    s_cmp_eq_u32 s57, 2
    s_cbranch_scc1 L2_own2
    buffer_store_dwordx4 v[36:39], v10, s[12:15], s44 offen sc1
    buffer_store_dwordx4 v[40:43], v10, s[12:15], s44 offen offset:1024 sc1
    buffer_store_dwordx2 v[44:45], v13, s[12:15], s44 offen offset:2048 sc1
    s_branch L2_ownj2
L2_own2:
    v_mov_b32 v172, v36
    v_mov_b32 v173, v37
    v_mov_b32 v174, v38
    v_mov_b32 v175, v39
    v_mov_b32 v176, v40
    v_mov_b32 v177, v41
    v_mov_b32 v178, v42
    v_mov_b32 v179, v43
    v_mov_b32 v180, v44
    v_mov_b32 v181, v45
L2_ownj2:
    s_add_u32 s44, s44, 10240
    s_waitcnt lgkmcnt(0)
    v_pk_add_f32 v[46:47], v[46:47], v[126:127]
    v_pk_add_f32 v[48:49], v[48:49], v[128:129]
    v_pk_add_f32 v[50:51], v[50:51], v[130:131]
    v_pk_add_f32 v[52:53], v[52:53], v[132:133]
    v_pk_add_f32 v[54:55], v[54:55], v[134:135]
    s_cmp_eq_u32 s57, 3
    s_cbranch_scc1 L2_own3
    buffer_store_dwordx4 v[46:49], v10, s[12:15], s44 offen sc1
    buffer_store_dwordx4 v[50:53], v10, s[12:15], s44 offen offset:1024 sc1
    buffer_store_dwordx2 v[54:55], v13, s[12:15], s44 offen offset:2048 sc1
    s_branch L2_ownj3
L2_own3:
    v_mov_b32 v172, v46
    v_mov_b32 v173, v47
    v_mov_b32 v174, v48
    v_mov_b32 v175, v49
    v_mov_b32 v176, v50
    v_mov_b32 v177, v51
    v_mov_b32 v178, v52
    v_mov_b32 v179, v53
    v_mov_b32 v180, v54
    v_mov_b32 v181, v55
L2_ownj3:
    s_add_u32 s44, s44, 10240
    s_waitcnt vmcnt(0)
    s_barrier
    s_and_b32 s46, s2, 0xfc
    s_lshl_b32 s46, s46, 7
    s_add_u32 s46, s46, 32768
    s_cmp_lg_u32 s27, 0
    s_cbranch_scc1 L2_wait
    s_lshl_b32 s47, s57, 7
    s_add_u32 s47, s47, s46
    v_mov_b32 v11, 1
    v_mov_b32 v12, 0
    s_mov_b64 exec, 1
    buffer_store_dword v11, v12, s[88:91], s47 offen sc1
    s_mov_b64 exec, 15
    v_lshlrev_b32 v12, 7, v1
    s_mov_b32 s50, 0
L2_poll:
    buffer_load_dword v11, v12, s[88:91], s46 offen sc1
    s_add_u32 s50, s50, 1
    s_waitcnt vmcnt(0)
    v_cmp_ne_u32 vcc, 1, v11
    s_cmp_gt_u32 s50, 0x8000
    s_cbranch_scc1 L2_go
    s_cbranch_vccz L2_go
    s_sleep 1
    s_branch L2_poll
L2_go:
    s_mov_b64 exec, -1
L2_wait:
    s_barrier
    s_mul_i32 s45, s57, 10240
    s_add_u32 s44, s57, 1
    s_and_b32 s44, s44, 3
    s_mul_i32 s44, s44, 2560
    s_add_u32 s44, s44, s45
    buffer_load_dwordx4 v[136:139], v10, s[12:15], s44 offen sc1
    buffer_load_dwordx4 v[140:143], v10, s[12:15], s44 offen offset:1024 sc1
    buffer_load_dwordx2 v[144:145], v13, s[12:15], s44 offen offset:2048 sc1
    s_add_u32 s44, s57, 2
    s_and_b32 s44, s44, 3
    s_mul_i32 s44, s44, 2560
    s_add_u32 s44, s44, s45
    buffer_load_dwordx4 v[148:151], v10, s[12:15], s44 offen sc1
    buffer_load_dwordx4 v[152:155], v10, s[12:15], s44 offen offset:1024 sc1
    buffer_load_dwordx2 v[156:157], v13, s[12:15], s44 offen offset:2048 sc1
    s_add_u32 s44, s57, 3
    s_and_b32 s44, s44, 3
    s_mul_i32 s44, s44, 2560
    s_add_u32 s44, s44, s45
    buffer_load_dwordx4 v[160:163], v10, s[12:15], s44 offen sc1
    buffer_load_dwordx4 v[164:167], v10, s[12:15], s44 offen offset:1024 sc1
    buffer_load_dwordx2 v[168:169], v13, s[12:15], s44 offen offset:2048 sc1
    s_mov_b32 s20, s36
    s_and_b32 s21, s37, 0xffff
    s_mov_b32 s22, 0x280000
    s_mov_b32 s23, 0x00020000
    s_lshl_b32 s44, s58, 7
    s_lshl_b32 s45, s24, 5
    s_add_u32 s44, s44, s45
    s_lshl_b32 s45, s54, 4
    s_add_u32 s44, s44, s45
    s_mul_i32 s44, s44, 2560
    s_mul_i32 s45, s56, 1280
    s_add_u32 s44, s44, s45
    s_mul_i32 s45, s59, 320
    s_add_u32 s44, s44, s45
    v_and_b32 v11, 15, v1
    v_mul_u32_u24 v11, 2560, v11
    v_lshrrev_b32 v12, 4, v1
    v_lshl_add_u32 v11, v12, 3, v11
    s_mul_i32 s45, s57, 5
    s_add_u32 s46, s45, 0
    s_lshr_b32 s47, s46, 1
    s_lshl_b32 s47, s47, 5
    s_and_b32 s46, s46, 1
    s_lshl_b32 s46, s46, 2
    s_add_u32 s47, s47, s46
    s_add_u32 s48, s47, s44
    s_add_u32 s46, s45, 1
    s_lshr_b32 s47, s46, 1
    s_lshl_b32 s47, s47, 5
    s_and_b32 s46, s46, 1
    s_lshl_b32 s46, s46, 2
    s_add_u32 s47, s47, s46
    s_add_u32 s49, s47, s44
    s_add_u32 s46, s45, 2
    s_lshr_b32 s47, s46, 1
    s_lshl_b32 s47, s47, 5
    s_and_b32 s46, s46, 1
    s_lshl_b32 s46, s46, 2
    s_add_u32 s47, s47, s46
    s_add_u32 s50, s47, s44
    s_add_u32 s46, s45, 3
    s_lshr_b32 s47, s46, 1
    s_lshl_b32 s47, s47, 5
    s_and_b32 s46, s46, 1
    s_lshl_b32 s46, s46, 2
    s_add_u32 s47, s47, s46
    s_add_u32 s51, s47, s44
    s_add_u32 s46, s45, 4
    s_lshr_b32 s47, s46, 1
    s_lshl_b32 s47, s47, 5
    s_and_b32 s46, s46, 1
    s_lshl_b32 s46, s46, 2
    s_add_u32 s47, s47, s46
    s_add_u32 s52, s47, s44
    s_waitcnt vmcnt(0)
    v_pk_add_f32 v[136:137], v[136:137], v[148:149]
    v_pk_add_f32 v[160:161], v[160:161], v[172:173]
    v_pk_add_f32 v[138:139], v[138:139], v[150:151]
    v_pk_add_f32 v[162:163], v[162:163], v[174:175]
    v_pk_add_f32 v[140:141], v[140:141], v[152:153]
    v_pk_add_f32 v[164:165], v[164:165], v[176:177]
    v_pk_add_f32 v[142:143], v[142:143], v[154:155]
    v_pk_add_f32 v[166:167], v[166:167], v[178:179]
    v_pk_add_f32 v[144:145], v[144:145], v[156:157]
    v_pk_add_f32 v[168:169], v[168:169], v[180:181]
    v_pk_add_f32 v[136:137], v[136:137], v[160:161]
    v_pk_add_f32 v[138:139], v[138:139], v[162:163]
    v_pk_add_f32 v[140:141], v[140:141], v[164:165]
    v_pk_add_f32 v[142:143], v[142:143], v[166:167]
    v_pk_add_f32 v[144:145], v[144:145], v[168:169]
    v_cvt_pk_bf16_f32 v16, v136, v137
    buffer_store_dword v16, v11, s[20:23], s48 offen
    v_cvt_pk_bf16_f32 v17, v138, v139
    buffer_store_dword v17, v11, s[20:23], s49 offen
    v_cvt_pk_bf16_f32 v18, v140, v141
    buffer_store_dword v18, v11, s[20:23], s50 offen
    v_cvt_pk_bf16_f32 v19, v142, v143
    buffer_store_dword v19, v11, s[20:23], s51 offen
    v_cvt_pk_bf16_f32 v20, v144, v145
    buffer_store_dword v20, v11, s[20:23], s52 offen
    s_waitcnt vmcnt(0)
L2_end:
    s_endpgm
.section .rodata,"a"
.p2align 6
.amdhsa_kernel concat_heads__gqa_block_cached__gqa_block_cached__near_ridge_kernel
  .amdhsa_next_free_vgpr 256
  .amdhsa_next_free_sgpr 102
  .amdhsa_accum_offset 256
  .amdhsa_group_segment_fixed_size 0
  .amdhsa_kernarg_size 104
  .amdhsa_user_sgpr_count 2
  .amdhsa_user_sgpr_kernarg_segment_ptr 1
  .amdhsa_system_sgpr_workgroup_id_x 1
.end_amdhsa_kernel
```
